```python
import torch

def _softmax(x, axis=-1):
    return torch.softmax(x, dim=axis)

def _gelu(x):
    return torch.nn.functional.gelu(x, approximate='tanh')

def _silu(x):
    return torch.nn.functional.silu(x)

def _sigmoid(x):
    return torch.sigmoid(x)

def _layernorm(x, axis=-1, eps=1e-05):
    m = x.mean(dim=axis, keepdim=True)
    v = x.var(dim=axis, keepdim=True, unbiased=False)
    return (x - m) / torch.sqrt(v + eps)

def _scatter_add(tgt, idx, src, axis=0):
    return tgt.clone().index_add_(axis, idx, src)

def _segment_sum(src, seg, n):
    out = torch.zeros((n,) + src.shape[1:], dtype=src.dtype)
    return out.index_add_(0, seg, src)

def _pad(x, pw):
    flat = tuple((v for pair in reversed(pw) for v in pair))
    return torch.nn.functional.pad(x, flat)
kernel_name = 'gated_mix__memory_aug_recurrent_mem_tr__glu_gated_reglu__prompt'

def setup_inputs():

    _w = lambda a: (lambda t: t.to(torch.bfloat16) if t.is_floating_point() else t)(torch.as_tensor(a))

    def _A_setup():
        B, S, Dm = (1, 2048, 512)
        H, Dh = (32, 128)
        M, seg = (8, 32)
        seg = min(seg, S)
        S = S // seg * seg
        return {'x': _w((lambda *s: torch.randn(*s, dtype=torch.bfloat16) * 0.05)(B, S, Dm)), 'mem0': _w((lambda *s: torch.randn(*s, dtype=torch.bfloat16) * 0.4)(B, M, Dm)), 'Wq': _w((lambda *s: torch.randn(*s, dtype=torch.bfloat16) * 6.4)(Dm, H, Dh) * Dm ** (-0.5)), 'Wk': _w((lambda *s: torch.randn(*s, dtype=torch.bfloat16) * 6.4)(Dm, H, Dh) * Dm ** (-0.5)), 'Wv': _w((lambda *s: torch.randn(*s, dtype=torch.bfloat16) * 0.4)(Dm, H, Dh) * Dm ** (-0.5)), 'Wo': _w((lambda *s: torch.randn(*s, dtype=torch.bfloat16) * 0.4)(H, Dh, Dm) * (H * Dh) ** (-0.5)), 'seg_len': seg}
    _A_in = _A_setup()

    def _B_setup():
        B, S, D, F = (1, 2048, 512, 1792)
        return {'x': _w((lambda *s: torch.randn(*s, dtype=torch.bfloat16) * 0.05)(B, S, D)), 'W_gate': _w((lambda *s: torch.randn(*s, dtype=torch.bfloat16) * 0.8)(D, F) * (2.0 / D) ** 0.5), 'W_up': _w((lambda *s: torch.randn(*s, dtype=torch.bfloat16) * 0.8)(D, F) * (2.0 / D) ** 0.5), 'W_down': _w((lambda *s: torch.randn(*s, dtype=torch.bfloat16) * 0.8)(F, D) * (1.0 / F) ** 0.5)}
    _B_in = _B_setup()
    return {'A_x': _A_in['x'], 'A_mem0': _A_in['mem0'], 'A_Wq': _A_in['Wq'], 'A_Wk': _A_in['Wk'], 'A_Wv': _A_in['Wv'], 'A_Wo': _A_in['Wo'], 'A_seg_len': _A_in['seg_len'], 'B_x': _B_in['x'], 'B_W_gate': _B_in['W_gate'], 'B_W_up': _B_in['W_up'], 'B_W_down': _B_in['W_down'], 'gate_w': _w((lambda *s: torch.randn(*s, dtype=torch.bfloat16) * 0.05)(512) * 16.0)}

def reference(A_x, A_mem0, A_Wq, A_Wk, A_Wv, A_Wo, A_seg_len, B_x, B_W_gate, B_W_up, B_W_down, gate_w):

    def _A_ref(x, mem0, Wq, Wk, Wv, Wo, seg_len):
        B, S, Dm = x.shape
        H, Dh = (Wq.shape[1], Wq.shape[2])
        M = mem0.shape[1]
        scale = Dh ** (-0.5)
        n_seg = S // seg_len
        L = M + seg_len
        idx = torch.arange(L)
        mask = (idx[:, None] < M) | (idx[:, None] >= idx[None, :])
        mem = mem0
        outs = []
        for s in range(n_seg):
            xs = x[:, s * seg_len:(s + 1) * seg_len, :].clone()
            h = torch.concatenate([mem, xs], axis=1)
            q = torch.einsum('btd,dhe->bhte', h, Wq)
            k = torch.einsum('btd,dhe->bhte', h, Wk)
            v = torch.einsum('btd,dhe->bhte', h, Wv)
            scores = torch.einsum('bhqe,bhke->bhqk', q, k) * scale
            scores = torch.where(mask[None, None], scores, -1000000000.0)
            p = _softmax(scores, axis=-1)
            o = torch.einsum('bhqk,bhke->bhqe', p, v)
            o = torch.einsum('bhte,hed->btd', o, Wo)
            mem = o[:, :M, :].clone()
            outs.append(o[:, M:, :])
        return torch.concatenate(outs, axis=1)

    def _B_ref(x, W_gate, W_up, W_down):
        gate = torch.einsum('bsd,df->bsf', x, W_gate)
        up = torch.einsum('bsd,df->bsf', x, W_up)
        gate = gate * (lambda x, dt: x.to(dt))(gate > 0, gate.dtype)
        h = gate * up
        return torch.einsum('bsf,fd->bsd', h, W_down)
    x = A_x
    g = _sigmoid((x * gate_w).sum(-1, keepdims=True))
    a = _A_ref(x, A_mem0, A_Wq, A_Wk, A_Wv, A_Wo, A_seg_len)
    b = _B_ref(x, B_W_gate, B_W_up, B_W_down)
    return g * a + (1 - g) * b
```

```asm
; @launch grid=(256,1,1) block=(256,1,1) lds=163840
.amdgcn_target "amdgcn-amd-amdhsa--gfx950"
.text
.globl gated_mix__memory_aug_recurrent_mem_tr__glu_gated_reglu__prompt_kernel
.p2align 8
.type gated_mix__memory_aug_recurrent_mem_tr__glu_gated_reglu__prompt_kernel,@function
gated_mix__memory_aug_recurrent_mem_tr__glu_gated_reglu__prompt_kernel:
    s_cmp_ge_u32 s2, 256
    s_cbranch_scc1 L_end
    s_load_dwordx16 s[60:75], s[0:1], 0
    s_load_dwordx8 s[76:83], s[0:1], 64
    s_load_dwordx4 s[84:87], s[0:1], 96
    s_load_dwordx2 s[88:89], s[0:1], 112
    v_lshrrev_b32 v1, 6, v0
    v_and_b32 v0, 63, v0
    v_readfirstlane_b32 s3, v1
    s_mov_b32 s40, 0x05040100
    s_mov_b32 s41, 0x07060302
    s_mov_b32 s42, 1040356334
    s_getreg_b32 s4, hwreg(HW_REG_XCC_ID)
    s_and_b32 s4, s4, 7
    s_waitcnt lgkmcnt(0)
    s_mov_b32 s8, s60
    s_mov_b32 s9, s61
    s_mov_b32 s10, 2097152
    s_mov_b32 s11, 0x20000
    s_mov_b32 s12, s88
    s_mov_b32 s13, s89
    s_mov_b32 s14, 268435456
    s_mov_b32 s15, 0x20000
    s_mov_b32 s16, s86
    s_mov_b32 s17, s87
    s_mov_b32 s18, 256
    s_mov_b32 s19, 0x20000
    v_mov_b32 v3, 161792
    s_cmp_lg_u32 s3, 0
    s_cbranch_scc1 L_role_wait
    v_lshlrev_b32 v4, 2, v0
    v_add_u32 v4, 128, v4
    v_cmp_eq_u32 vcc, 0, v0
    s_nop 1
    v_cndmask_b32 v4, v4, v0, vcc
    s_mov_b64 exec, 1
    s_lshl_b32 s7, s4, 2
    s_add_u32 s7, s7, 128
    s_cmp_eq_u32 s4, 0
    s_cselect_b32 s7, 0, s7
    v_mov_b32 v2, 1
    buffer_atomic_add v2, off, s[16:19], s7 sc0
    s_waitcnt vmcnt(0)
    v_readfirstlane_b32 s5, v2
    s_nop 3
    s_cmp_lt_u32 s5, 32
    s_cbranch_scc1 L_role_slot
    v_mov_b32 v2, 1
    buffer_atomic_add v2, off, s[16:19], 0 offset:128 sc0
    s_waitcnt vmcnt(0)
    v_readfirstlane_b32 s6, v2
    s_mov_b64 exec, 0xff
    s_mov_b32 s96, 0
L_role_census:
    buffer_load_dword v2, v4, s[16:19], 0 offen sc1
    s_waitcnt vmcnt(0)
    v_readlane_b32 s44, v2, 0
    v_readlane_b32 s45, v2, 1
    v_readlane_b32 s46, v2, 2
    v_readlane_b32 s47, v2, 3
    v_readlane_b32 s48, v2, 4
    v_readlane_b32 s49, v2, 5
    v_readlane_b32 s50, v2, 6
    v_readlane_b32 s51, v2, 7
    s_nop 3
    s_mov_b32 s7, 0
    s_add_u32 s7, s7, s44
    s_add_u32 s7, s7, s45
    s_add_u32 s7, s7, s46
    s_add_u32 s7, s7, s47
    s_add_u32 s7, s7, s48
    s_add_u32 s7, s7, s49
    s_add_u32 s7, s7, s50
    s_add_u32 s7, s7, s51
    s_cmp_ge_u32 s7, 256
    s_cbranch_scc1 L_role_pick
    s_sleep 4
    s_add_u32 s96, s96, 1
    s_cmp_lt_u32 s96, 330033
    s_cbranch_scc1 L_role_census
    s_branch L_bail
L_role_pick:
    s_mov_b64 exec, 1
    s_min_u32 s7, s44, 32
    s_mov_b32 s4, 0
    s_add_u32 s5, s7, s6
    s_cmp_lt_u32 s5, 32
    s_cbranch_scc1 L_role_slot
    s_sub_u32 s6, s5, 32
    s_min_u32 s7, s45, 32
    s_mov_b32 s4, 1
    s_add_u32 s5, s7, s6
    s_cmp_lt_u32 s5, 32
    s_cbranch_scc1 L_role_slot
    s_sub_u32 s6, s5, 32
    s_min_u32 s7, s46, 32
    s_mov_b32 s4, 2
    s_add_u32 s5, s7, s6
    s_cmp_lt_u32 s5, 32
    s_cbranch_scc1 L_role_slot
    s_sub_u32 s6, s5, 32
    s_min_u32 s7, s47, 32
    s_mov_b32 s4, 3
    s_add_u32 s5, s7, s6
    s_cmp_lt_u32 s5, 32
    s_cbranch_scc1 L_role_slot
    s_sub_u32 s6, s5, 32
    s_min_u32 s7, s48, 32
    s_mov_b32 s4, 4
    s_add_u32 s5, s7, s6
    s_cmp_lt_u32 s5, 32
    s_cbranch_scc1 L_role_slot
    s_sub_u32 s6, s5, 32
    s_min_u32 s7, s49, 32
    s_mov_b32 s4, 5
    s_add_u32 s5, s7, s6
    s_cmp_lt_u32 s5, 32
    s_cbranch_scc1 L_role_slot
    s_sub_u32 s6, s5, 32
    s_min_u32 s7, s50, 32
    s_mov_b32 s4, 6
    s_add_u32 s5, s7, s6
    s_cmp_lt_u32 s5, 32
    s_cbranch_scc1 L_role_slot
    s_sub_u32 s6, s5, 32
    s_min_u32 s7, s51, 32
    s_mov_b32 s4, 7
    s_add_u32 s5, s7, s6
    s_cmp_lt_u32 s5, 32
    s_cbranch_scc1 L_role_slot
    s_sub_u32 s6, s5, 32
    s_mov_b32 s5, 255
    s_branch L_role_have
L_role_slot:
    s_mul_i32 s7, s5, 7
    s_add_u32 s7, s7, s4
    s_add_u32 s7, s7, 31
    s_cmp_eq_u32 s4, 0
    s_cselect_b32 s5, s5, s7
L_role_have:
    v_mov_b32 v2, s5
    ds_write_b32 v3, v2
    s_waitcnt lgkmcnt(0)
    s_mov_b64 exec, -1
L_role_wait:
    s_mov_b32 s24, s66
    s_mov_b32 s25, s67
    s_mov_b32 s26, 4194304
    s_mov_b32 s27, 0x20000
    s_cmp_eq_u32 s3, 0
    s_cbranch_scc1 L_pt_done
    s_cmp_lg_u32 s4, 0
    s_cbranch_scc1 L_pt_done
    s_lshr_b32 s7, s2, 3
    s_and_b32 s43, s7, 7
    s_lshl_b32 s43, s43, 16
    s_lshr_b32 s7, s7, 3
    s_lshl_b32 s7, s7, 20
    s_add_u32 s7, s7, s43
    s_sub_u32 s43, s3, 1
    s_mul_i32 s43, s43, 16384
    s_add_u32 s7, s7, s43
    v_lshlrev_b32 v4, 7, v0
    s_nop 15
    buffer_load_dword v100, v4, s[24:27], s7 offen
    s_add_u32 s7, s7, 8192
    buffer_load_dword v101, v4, s[24:27], s7 offen
    s_add_u32 s7, s7, 8192
L_pt_done:
    s_barrier
    ds_read_b32 v2, v3
    s_waitcnt lgkmcnt(0)
    v_readfirstlane_b32 s4, v2
    v_lshrrev_b32 v1, 4, v0
    v_and_b32 v2, 15, v0
    s_nop 2
    s_and_b32 s4, s4, 255
    s_cmp_lt_u32 s4, 32
    s_cbranch_scc1 L_chain
    s_cmp_lt_u32 s4, 96
    s_cbranch_scc1 L_B
    s_cmp_lt_u32 s4, 160
    s_cbranch_scc1 L_C
    s_cmp_lt_u32 s4, 188
    s_cbranch_scc1 L_F
    s_cmp_lt_u32 s4, 252
    s_cbranch_scc1 L_R
    s_barrier
    s_cmp_lg_u32 s3, 0
    s_cbranch_scc1 IA_1
    v_mov_b32 v3, 1
    s_mov_b64 exec, 1
    buffer_atomic_add v3, off, s[16:19], 0 offset:64
    s_mov_b64 exec, -1
IA_1:
    s_cmp_lg_u32 s4, 252
    s_cbranch_scc1 L_end
    s_cmp_lg_u32 s3, 0
    s_cbranch_scc1 L_end
    s_mov_b32 s96, 0
WS_2:
    buffer_load_dword v3, off, s[16:19], 64 sc1
    s_waitcnt vmcnt(0)
    v_readfirstlane_b32 s7, v3
    s_nop 3
    s_cmp_ge_u32 s7, 256
    s_cbranch_scc1 WSOK_3
    s_sleep 12
    s_add_u32 s96, s96, 1
    s_cmp_lt_u32 s96, 178890
    s_cbranch_scc1 WS_2
    s_branch L_bail
WSOK_3:
    v_mov_b32 v3, 1
    s_mov_b64 exec, 1
    buffer_store_dword v3, off, s[16:19], 0 offset:224 sc1
    s_waitcnt vmcnt(0)
    s_endpgm
L_bail:
    s_mov_b64 exec, 1
    v_mov_b32 v0, s4
    v_add_u32 v0, 0x100, v0
    buffer_store_dword v0, off, s[16:19], 0 offset:192
    s_waitcnt vmcnt(0)
L_end:
    s_endpgm
L_R:
    s_sub_u32 s4, s4, 188
    s_lshr_b32 s5, s4, 5
    s_and_b32 s4, s4, 31
    v_lshlrev_b32 v4, 15, v1
    v_lshl_add_u32 v4, v2, 4, v4
    s_lshl_b32 s7, s4, 10
    s_lshl_b32 s43, s3, 8
    s_add_u32 s7, s7, s43
    v_add_u32 v4, s7, v4
    v_lshlrev_b32 v5, 3, v1
    v_lshl_add_u32 v5, v2, 4, v5
    v_add_u32 v5, s7, v5
    v_mov_b64 v[24:25], -1
    v_mov_b64 v[26:27], -1
    s_lshl_b32 s45, s5, 19
    s_add_u32 s45, s45, 84934656
    buffer_store_dwordx4 v[24:27], v4, s[12:15], s45 offen sc1
    s_add_u32 s45, s45, 0x20000
    buffer_store_dwordx4 v[24:27], v4, s[12:15], s45 offen sc1
    s_add_u32 s45, s45, 0x20000
    buffer_store_dwordx4 v[24:27], v4, s[12:15], s45 offen sc1
    s_add_u32 s45, s45, 0x20000
    buffer_store_dwordx4 v[24:27], v4, s[12:15], s45 offen sc1
    s_add_u32 s45, s45, 0x20000
    s_waitcnt vmcnt(0)
    s_barrier
    s_cmp_lg_u32 s3, 0
    s_cbranch_scc1 IA_4
    v_mov_b32 v24, 1
    s_mov_b64 exec, 1
    buffer_atomic_add v24, off, s[16:19], 0 offset:64
    s_mov_b64 exec, -1
IA_4:
    s_lshl_b32 s7, s5, 5
    s_add_u32 s7, s7, s4
    s_lshl_b32 s7, s7, 2
    s_add_u32 s7, s7, s3
    s_lshl_b32 s7, s7, 14
    v_lshlrev_b32 v24, 7, v0
    s_mov_b32 s24, s64
    s_mov_b32 s25, s65
    s_mov_b32 s26, 4194304
    s_mov_b32 s27, 0x20000
    buffer_load_dword v26, v24, s[24:27], s7 offen
    s_add_u32 s43, s7, 8192
    buffer_load_dword v27, v24, s[24:27], s43 offen
    s_mov_b32 s24, s68
    s_mov_b32 s25, s69
    s_mov_b32 s26, 4194304
    s_mov_b32 s27, 0x20000
    buffer_load_dword v28, v24, s[24:27], s7 offen
    s_add_u32 s43, s7, 8192
    buffer_load_dword v29, v24, s[24:27], s43 offen
    s_mov_b32 s24, s70
    s_mov_b32 s25, s71
    s_mov_b32 s26, 4194304
    s_mov_b32 s27, 0x20000
    buffer_load_dword v30, v24, s[24:27], s7 offen
    s_add_u32 s43, s7, 8192
    buffer_load_dword v31, v24, s[24:27], s43 offen
    s_waitcnt vmcnt(0)
    s_mov_b32 s20, s84
    s_mov_b32 s21, s85
    s_mov_b32 s22, 2097152
    s_mov_b32 s23, 0x20000
    s_mov_b32 s24, s82
    s_mov_b32 s25, s83
    s_mov_b32 s26, 1024
    s_mov_b32 s27, 0x20000
    v_and_b32 v24, 1, v2
    v_lshlrev_b32 v24, 4, v24
    v_mov_b32 v25, 0x3f80
    v_lshlrev_b32 v24, v24, v25
    v_bfe_u32 v25, v2, 1, 2
    v_cmp_eq_u32 vcc, 0, v25
    s_nop 1
    v_cndmask_b32 v16, 0, v24, vcc
    v_cmp_eq_u32 vcc, 1, v25
    s_nop 1
    v_cndmask_b32 v17, 0, v24, vcc
    v_cmp_eq_u32 vcc, 2, v25
    s_nop 1
    v_cndmask_b32 v18, 0, v24, vcc
    v_cmp_eq_u32 vcc, 3, v25
    s_nop 1
    v_cndmask_b32 v19, 0, v24, vcc
    v_lshlrev_b32 v3, 7, v0
    v_lshlrev_b32 v0, 4, v0
    buffer_load_dwordx4 v[8:11], v0, s[24:27], 0 offen
    s_lshl_b32 s7, s5, 2
    s_add_u32 s7, s7, s3
    s_lshl_b32 s7, s7, 11
    s_add_u32 s54, s7, 393216
    s_add_u32 s55, s7, 425984
    s_mov_b32 s6, 0
    s_mov_b32 s58, 3216550459
    v_mov_b32 v76, 0
    v_mov_b32 v77, 0
    v_mov_b32 v78, 0
    v_mov_b32 v79, 0
    s_mov_b32 s90, 224
    s_mov_b32 s96, 0
WS_5:
    buffer_load_dword v24, off, s[16:19], s90 sc1
    s_waitcnt vmcnt(0)
    v_readfirstlane_b32 s7, v24
    s_nop 3
    s_cmp_ge_u32 s7, 1
    s_cbranch_scc1 WSOK_6
    s_sleep 64
    s_add_u32 s96, s96, 1
    s_cmp_lt_u32 s96, 44984
    s_cbranch_scc1 WS_5
    s_branch L_bail
WSOK_6:
R_loop:
    s_lshl_b32 s43, s6, 1
    s_add_u32 s43, s43, s5
    s_add_u32 s57, s6, 1
    s_lshl_b32 s44, s43, 15
    s_lshl_b32 s7, s4, 10
    s_add_u32 s7, s7, s44
    buffer_load_dwordx4 v[12:15], v0, s[8:11], s7 offen
    s_mov_b32 s96, 0
    s_mov_b32 exec_lo, 0x3fff
    s_mov_b32 exec_hi, 0
WL_7:
    buffer_load_dword v24, v3, s[12:15], s55 offen sc1
    s_waitcnt vmcnt(0)
    v_cmp_gt_u32 vcc, s57, v24
    s_cbranch_vccz WLOK_8
    s_sleep 2
    s_add_u32 s96, s96, 1
    s_cmp_lt_u32 s96, 418410
    s_cbranch_scc1 WL_7
    s_branch L_bail
WLOK_8:
    s_mov_b64 exec, -1
    s_lshl_b32 s45, s43, 19
    s_and_b32 s45, s45, 0x1ffffff
    s_add_u32 s45, s45, 117440512
    buffer_load_dwordx4 v[64:67], v4, s[12:15], s45 offen sc1
    s_add_u32 s45, s45, 0x20000
    buffer_load_dwordx4 v[68:71], v4, s[12:15], s45 offen sc1
    s_add_u32 s45, s45, 0x20000
    buffer_load_dwordx4 v[72:75], v4, s[12:15], s45 offen sc1
    s_add_u32 s45, s45, 0x20000
    s_mov_b32 exec_hi, 0
    buffer_load_dwordx4 v[76:79], v4, s[12:15], s45 offen sc1
    s_mov_b64 exec, -1
    v_mov_b32 v24, 0
    v_dot2c_f32_bf16 v24, v12, v8
    v_dot2c_f32_bf16 v24, v13, v9
    v_dot2c_f32_bf16 v24, v14, v10
    v_dot2c_f32_bf16 v24, v15, v11
    s_nop 2
    v_add_f32_dpp v24, v24, v24 row_ror:8 row_mask:0xf bank_mask:0xf
    s_nop 1
    v_add_f32_dpp v24, v24, v24 row_ror:4 row_mask:0xf bank_mask:0xf
    s_nop 1
    v_add_f32_dpp v24, v24, v24 row_ror:2 row_mask:0xf bank_mask:0xf
    s_nop 1
    v_add_f32_dpp v24, v24, v24 row_ror:1 row_mask:0xf bank_mask:0xf
    v_mov_b32 v25, v24
    s_nop 1
    v_permlane16_swap_b32 v24, v25
    v_add_f32 v24, v24, v25
    v_mov_b32 v25, v24
    s_nop 1
    v_permlane32_swap_b32 v24, v25
    v_add_f32 v24, v24, v25
    v_mul_f32 v24, s58, v24
    v_exp_f32 v24, v24
    s_nop 0
    v_add_f32 v24, 1.0, v24
    v_rcp_f32 v6, v24
    s_nop 0
    v_sub_f32 v7, 1.0, v6
    s_waitcnt vmcnt(0)
    v_mfma_f32_16x16x32_bf16 v[28:31], v[16:19], v[64:67], 0
    v_mfma_f32_16x16x32_bf16 v[28:31], v[16:19], v[68:71], v[28:31]
    v_mfma_f32_16x16x32_bf16 v[28:31], v[16:19], v[72:75], v[28:31]
    v_mfma_f32_16x16x32_bf16 v[28:31], v[16:19], v[76:79], v[28:31]
    s_nop 7
    v_mul_f32 v28, v28, v7
    v_mul_f32 v29, v29, v7
    v_mul_f32 v30, v30, v7
    v_mul_f32 v31, v31, v7
    s_cmp_eq_u32 s6, 31
    s_cbranch_scc1 R_direct
    s_and_b32 s7, s6, 1
    s_lshl_b32 s7, s7, 14
    s_add_u32 s46, s54, s7
    s_lshr_b32 s57, s6, 1
    s_add_u32 s57, s57, 1
    s_mov_b32 s96, 0
    s_mov_b32 exec_lo, 0xffff
    s_mov_b32 exec_hi, 0
WL_9:
    buffer_load_dword v24, v3, s[12:15], s46 offen sc1
    s_waitcnt vmcnt(0)
    v_cmp_gt_u32 vcc, s57, v24
    s_cbranch_vccz WLOK_10
    s_sleep 2
    s_add_u32 s96, s96, 1
    s_cmp_lt_u32 s96, 418410
    s_cbranch_scc1 WL_9
    s_branch L_bail
WLOK_10:
    s_mov_b64 exec, -1
R_direct:
    s_mov_b32 s96, 0
R_poll:
    s_lshl_b32 s45, s43, 19
    s_add_u32 s45, s45, 52428800
    buffer_load_dwordx4 v[32:35], v4, s[12:15], s45 offen sc1
    s_add_u32 s45, s45, 0x20000
    buffer_load_dwordx4 v[36:39], v4, s[12:15], s45 offen sc1
    s_add_u32 s45, s45, 0x20000
    buffer_load_dwordx4 v[40:43], v4, s[12:15], s45 offen sc1
    s_add_u32 s45, s45, 0x20000
    buffer_load_dwordx4 v[44:47], v4, s[12:15], s45 offen sc1
    s_waitcnt vmcnt(3)
    v_mfma_f32_16x16x32_bf16 v[24:27], v[16:19], v[32:35], 0
    v_max3_u32 v48, v32, v33, v34
    v_max_u32 v48, v48, v35
    s_waitcnt vmcnt(2)
    v_mfma_f32_16x16x32_bf16 v[24:27], v[16:19], v[36:39], v[24:27]
    v_max3_u32 v49, v36, v37, v38
    v_max_u32 v49, v49, v39
    s_waitcnt vmcnt(1)
    v_mfma_f32_16x16x32_bf16 v[24:27], v[16:19], v[40:43], v[24:27]
    v_max3_u32 v50, v40, v41, v42
    v_max_u32 v50, v50, v43
    s_waitcnt vmcnt(0)
    v_mfma_f32_16x16x32_bf16 v[24:27], v[16:19], v[44:47], v[24:27]
    v_max3_u32 v51, v44, v45, v46
    v_max_u32 v51, v51, v47
    v_max3_u32 v48, v48, v49, v50
    v_max_u32 v48, v48, v51
    v_cmp_eq_u32 vcc, -1, v48
    s_cbranch_vccz R_have
    s_sleep 2
    s_add_u32 s96, s96, 1
    s_cmp_lt_u32 s96, 418410
    s_cbranch_scc1 R_poll
    s_branch L_bail
R_have:
    s_nop 3
    v_fma_f32 v24, v24, v6, v28
    v_fma_f32 v25, v25, v6, v29
    v_fma_f32 v26, v26, v6, v30
    v_fma_f32 v27, v27, v6, v31
    v_cvt_pk_bf16_f32 v24, v24, v25
    v_cvt_pk_bf16_f32 v25, v26, v27
    s_mov_b32 exec_hi, 0
    buffer_store_dwordx2 v[24:25], v5, s[20:23], s44 offen sc1
    s_mov_b64 exec, -1
    s_add_u32 s6, s6, 1
    s_cmp_lt_u32 s6, 32
    s_cbranch_scc1 R_loop
    s_waitcnt vmcnt(0)
    s_waitcnt vmcnt(0)
    s_endpgm
L_chain:
    s_mov_b32 s20, s62
    s_mov_b32 s21, s63
    s_mov_b32 s22, 8192
    s_mov_b32 s23, 0x20000
    s_mov_b32 s24, s64
    s_mov_b32 s25, s65
    s_mov_b32 s26, 4194304
    s_mov_b32 s27, 0x20000
    s_mov_b32 s28, s66
    s_mov_b32 s29, s67
    s_mov_b32 s30, 4194304
    s_mov_b32 s31, 0x20000
    s_mov_b32 s32, s68
    s_mov_b32 s33, s69
    s_mov_b32 s34, 4194304
    s_mov_b32 s35, 0x20000
    s_mov_b32 s36, s70
    s_mov_b32 s37, s71
    s_mov_b32 s38, 4194304
    s_mov_b32 s39, 0x20000
    v_and_b32 v20, 1, v2
    v_lshlrev_b32 v20, 4, v20
    v_mov_b32 v21, 0x3f80
    v_lshlrev_b32 v20, v20, v21
    v_bfe_u32 v21, v2, 1, 2
    v_cmp_eq_u32 vcc, 0, v21
    s_nop 1
    v_cndmask_b32 v12, 0, v20, vcc
    v_cmp_eq_u32 vcc, 1, v21
    s_nop 1
    v_cndmask_b32 v13, 0, v20, vcc
    v_cmp_eq_u32 vcc, 2, v21
    s_nop 1
    v_cndmask_b32 v14, 0, v20, vcc
    v_cmp_eq_u32 vcc, 3, v21
    s_nop 1
    v_cndmask_b32 v15, 0, v20, vcc
    v_mov_b32 v22, v0
    v_lshlrev_b32 v0, 4, v0
    v_and_b32 v24, 1, v2
    v_lshrrev_b32 v25, 2, v2
    v_and_b32 v26, 3, v2
    v_lshrrev_b32 v28, 1, v2
    v_and_b32 v29, 1, v1
    v_lshrrev_b32 v23, 1, v1
    v_lshlrev_b32 v27, 18, v23
    v_lshl_add_u32 v27, v29, 16, v27
    v_lshl_add_u32 v27, v2, 4, v27
    s_lshl_b32 s90, s4, 8
    s_lshl_b32 s91, s3, 20
    s_add_u32 s90, s90, s91
    v_add_u32 v30, s90, v27
    v_add_u32 v31, 8192, v30
    v_lshlrev_b32 v18, 8, v1
    v_lshl_add_u32 v18, v26, 6, v18
    v_add_u32 v18, 32768, v18
    s_mov_b32 s90, 32768
    v_lshrrev_b32 v27, 1, v25
    v_and_b32 v19, 1, v25
    v_lshl_add_u32 v19, v19, 1, v27
    v_mul_lo_u32 v16, v19, s90
    v_sub_u32 v19, s3, v25
    v_and_b32 v19, 3, v19
    v_lshl_add_u32 v16, v19, 12, v16
    v_add_u32 v16, v16, v18
    v_mul_lo_u32 v17, v25, s90
    v_sub_u32 v19, s3, v27
    v_add_u32 v19, 2, v19
    v_and_b32 v19, 3, v19
    v_lshl_add_u32 v17, v19, 12, v17
    v_add_u32 v17, v17, v18
    s_and_b32 s91, s3, 1
    s_mul_i32 s91, s91, 65536
    s_add_u32 s91, s91, 32768
    v_add_u32 v18, s91, v0
    s_lshr_b32 s7, s3, 1
    s_mul_i32 s7, s7, 32768
    v_add_u32 v19, s7, v18
    v_lshlrev_b32 v27, 14, v23
    v_lshl_add_u32 v27, v29, 12, v27
    v_lshl_add_u32 v27, v2, 4, v27
    s_lshl_b32 s90, s4, 17
    s_lshl_b32 s91, s3, 8
    s_add_u32 s90, s90, s91
    v_add_u32 v11, s90, v27
    v_mov_b32 v20, 0x4444
    v_mov_b32 v21, 0xeeee
    v_cmp_eq_u32 vcc, 0, v24
    s_nop 1
    v_cndmask_b32 v4, v21, v20, vcc
    s_lshl_b32 s86, s3, 10
    s_add_u32 s90, s86, 0
    v_add_u32 v3, s90, v0
    v_lshlrev_b32 v5, 7, v25
    v_lshl_add_u32 v5, v1, 5, v5
    v_lshl_add_u32 v5, v26, 2, v5
    s_mul_i32 s90, s3, 1024
    s_add_u32 s90, s90, 8192
    v_add_u32 v5, s90, v5
    v_lshl_add_u32 v27, v25, 1, v24
    v_lshlrev_b32 v27, 4, v27
    v_lshl_add_u32 v27, v1, 7, v27
    v_cmp_gt_u32 vcc, 2, v26
    v_add_u32 v8, 8192, v27
    s_add_u32 s90, s86, 12288
    v_add_u32 v20, s90, v27
    v_xor_b32 v21, 64, v20
    v_add_u32 v21, 512, v21
    v_cndmask_b32 v9, v20, v21, vcc
    v_lshl_add_u32 v27, v1, 1, v24
    v_lshlrev_b32 v27, 7, v27
    v_lshl_add_u32 v27, v28, 4, v27
    v_lshlrev_b32 v20, 6, v23
    v_xor_b32 v27, v27, v20
    v_add_u32 v6, 12288, v27
    v_lshl_add_u32 v27, v25, 1, v23
    v_lshlrev_b32 v27, 13, v27
    v_lshl_add_u32 v27, v29, 11, v27
    v_lshl_add_u32 v27, v26, 4, v27
    s_lshl_b32 s90, s3, 16
    s_lshl_b32 s91, s4, 6
    s_add_u32 s90, s90, s91
    v_add_u32 v7, s90, v27
    v_lshlrev_b32 v25, 10, v28
    v_lshl_add_u32 v25, v1, 6, v25
    v_lshl_add_u32 v25, v24, 5, v25
    s_lshl_b32 s91, s3, 8
    v_add_u32 v25, s91, v25
    s_and_b32 s91, s3, 1
    s_mul_i32 s91, s91, 2048
    s_add_u32 s91, s91, 8704
    v_mul_u32_u24 v24, 1024, v23
    v_and_b32 v27, 31, v22
    v_lshl_add_u32 v24, v27, 4, v24
    v_add_u32 v24, s91, v24
    s_lshr_b32 s90, s3, 1
    s_lshl_b32 s90, s90, 12
    s_lshl_b32 s91, s4, 7
    s_add_u32 s90, s90, s91
    s_and_b32 s91, s3, 1
    s_lshl_b32 s91, s91, 6
    s_add_u32 s90, s90, s91
    v_lshlrev_b32 v27, 5, v29
    v_lshl_add_u32 v27, v26, 3, v27
    v_and_b32 v20, 4, v2
    v_add_u32 v27, v27, v20
    v_add_u32 v1, s90, v27
    s_mov_b32 s58, 0x00ff00ff
    s_mov_b32 s59, 0
    s_lshl_b32 s44, s4, 2
    s_add_u32 s44, s44, s3
    s_lshl_b32 s44, s44, 11
    s_add_u32 s44, s44, 1048576
    s_lshl_b32 s55, s4, 7
    s_lshl_b32 s54, s4, 2
    s_add_u32 s54, s54, s3
    s_lshl_b32 s54, s54, 7
    s_add_u32 s54, s54, 16384
    s_add_u32 s55, s55, 0
    s_add_u32 s7, s3, 1
    s_and_b32 s7, s7, 3
    s_lshl_b32 s7, s7, 10
    s_add_u32 s81, s7, 0
    s_add_u32 s7, s3, 2
    s_and_b32 s7, s7, 3
    s_lshl_b32 s7, s7, 10
    s_add_u32 s82, s7, 0
    s_add_u32 s7, s3, 3
    s_and_b32 s7, s7, 3
    s_lshl_b32 s7, s7, 10
    s_add_u32 s83, s7, 0
    v_mov_b64 v[20:21], -1
    v_mov_b64 v[22:23], -1
    s_add_u32 s7, s44, 0
    buffer_store_dwordx4 v[20:23], v0, s[12:15], s7 offen offset:0 sc1
    buffer_store_dwordx4 v[20:23], v0, s[12:15], s7 offen offset:1024 sc1
    s_add_u32 s7, s44, 262144
    buffer_store_dwordx4 v[20:23], v0, s[12:15], s7 offen offset:0 sc1
    buffer_store_dwordx4 v[20:23], v0, s[12:15], s7 offen offset:1024 sc1
    s_mov_b64 exec, s[58:59]
    s_mov_b32 s7, 65536
    buffer_store_dword v20, v1, s[12:15], s7 offen sc1
    s_mov_b32 s7, 73728
    buffer_store_dword v20, v1, s[12:15], s7 offen sc1
    s_mov_b32 s7, 81920
    buffer_store_dword v20, v1, s[12:15], s7 offen sc1
    s_mov_b32 s7, 90112
    buffer_store_dword v20, v1, s[12:15], s7 offen sc1
    s_mov_b64 exec, -1
    v_mov_b32 v27, 0
    s_mov_b64 exec, 1
    buffer_store_dword v27, off, s[12:15], s54 sc1
    s_mov_b64 exec, -1
    s_mov_b32 s7, 0
    buffer_load_dwordx4 v[64:67], v30, s[28:31], s7 offen
    buffer_load_dwordx4 v[68:71], v31, s[28:31], s7 offen
    s_mov_b32 s7, 131072
    buffer_load_dwordx4 v[72:75], v30, s[28:31], s7 offen
    buffer_load_dwordx4 v[76:79], v31, s[28:31], s7 offen
    s_mov_b32 s7, 16384
    buffer_load_dwordx4 v[80:83], v30, s[28:31], s7 offen
    buffer_load_dwordx4 v[84:87], v31, s[28:31], s7 offen
    s_mov_b32 s7, 147456
    buffer_load_dwordx4 v[88:91], v30, s[28:31], s7 offen
    buffer_load_dwordx4 v[92:95], v31, s[28:31], s7 offen
    s_mov_b32 s7, 524288
    buffer_load_dwordx4 v[96:99], v30, s[28:31], s7 offen
    buffer_load_dwordx4 v[100:103], v31, s[28:31], s7 offen
    s_mov_b32 s7, 655360
    buffer_load_dwordx4 v[104:107], v30, s[28:31], s7 offen
    buffer_load_dwordx4 v[108:111], v31, s[28:31], s7 offen
    s_mov_b32 s7, 540672
    buffer_load_dwordx4 v[112:115], v30, s[28:31], s7 offen
    buffer_load_dwordx4 v[116:119], v31, s[28:31], s7 offen
    s_mov_b32 s7, 671744
    buffer_load_dwordx4 v[120:123], v30, s[28:31], s7 offen
    buffer_load_dwordx4 v[124:127], v31, s[28:31], s7 offen
    s_waitcnt vmcnt(14)
    v_perm_b32 v32, v68, v64, s40
    v_perm_b32 v36, v68, v64, s41
    v_perm_b32 v40, v69, v65, s40
    v_perm_b32 v44, v69, v65, s41
    v_perm_b32 v48, v70, v66, s40
    v_perm_b32 v52, v70, v66, s41
    v_perm_b32 v56, v71, v67, s40
    v_perm_b32 v60, v71, v67, s41
    s_mov_b32 s7, 32768
    buffer_load_dwordx4 v[64:67], v30, s[28:31], s7 offen
    buffer_load_dwordx4 v[68:71], v31, s[28:31], s7 offen
    s_barrier
    s_cmp_lg_u32 s3, 0
    s_cbranch_scc1 IA_11
    v_mov_b32 v27, 1
    s_mov_b64 exec, 1
    buffer_atomic_add v27, off, s[16:19], 0 offset:64
    s_mov_b64 exec, -1
IA_11:
    s_waitcnt vmcnt(14)
    v_perm_b32 v33, v76, v72, s40
    v_perm_b32 v37, v76, v72, s41
    v_perm_b32 v41, v77, v73, s40
    v_perm_b32 v45, v77, v73, s41
    v_perm_b32 v49, v78, v74, s40
    v_perm_b32 v53, v78, v74, s41
    v_perm_b32 v57, v79, v75, s40
    v_perm_b32 v61, v79, v75, s41
    s_mov_b32 s7, 163840
    buffer_load_dwordx4 v[72:75], v30, s[28:31], s7 offen
    buffer_load_dwordx4 v[76:79], v31, s[28:31], s7 offen
    s_waitcnt vmcnt(14)
    v_perm_b32 v34, v84, v80, s40
    v_perm_b32 v38, v84, v80, s41
    v_perm_b32 v42, v85, v81, s40
    v_perm_b32 v46, v85, v81, s41
    v_perm_b32 v50, v86, v82, s40
    v_perm_b32 v54, v86, v82, s41
    v_perm_b32 v58, v87, v83, s40
    v_perm_b32 v62, v87, v83, s41
    s_mov_b32 s7, 49152
    buffer_load_dwordx4 v[80:83], v30, s[28:31], s7 offen
    buffer_load_dwordx4 v[84:87], v31, s[28:31], s7 offen
    s_waitcnt vmcnt(14)
    v_perm_b32 v35, v92, v88, s40
    v_perm_b32 v39, v92, v88, s41
    v_perm_b32 v43, v93, v89, s40
    v_perm_b32 v47, v93, v89, s41
    v_perm_b32 v51, v94, v90, s40
    v_perm_b32 v55, v94, v90, s41
    v_perm_b32 v59, v95, v91, s40
    v_perm_b32 v63, v95, v91, s41
    s_mov_b32 s7, 180224
    buffer_load_dwordx4 v[88:91], v30, s[28:31], s7 offen
    buffer_load_dwordx4 v[92:95], v31, s[28:31], s7 offen
    ds_write_b128 v16, v[32:35] offset:0
    ds_write_b128 v16, v[36:39] offset:2048
    ds_write_b128 v16, v[40:43] offset:16
    ds_write_b128 v16, v[44:47] offset:2064
    ds_write_b128 v16, v[48:51] offset:32
    ds_write_b128 v16, v[52:55] offset:2080
    ds_write_b128 v16, v[56:59] offset:48
    ds_write_b128 v16, v[60:63] offset:2096
    s_waitcnt vmcnt(14)
    v_perm_b32 v32, v100, v96, s40
    v_perm_b32 v36, v100, v96, s41
    v_perm_b32 v40, v101, v97, s40
    v_perm_b32 v44, v101, v97, s41
    v_perm_b32 v48, v102, v98, s40
    v_perm_b32 v52, v102, v98, s41
    v_perm_b32 v56, v103, v99, s40
    v_perm_b32 v60, v103, v99, s41
    s_mov_b32 s7, 557056
    buffer_load_dwordx4 v[96:99], v30, s[28:31], s7 offen
    buffer_load_dwordx4 v[100:103], v31, s[28:31], s7 offen
    s_waitcnt vmcnt(14)
    v_perm_b32 v33, v108, v104, s40
    v_perm_b32 v37, v108, v104, s41
    v_perm_b32 v41, v109, v105, s40
    v_perm_b32 v45, v109, v105, s41
    v_perm_b32 v49, v110, v106, s40
    v_perm_b32 v53, v110, v106, s41
    v_perm_b32 v57, v111, v107, s40
    v_perm_b32 v61, v111, v107, s41
    s_mov_b32 s7, 688128
    buffer_load_dwordx4 v[104:107], v30, s[28:31], s7 offen
    buffer_load_dwordx4 v[108:111], v31, s[28:31], s7 offen
    s_waitcnt vmcnt(14)
    v_perm_b32 v34, v116, v112, s40
    v_perm_b32 v38, v116, v112, s41
    v_perm_b32 v42, v117, v113, s40
    v_perm_b32 v46, v117, v113, s41
    v_perm_b32 v50, v118, v114, s40
    v_perm_b32 v54, v118, v114, s41
    v_perm_b32 v58, v119, v115, s40
    v_perm_b32 v62, v119, v115, s41
    s_mov_b32 s7, 573440
    buffer_load_dwordx4 v[112:115], v30, s[28:31], s7 offen
    buffer_load_dwordx4 v[116:119], v31, s[28:31], s7 offen
    s_waitcnt vmcnt(14)
    v_perm_b32 v35, v124, v120, s40
    v_perm_b32 v39, v124, v120, s41
    v_perm_b32 v43, v125, v121, s40
    v_perm_b32 v47, v125, v121, s41
    v_perm_b32 v51, v126, v122, s40
    v_perm_b32 v55, v126, v122, s41
    v_perm_b32 v59, v127, v123, s40
    v_perm_b32 v63, v127, v123, s41
    s_mov_b32 s7, 704512
    buffer_load_dwordx4 v[120:123], v30, s[28:31], s7 offen
    buffer_load_dwordx4 v[124:127], v31, s[28:31], s7 offen
    ds_write_b128 v16, v[32:35] offset:1024
    ds_write_b128 v16, v[36:39] offset:3072
    ds_write_b128 v16, v[40:43] offset:1040
    ds_write_b128 v16, v[44:47] offset:3088
    ds_write_b128 v16, v[48:51] offset:1056
    ds_write_b128 v16, v[52:55] offset:3104
    ds_write_b128 v16, v[56:59] offset:1072
    ds_write_b128 v16, v[60:63] offset:3120
    s_waitcnt vmcnt(14)
    v_perm_b32 v32, v68, v64, s40
    v_perm_b32 v36, v68, v64, s41
    v_perm_b32 v40, v69, v65, s40
    v_perm_b32 v44, v69, v65, s41
    v_perm_b32 v48, v70, v66, s40
    v_perm_b32 v52, v70, v66, s41
    v_perm_b32 v56, v71, v67, s40
    v_perm_b32 v60, v71, v67, s41
    s_mov_b32 s7, 0
    buffer_load_dwordx4 v[64:67], v30, s[24:27], s7 offen
    buffer_load_dwordx4 v[68:71], v31, s[24:27], s7 offen
    s_waitcnt vmcnt(14)
    v_perm_b32 v33, v76, v72, s40
    v_perm_b32 v37, v76, v72, s41
    v_perm_b32 v41, v77, v73, s40
    v_perm_b32 v45, v77, v73, s41
    v_perm_b32 v49, v78, v74, s40
    v_perm_b32 v53, v78, v74, s41
    v_perm_b32 v57, v79, v75, s40
    v_perm_b32 v61, v79, v75, s41
    s_mov_b32 s7, 131072
    buffer_load_dwordx4 v[72:75], v30, s[24:27], s7 offen
    buffer_load_dwordx4 v[76:79], v31, s[24:27], s7 offen
    s_waitcnt vmcnt(14)
    v_perm_b32 v34, v84, v80, s40
    v_perm_b32 v38, v84, v80, s41
    v_perm_b32 v42, v85, v81, s40
    v_perm_b32 v46, v85, v81, s41
    v_perm_b32 v50, v86, v82, s40
    v_perm_b32 v54, v86, v82, s41
    v_perm_b32 v58, v87, v83, s40
    v_perm_b32 v62, v87, v83, s41
    s_mov_b32 s7, 16384
    buffer_load_dwordx4 v[80:83], v30, s[24:27], s7 offen
    buffer_load_dwordx4 v[84:87], v31, s[24:27], s7 offen
    s_waitcnt vmcnt(14)
    v_perm_b32 v35, v92, v88, s40
    v_perm_b32 v39, v92, v88, s41
    v_perm_b32 v43, v93, v89, s40
    v_perm_b32 v47, v93, v89, s41
    v_perm_b32 v51, v94, v90, s40
    v_perm_b32 v55, v94, v90, s41
    v_perm_b32 v59, v95, v91, s40
    v_perm_b32 v63, v95, v91, s41
    s_mov_b32 s7, 147456
    buffer_load_dwordx4 v[88:91], v30, s[24:27], s7 offen
    buffer_load_dwordx4 v[92:95], v31, s[24:27], s7 offen
    ds_write_b128 v16, v[32:35] offset:16384
    ds_write_b128 v16, v[36:39] offset:18432
    ds_write_b128 v16, v[40:43] offset:16400
    ds_write_b128 v16, v[44:47] offset:18448
    ds_write_b128 v16, v[48:51] offset:16416
    ds_write_b128 v16, v[52:55] offset:18464
    ds_write_b128 v16, v[56:59] offset:16432
    ds_write_b128 v16, v[60:63] offset:18480
    s_waitcnt vmcnt(14)
    v_perm_b32 v32, v100, v96, s40
    v_perm_b32 v36, v100, v96, s41
    v_perm_b32 v40, v101, v97, s40
    v_perm_b32 v44, v101, v97, s41
    v_perm_b32 v48, v102, v98, s40
    v_perm_b32 v52, v102, v98, s41
    v_perm_b32 v56, v103, v99, s40
    v_perm_b32 v60, v103, v99, s41
    s_mov_b32 s7, 524288
    buffer_load_dwordx4 v[96:99], v30, s[24:27], s7 offen
    buffer_load_dwordx4 v[100:103], v31, s[24:27], s7 offen
    s_waitcnt vmcnt(14)
    v_perm_b32 v33, v108, v104, s40
    v_perm_b32 v37, v108, v104, s41
    v_perm_b32 v41, v109, v105, s40
    v_perm_b32 v45, v109, v105, s41
    v_perm_b32 v49, v110, v106, s40
    v_perm_b32 v53, v110, v106, s41
    v_perm_b32 v57, v111, v107, s40
    v_perm_b32 v61, v111, v107, s41
    s_mov_b32 s7, 655360
    buffer_load_dwordx4 v[104:107], v30, s[24:27], s7 offen
    buffer_load_dwordx4 v[108:111], v31, s[24:27], s7 offen
    s_waitcnt vmcnt(14)
    v_perm_b32 v34, v116, v112, s40
    v_perm_b32 v38, v116, v112, s41
    v_perm_b32 v42, v117, v113, s40
    v_perm_b32 v46, v117, v113, s41
    v_perm_b32 v50, v118, v114, s40
    v_perm_b32 v54, v118, v114, s41
    v_perm_b32 v58, v119, v115, s40
    v_perm_b32 v62, v119, v115, s41
    s_mov_b32 s7, 540672
    buffer_load_dwordx4 v[112:115], v30, s[24:27], s7 offen
    buffer_load_dwordx4 v[116:119], v31, s[24:27], s7 offen
    s_waitcnt vmcnt(14)
    v_perm_b32 v35, v124, v120, s40
    v_perm_b32 v39, v124, v120, s41
    v_perm_b32 v43, v125, v121, s40
    v_perm_b32 v47, v125, v121, s41
    v_perm_b32 v51, v126, v122, s40
    v_perm_b32 v55, v126, v122, s41
    v_perm_b32 v59, v127, v123, s40
    v_perm_b32 v63, v127, v123, s41
    s_mov_b32 s7, 671744
    buffer_load_dwordx4 v[120:123], v30, s[24:27], s7 offen
    buffer_load_dwordx4 v[124:127], v31, s[24:27], s7 offen
    ds_write_b128 v16, v[32:35] offset:17408
    ds_write_b128 v16, v[36:39] offset:19456
    ds_write_b128 v16, v[40:43] offset:17424
    ds_write_b128 v16, v[44:47] offset:19472
    ds_write_b128 v16, v[48:51] offset:17440
    ds_write_b128 v16, v[52:55] offset:19488
    ds_write_b128 v16, v[56:59] offset:17456
    ds_write_b128 v16, v[60:63] offset:19504
    s_waitcnt lgkmcnt(0)
    s_barrier
    ds_read_b128 a[0:3], v19 offset:0
    ds_read_b128 a[4:7], v19 offset:1024
    ds_read_b128 a[8:11], v19 offset:2048
    ds_read_b128 a[12:15], v19 offset:3072
    ds_read_b128 a[16:19], v19 offset:4096
    ds_read_b128 a[20:23], v19 offset:5120
    ds_read_b128 a[24:27], v19 offset:6144
    ds_read_b128 a[28:31], v19 offset:7168
    ds_read_b128 a[32:35], v19 offset:8192
    ds_read_b128 a[36:39], v19 offset:9216
    ds_read_b128 a[40:43], v19 offset:10240
    ds_read_b128 a[44:47], v19 offset:11264
    ds_read_b128 a[48:51], v19 offset:12288
    ds_read_b128 a[52:55], v19 offset:13312
    ds_read_b128 a[56:59], v19 offset:14336
    ds_read_b128 a[60:63], v19 offset:15360
    ds_read_b128 a[64:67], v19 offset:16384
    ds_read_b128 a[68:71], v19 offset:17408
    ds_read_b128 a[72:75], v19 offset:18432
    ds_read_b128 a[76:79], v19 offset:19456
    ds_read_b128 a[80:83], v19 offset:20480
    ds_read_b128 a[84:87], v19 offset:21504
    ds_read_b128 a[88:91], v19 offset:22528
    ds_read_b128 a[92:95], v19 offset:23552
    ds_read_b128 a[96:99], v19 offset:24576
    ds_read_b128 a[100:103], v19 offset:25600
    ds_read_b128 a[104:107], v19 offset:26624
    ds_read_b128 a[108:111], v19 offset:27648
    ds_read_b128 a[112:115], v19 offset:28672
    ds_read_b128 a[116:119], v19 offset:29696
    ds_read_b128 a[120:123], v19 offset:30720
    ds_read_b128 a[124:127], v19 offset:31744
    s_waitcnt lgkmcnt(0)
    s_barrier
    s_waitcnt vmcnt(14)
    v_perm_b32 v32, v68, v64, s40
    v_perm_b32 v36, v68, v64, s41
    v_perm_b32 v40, v69, v65, s40
    v_perm_b32 v44, v69, v65, s41
    v_perm_b32 v48, v70, v66, s40
    v_perm_b32 v52, v70, v66, s41
    v_perm_b32 v56, v71, v67, s40
    v_perm_b32 v60, v71, v67, s41
    s_mov_b32 s7, 32768
    buffer_load_dwordx4 v[64:67], v30, s[24:27], s7 offen
    buffer_load_dwordx4 v[68:71], v31, s[24:27], s7 offen
    s_waitcnt vmcnt(14)
    v_perm_b32 v33, v76, v72, s40
    v_perm_b32 v37, v76, v72, s41
    v_perm_b32 v41, v77, v73, s40
    v_perm_b32 v45, v77, v73, s41
    v_perm_b32 v49, v78, v74, s40
    v_perm_b32 v53, v78, v74, s41
    v_perm_b32 v57, v79, v75, s40
    v_perm_b32 v61, v79, v75, s41
    s_mov_b32 s7, 163840
    buffer_load_dwordx4 v[72:75], v30, s[24:27], s7 offen
    buffer_load_dwordx4 v[76:79], v31, s[24:27], s7 offen
    s_waitcnt vmcnt(14)
    v_perm_b32 v34, v84, v80, s40
    v_perm_b32 v38, v84, v80, s41
    v_perm_b32 v42, v85, v81, s40
    v_perm_b32 v46, v85, v81, s41
    v_perm_b32 v50, v86, v82, s40
    v_perm_b32 v54, v86, v82, s41
    v_perm_b32 v58, v87, v83, s40
    v_perm_b32 v62, v87, v83, s41
    s_mov_b32 s7, 49152
    buffer_load_dwordx4 v[80:83], v30, s[24:27], s7 offen
    buffer_load_dwordx4 v[84:87], v31, s[24:27], s7 offen
    s_waitcnt vmcnt(14)
    v_perm_b32 v35, v92, v88, s40
    v_perm_b32 v39, v92, v88, s41
    v_perm_b32 v43, v93, v89, s40
    v_perm_b32 v47, v93, v89, s41
    v_perm_b32 v51, v94, v90, s40
    v_perm_b32 v55, v94, v90, s41
    v_perm_b32 v59, v95, v91, s40
    v_perm_b32 v63, v95, v91, s41
    s_mov_b32 s7, 180224
    buffer_load_dwordx4 v[88:91], v30, s[24:27], s7 offen
    buffer_load_dwordx4 v[92:95], v31, s[24:27], s7 offen
    ds_write_b128 v16, v[32:35] offset:0
    ds_write_b128 v16, v[36:39] offset:2048
    ds_write_b128 v16, v[40:43] offset:16
    ds_write_b128 v16, v[44:47] offset:2064
    ds_write_b128 v16, v[48:51] offset:32
    ds_write_b128 v16, v[52:55] offset:2080
    ds_write_b128 v16, v[56:59] offset:48
    ds_write_b128 v16, v[60:63] offset:2096
    s_waitcnt vmcnt(14)
    v_perm_b32 v32, v100, v96, s40
    v_perm_b32 v36, v100, v96, s41
    v_perm_b32 v40, v101, v97, s40
    v_perm_b32 v44, v101, v97, s41
    v_perm_b32 v48, v102, v98, s40
    v_perm_b32 v52, v102, v98, s41
    v_perm_b32 v56, v103, v99, s40
    v_perm_b32 v60, v103, v99, s41
    s_mov_b32 s7, 557056
    buffer_load_dwordx4 v[96:99], v30, s[24:27], s7 offen
    buffer_load_dwordx4 v[100:103], v31, s[24:27], s7 offen
    s_waitcnt vmcnt(14)
    v_perm_b32 v33, v108, v104, s40
    v_perm_b32 v37, v108, v104, s41
    v_perm_b32 v41, v109, v105, s40
    v_perm_b32 v45, v109, v105, s41
    v_perm_b32 v49, v110, v106, s40
    v_perm_b32 v53, v110, v106, s41
    v_perm_b32 v57, v111, v107, s40
    v_perm_b32 v61, v111, v107, s41
    s_mov_b32 s7, 688128
    buffer_load_dwordx4 v[104:107], v30, s[24:27], s7 offen
    buffer_load_dwordx4 v[108:111], v31, s[24:27], s7 offen
    s_waitcnt vmcnt(14)
    v_perm_b32 v34, v116, v112, s40
    v_perm_b32 v38, v116, v112, s41
    v_perm_b32 v42, v117, v113, s40
    v_perm_b32 v46, v117, v113, s41
    v_perm_b32 v50, v118, v114, s40
    v_perm_b32 v54, v118, v114, s41
    v_perm_b32 v58, v119, v115, s40
    v_perm_b32 v62, v119, v115, s41
    s_mov_b32 s7, 573440
    buffer_load_dwordx4 v[112:115], v30, s[24:27], s7 offen
    buffer_load_dwordx4 v[116:119], v31, s[24:27], s7 offen
    s_waitcnt vmcnt(14)
    v_perm_b32 v35, v124, v120, s40
    v_perm_b32 v39, v124, v120, s41
    v_perm_b32 v43, v125, v121, s40
    v_perm_b32 v47, v125, v121, s41
    v_perm_b32 v51, v126, v122, s40
    v_perm_b32 v55, v126, v122, s41
    v_perm_b32 v59, v127, v123, s40
    v_perm_b32 v63, v127, v123, s41
    s_mov_b32 s7, 704512
    buffer_load_dwordx4 v[120:123], v30, s[24:27], s7 offen
    buffer_load_dwordx4 v[124:127], v31, s[24:27], s7 offen
    ds_write_b128 v16, v[32:35] offset:1024
    ds_write_b128 v16, v[36:39] offset:3072
    ds_write_b128 v16, v[40:43] offset:1040
    ds_write_b128 v16, v[44:47] offset:3088
    ds_write_b128 v16, v[48:51] offset:1056
    ds_write_b128 v16, v[52:55] offset:3104
    ds_write_b128 v16, v[56:59] offset:1072
    ds_write_b128 v16, v[60:63] offset:3120
    s_waitcnt vmcnt(14)
    v_perm_b32 v32, v68, v64, s40
    v_perm_b32 v36, v68, v64, s41
    v_perm_b32 v40, v69, v65, s40
    v_perm_b32 v44, v69, v65, s41
    v_perm_b32 v48, v70, v66, s40
    v_perm_b32 v52, v70, v66, s41
    v_perm_b32 v56, v71, v67, s40
    v_perm_b32 v60, v71, v67, s41
    s_mov_b32 s7, 0
    buffer_load_dwordx4 v[64:67], v30, s[32:35], s7 offen
    buffer_load_dwordx4 v[68:71], v31, s[32:35], s7 offen
    s_waitcnt vmcnt(14)
    v_perm_b32 v33, v76, v72, s40
    v_perm_b32 v37, v76, v72, s41
    v_perm_b32 v41, v77, v73, s40
    v_perm_b32 v45, v77, v73, s41
    v_perm_b32 v49, v78, v74, s40
    v_perm_b32 v53, v78, v74, s41
    v_perm_b32 v57, v79, v75, s40
    v_perm_b32 v61, v79, v75, s41
    s_mov_b32 s7, 131072
    buffer_load_dwordx4 v[72:75], v30, s[32:35], s7 offen
    buffer_load_dwordx4 v[76:79], v31, s[32:35], s7 offen
    s_waitcnt vmcnt(14)
    v_perm_b32 v34, v84, v80, s40
    v_perm_b32 v38, v84, v80, s41
    v_perm_b32 v42, v85, v81, s40
    v_perm_b32 v46, v85, v81, s41
    v_perm_b32 v50, v86, v82, s40
    v_perm_b32 v54, v86, v82, s41
    v_perm_b32 v58, v87, v83, s40
    v_perm_b32 v62, v87, v83, s41
    s_mov_b32 s7, 16384
    buffer_load_dwordx4 v[80:83], v30, s[32:35], s7 offen
    buffer_load_dwordx4 v[84:87], v31, s[32:35], s7 offen
    s_waitcnt vmcnt(14)
    v_perm_b32 v35, v92, v88, s40
    v_perm_b32 v39, v92, v88, s41
    v_perm_b32 v43, v93, v89, s40
    v_perm_b32 v47, v93, v89, s41
    v_perm_b32 v51, v94, v90, s40
    v_perm_b32 v55, v94, v90, s41
    v_perm_b32 v59, v95, v91, s40
    v_perm_b32 v63, v95, v91, s41
    s_mov_b32 s7, 147456
    buffer_load_dwordx4 v[88:91], v30, s[32:35], s7 offen
    buffer_load_dwordx4 v[92:95], v31, s[32:35], s7 offen
    ds_write_b128 v16, v[32:35] offset:16384
    ds_write_b128 v16, v[36:39] offset:18432
    ds_write_b128 v16, v[40:43] offset:16400
    ds_write_b128 v16, v[44:47] offset:18448
    ds_write_b128 v16, v[48:51] offset:16416
    ds_write_b128 v16, v[52:55] offset:18464
    ds_write_b128 v16, v[56:59] offset:16432
    ds_write_b128 v16, v[60:63] offset:18480
    s_waitcnt vmcnt(14)
    v_perm_b32 v32, v100, v96, s40
    v_perm_b32 v36, v100, v96, s41
    v_perm_b32 v40, v101, v97, s40
    v_perm_b32 v44, v101, v97, s41
    v_perm_b32 v48, v102, v98, s40
    v_perm_b32 v52, v102, v98, s41
    v_perm_b32 v56, v103, v99, s40
    v_perm_b32 v60, v103, v99, s41
    s_mov_b32 s7, 524288
    buffer_load_dwordx4 v[96:99], v30, s[32:35], s7 offen
    buffer_load_dwordx4 v[100:103], v31, s[32:35], s7 offen
    s_waitcnt vmcnt(14)
    v_perm_b32 v33, v108, v104, s40
    v_perm_b32 v37, v108, v104, s41
    v_perm_b32 v41, v109, v105, s40
    v_perm_b32 v45, v109, v105, s41
    v_perm_b32 v49, v110, v106, s40
    v_perm_b32 v53, v110, v106, s41
    v_perm_b32 v57, v111, v107, s40
    v_perm_b32 v61, v111, v107, s41
    s_mov_b32 s7, 655360
    buffer_load_dwordx4 v[104:107], v30, s[32:35], s7 offen
    buffer_load_dwordx4 v[108:111], v31, s[32:35], s7 offen
    s_waitcnt vmcnt(14)
    v_perm_b32 v34, v116, v112, s40
    v_perm_b32 v38, v116, v112, s41
    v_perm_b32 v42, v117, v113, s40
    v_perm_b32 v46, v117, v113, s41
    v_perm_b32 v50, v118, v114, s40
    v_perm_b32 v54, v118, v114, s41
    v_perm_b32 v58, v119, v115, s40
    v_perm_b32 v62, v119, v115, s41
    s_mov_b32 s7, 540672
    buffer_load_dwordx4 v[112:115], v30, s[32:35], s7 offen
    buffer_load_dwordx4 v[116:119], v31, s[32:35], s7 offen
    s_waitcnt vmcnt(14)
    v_perm_b32 v35, v124, v120, s40
    v_perm_b32 v39, v124, v120, s41
    v_perm_b32 v43, v125, v121, s40
    v_perm_b32 v47, v125, v121, s41
    v_perm_b32 v51, v126, v122, s40
    v_perm_b32 v55, v126, v122, s41
    v_perm_b32 v59, v127, v123, s40
    v_perm_b32 v63, v127, v123, s41
    s_mov_b32 s7, 671744
    buffer_load_dwordx4 v[120:123], v30, s[32:35], s7 offen
    buffer_load_dwordx4 v[124:127], v31, s[32:35], s7 offen
    ds_write_b128 v16, v[32:35] offset:17408
    ds_write_b128 v16, v[36:39] offset:19456
    ds_write_b128 v16, v[40:43] offset:17424
    ds_write_b128 v16, v[44:47] offset:19472
    ds_write_b128 v16, v[48:51] offset:17440
    ds_write_b128 v16, v[52:55] offset:19488
    ds_write_b128 v16, v[56:59] offset:17456
    ds_write_b128 v16, v[60:63] offset:19504
    s_waitcnt lgkmcnt(0)
    s_barrier
    ds_read_b128 v[128:131], v19 offset:0
    ds_read_b128 v[132:135], v19 offset:1024
    ds_read_b128 v[136:139], v19 offset:2048
    ds_read_b128 v[140:143], v19 offset:3072
    ds_read_b128 v[144:147], v19 offset:4096
    ds_read_b128 v[148:151], v19 offset:5120
    ds_read_b128 v[152:155], v19 offset:6144
    ds_read_b128 v[156:159], v19 offset:7168
    ds_read_b128 v[160:163], v19 offset:8192
    ds_read_b128 v[164:167], v19 offset:9216
    ds_read_b128 v[168:171], v19 offset:10240
    ds_read_b128 v[172:175], v19 offset:11264
    ds_read_b128 v[176:179], v19 offset:12288
    ds_read_b128 v[180:183], v19 offset:13312
    ds_read_b128 v[184:187], v19 offset:14336
    ds_read_b128 v[188:191], v19 offset:15360
    ds_read_b128 v[192:195], v19 offset:16384
    ds_read_b128 v[196:199], v19 offset:17408
    ds_read_b128 v[200:203], v19 offset:18432
    ds_read_b128 v[204:207], v19 offset:19456
    ds_read_b128 v[208:211], v19 offset:20480
    ds_read_b128 v[212:215], v19 offset:21504
    ds_read_b128 v[216:219], v19 offset:22528
    ds_read_b128 v[220:223], v19 offset:23552
    ds_read_b128 v[224:227], v19 offset:24576
    ds_read_b128 v[228:231], v19 offset:25600
    ds_read_b128 v[232:235], v19 offset:26624
    ds_read_b128 v[236:239], v19 offset:27648
    ds_read_b128 v[240:243], v19 offset:28672
    ds_read_b128 v[244:247], v19 offset:29696
    ds_read_b128 v[248:251], v19 offset:30720
    ds_read_b128 v[252:255], v19 offset:31744
    s_waitcnt lgkmcnt(0)
    s_barrier
    s_waitcnt vmcnt(14)
    v_perm_b32 v32, v68, v64, s40
    v_perm_b32 v36, v68, v64, s41
    v_perm_b32 v40, v69, v65, s40
    v_perm_b32 v44, v69, v65, s41
    v_perm_b32 v48, v70, v66, s40
    v_perm_b32 v52, v70, v66, s41
    v_perm_b32 v56, v71, v67, s40
    v_perm_b32 v60, v71, v67, s41
    s_mov_b32 s7, 32768
    buffer_load_dwordx4 v[64:67], v30, s[32:35], s7 offen
    buffer_load_dwordx4 v[68:71], v31, s[32:35], s7 offen
    s_waitcnt vmcnt(14)
    v_perm_b32 v33, v76, v72, s40
    v_perm_b32 v37, v76, v72, s41
    v_perm_b32 v41, v77, v73, s40
    v_perm_b32 v45, v77, v73, s41
    v_perm_b32 v49, v78, v74, s40
    v_perm_b32 v53, v78, v74, s41
    v_perm_b32 v57, v79, v75, s40
    v_perm_b32 v61, v79, v75, s41
    s_mov_b32 s7, 163840
    buffer_load_dwordx4 v[72:75], v30, s[32:35], s7 offen
    buffer_load_dwordx4 v[76:79], v31, s[32:35], s7 offen
    s_waitcnt vmcnt(14)
    v_perm_b32 v34, v84, v80, s40
    v_perm_b32 v38, v84, v80, s41
    v_perm_b32 v42, v85, v81, s40
    v_perm_b32 v46, v85, v81, s41
    v_perm_b32 v50, v86, v82, s40
    v_perm_b32 v54, v86, v82, s41
    v_perm_b32 v58, v87, v83, s40
    v_perm_b32 v62, v87, v83, s41
    s_mov_b32 s7, 49152
    buffer_load_dwordx4 v[80:83], v30, s[32:35], s7 offen
    buffer_load_dwordx4 v[84:87], v31, s[32:35], s7 offen
    s_waitcnt vmcnt(14)
    v_perm_b32 v35, v92, v88, s40
    v_perm_b32 v39, v92, v88, s41
    v_perm_b32 v43, v93, v89, s40
    v_perm_b32 v47, v93, v89, s41
    v_perm_b32 v51, v94, v90, s40
    v_perm_b32 v55, v94, v90, s41
    v_perm_b32 v59, v95, v91, s40
    v_perm_b32 v63, v95, v91, s41
    s_mov_b32 s7, 180224
    buffer_load_dwordx4 v[88:91], v30, s[32:35], s7 offen
    buffer_load_dwordx4 v[92:95], v31, s[32:35], s7 offen
    ds_write_b128 v17, v[32:35] offset:0
    ds_write_b128 v17, v[36:39] offset:2048
    ds_write_b128 v17, v[40:43] offset:16
    ds_write_b128 v17, v[44:47] offset:2064
    ds_write_b128 v17, v[48:51] offset:32
    ds_write_b128 v17, v[52:55] offset:2080
    ds_write_b128 v17, v[56:59] offset:48
    ds_write_b128 v17, v[60:63] offset:2096
    s_waitcnt vmcnt(14)
    v_perm_b32 v32, v100, v96, s40
    v_perm_b32 v36, v100, v96, s41
    v_perm_b32 v40, v101, v97, s40
    v_perm_b32 v44, v101, v97, s41
    v_perm_b32 v48, v102, v98, s40
    v_perm_b32 v52, v102, v98, s41
    v_perm_b32 v56, v103, v99, s40
    v_perm_b32 v60, v103, v99, s41
    s_mov_b32 s7, 557056
    buffer_load_dwordx4 v[96:99], v30, s[32:35], s7 offen
    buffer_load_dwordx4 v[100:103], v31, s[32:35], s7 offen
    s_waitcnt vmcnt(14)
    v_perm_b32 v33, v108, v104, s40
    v_perm_b32 v37, v108, v104, s41
    v_perm_b32 v41, v109, v105, s40
    v_perm_b32 v45, v109, v105, s41
    v_perm_b32 v49, v110, v106, s40
    v_perm_b32 v53, v110, v106, s41
    v_perm_b32 v57, v111, v107, s40
    v_perm_b32 v61, v111, v107, s41
    s_mov_b32 s7, 688128
    buffer_load_dwordx4 v[104:107], v30, s[32:35], s7 offen
    buffer_load_dwordx4 v[108:111], v31, s[32:35], s7 offen
    s_waitcnt vmcnt(14)
    v_perm_b32 v34, v116, v112, s40
    v_perm_b32 v38, v116, v112, s41
    v_perm_b32 v42, v117, v113, s40
    v_perm_b32 v46, v117, v113, s41
    v_perm_b32 v50, v118, v114, s40
    v_perm_b32 v54, v118, v114, s41
    v_perm_b32 v58, v119, v115, s40
    v_perm_b32 v62, v119, v115, s41
    s_mov_b32 s7, 573440
    buffer_load_dwordx4 v[112:115], v30, s[32:35], s7 offen
    buffer_load_dwordx4 v[116:119], v31, s[32:35], s7 offen
    s_waitcnt vmcnt(14)
    v_perm_b32 v35, v124, v120, s40
    v_perm_b32 v39, v124, v120, s41
    v_perm_b32 v43, v125, v121, s40
    v_perm_b32 v47, v125, v121, s41
    v_perm_b32 v51, v126, v122, s40
    v_perm_b32 v55, v126, v122, s41
    v_perm_b32 v59, v127, v123, s40
    v_perm_b32 v63, v127, v123, s41
    s_mov_b32 s7, 704512
    buffer_load_dwordx4 v[120:123], v30, s[32:35], s7 offen
    buffer_load_dwordx4 v[124:127], v31, s[32:35], s7 offen
    ds_write_b128 v17, v[32:35] offset:1024
    ds_write_b128 v17, v[36:39] offset:3072
    ds_write_b128 v17, v[40:43] offset:1040
    ds_write_b128 v17, v[44:47] offset:3088
    ds_write_b128 v17, v[48:51] offset:1056
    ds_write_b128 v17, v[52:55] offset:3104
    ds_write_b128 v17, v[56:59] offset:1072
    ds_write_b128 v17, v[60:63] offset:3120
    s_waitcnt vmcnt(14)
    v_perm_b32 v32, v68, v64, s40
    v_perm_b32 v36, v68, v64, s41
    v_perm_b32 v40, v69, v65, s40
    v_perm_b32 v44, v69, v65, s41
    v_perm_b32 v48, v70, v66, s40
    v_perm_b32 v52, v70, v66, s41
    v_perm_b32 v56, v71, v67, s40
    v_perm_b32 v60, v71, v67, s41
    s_mov_b32 s7, 0
    buffer_load_dwordx4 v[64:67], v11, s[36:39], s7 offen
    buffer_load_dwordx4 v[68:71], v11, s[36:39], s7 offen offset:1024
    s_waitcnt vmcnt(14)
    v_perm_b32 v33, v76, v72, s40
    v_perm_b32 v37, v76, v72, s41
    v_perm_b32 v41, v77, v73, s40
    v_perm_b32 v45, v77, v73, s41
    v_perm_b32 v49, v78, v74, s40
    v_perm_b32 v53, v78, v74, s41
    v_perm_b32 v57, v79, v75, s40
    v_perm_b32 v61, v79, v75, s41
    s_mov_b32 s7, 8192
    buffer_load_dwordx4 v[72:75], v11, s[36:39], s7 offen
    buffer_load_dwordx4 v[76:79], v11, s[36:39], s7 offen offset:1024
    s_waitcnt vmcnt(14)
    v_perm_b32 v34, v84, v80, s40
    v_perm_b32 v38, v84, v80, s41
    v_perm_b32 v42, v85, v81, s40
    v_perm_b32 v46, v85, v81, s41
    v_perm_b32 v50, v86, v82, s40
    v_perm_b32 v54, v86, v82, s41
    v_perm_b32 v58, v87, v83, s40
    v_perm_b32 v62, v87, v83, s41
    s_mov_b32 s7, 2048
    buffer_load_dwordx4 v[80:83], v11, s[36:39], s7 offen
    buffer_load_dwordx4 v[84:87], v11, s[36:39], s7 offen offset:1024
    s_waitcnt vmcnt(14)
    v_perm_b32 v35, v92, v88, s40
    v_perm_b32 v39, v92, v88, s41
    v_perm_b32 v43, v93, v89, s40
    v_perm_b32 v47, v93, v89, s41
    v_perm_b32 v51, v94, v90, s40
    v_perm_b32 v55, v94, v90, s41
    v_perm_b32 v59, v95, v91, s40
    v_perm_b32 v63, v95, v91, s41
    s_mov_b32 s7, 10240
    buffer_load_dwordx4 v[88:91], v11, s[36:39], s7 offen
    buffer_load_dwordx4 v[92:95], v11, s[36:39], s7 offen offset:1024
    ds_write_b128 v17, v[32:35] offset:16384
    ds_write_b128 v17, v[36:39] offset:18432
    ds_write_b128 v17, v[40:43] offset:16400
    ds_write_b128 v17, v[44:47] offset:18448
    ds_write_b128 v17, v[48:51] offset:16416
    ds_write_b128 v17, v[52:55] offset:18464
    ds_write_b128 v17, v[56:59] offset:16432
    ds_write_b128 v17, v[60:63] offset:18480
    s_waitcnt vmcnt(14)
    v_perm_b32 v32, v100, v96, s40
    v_perm_b32 v36, v100, v96, s41
    v_perm_b32 v40, v101, v97, s40
    v_perm_b32 v44, v101, v97, s41
    v_perm_b32 v48, v102, v98, s40
    v_perm_b32 v52, v102, v98, s41
    v_perm_b32 v56, v103, v99, s40
    v_perm_b32 v60, v103, v99, s41
    s_mov_b32 s7, 32768
    buffer_load_dwordx4 v[96:99], v11, s[36:39], s7 offen
    buffer_load_dwordx4 v[100:103], v11, s[36:39], s7 offen offset:1024
    s_waitcnt vmcnt(14)
    v_perm_b32 v33, v108, v104, s40
    v_perm_b32 v37, v108, v104, s41
    v_perm_b32 v41, v109, v105, s40
    v_perm_b32 v45, v109, v105, s41
    v_perm_b32 v49, v110, v106, s40
    v_perm_b32 v53, v110, v106, s41
    v_perm_b32 v57, v111, v107, s40
    v_perm_b32 v61, v111, v107, s41
    s_mov_b32 s7, 40960
    buffer_load_dwordx4 v[104:107], v11, s[36:39], s7 offen
    buffer_load_dwordx4 v[108:111], v11, s[36:39], s7 offen offset:1024
    s_waitcnt vmcnt(14)
    v_perm_b32 v34, v116, v112, s40
    v_perm_b32 v38, v116, v112, s41
    v_perm_b32 v42, v117, v113, s40
    v_perm_b32 v46, v117, v113, s41
    v_perm_b32 v50, v118, v114, s40
    v_perm_b32 v54, v118, v114, s41
    v_perm_b32 v58, v119, v115, s40
    v_perm_b32 v62, v119, v115, s41
    s_mov_b32 s7, 34816
    buffer_load_dwordx4 v[112:115], v11, s[36:39], s7 offen
    buffer_load_dwordx4 v[116:119], v11, s[36:39], s7 offen offset:1024
    s_waitcnt vmcnt(14)
    v_perm_b32 v35, v124, v120, s40
    v_perm_b32 v39, v124, v120, s41
    v_perm_b32 v43, v125, v121, s40
    v_perm_b32 v47, v125, v121, s41
    v_perm_b32 v51, v126, v122, s40
    v_perm_b32 v55, v126, v122, s41
    v_perm_b32 v59, v127, v123, s40
    v_perm_b32 v63, v127, v123, s41
    s_mov_b32 s7, 43008
    buffer_load_dwordx4 v[120:123], v11, s[36:39], s7 offen
    buffer_load_dwordx4 v[124:127], v11, s[36:39], s7 offen offset:1024
    ds_write_b128 v17, v[32:35] offset:17408
    ds_write_b128 v17, v[36:39] offset:19456
    ds_write_b128 v17, v[40:43] offset:17424
    ds_write_b128 v17, v[44:47] offset:19472
    ds_write_b128 v17, v[48:51] offset:17440
    ds_write_b128 v17, v[52:55] offset:19488
    ds_write_b128 v17, v[56:59] offset:17456
    ds_write_b128 v17, v[60:63] offset:19504
    s_waitcnt lgkmcnt(0)
    s_barrier
    s_cmp_ge_u32 s3, 2
    s_cbranch_scc1 PV_12
    s_branch PE_13
PV_12:
    ds_read_b128 a[128:131], v18 offset:0
    ds_read_b128 a[132:135], v18 offset:1024
    ds_read_b128 a[136:139], v18 offset:2048
    ds_read_b128 a[140:143], v18 offset:3072
    ds_read_b128 a[144:147], v18 offset:4096
    ds_read_b128 a[148:151], v18 offset:5120
    ds_read_b128 a[152:155], v18 offset:6144
    ds_read_b128 a[156:159], v18 offset:7168
    ds_read_b128 a[160:163], v18 offset:8192
    ds_read_b128 a[164:167], v18 offset:9216
    ds_read_b128 a[168:171], v18 offset:10240
    ds_read_b128 a[172:175], v18 offset:11264
    ds_read_b128 a[176:179], v18 offset:12288
    ds_read_b128 a[180:183], v18 offset:13312
    ds_read_b128 a[184:187], v18 offset:14336
    ds_read_b128 a[188:191], v18 offset:15360
    ds_read_b128 a[192:195], v18 offset:16384
    ds_read_b128 a[196:199], v18 offset:17408
    ds_read_b128 a[200:203], v18 offset:18432
    ds_read_b128 a[204:207], v18 offset:19456
    ds_read_b128 a[208:211], v18 offset:20480
    ds_read_b128 a[212:215], v18 offset:21504
    ds_read_b128 a[216:219], v18 offset:22528
    ds_read_b128 a[220:223], v18 offset:23552
    ds_read_b128 a[224:227], v18 offset:24576
    ds_read_b128 a[228:231], v18 offset:25600
    ds_read_b128 a[232:235], v18 offset:26624
    ds_read_b128 a[236:239], v18 offset:27648
    ds_read_b128 a[240:243], v18 offset:28672
    ds_read_b128 a[244:247], v18 offset:29696
    ds_read_b128 a[248:251], v18 offset:30720
    ds_read_b128 a[252:255], v18 offset:31744
PE_13:
    s_waitcnt lgkmcnt(0)
    s_barrier
    buffer_load_dwordx2 v[20:21], v25, s[20:23], 0 offen offset:0
    buffer_load_dwordx2 v[22:23], v25, s[20:23], 0 offen offset:16
    buffer_load_dwordx2 v[26:27], v25, s[20:23], 0 offen offset:8
    buffer_load_dwordx2 v[28:29], v25, s[20:23], 0 offen offset:24
    buffer_load_dword v16, off, s[16:19], 0 offset:224 sc1
    buffer_load_dword v17, off, s[16:19], 0 sc1
    s_waitcnt vmcnt(20)
    v_perm_b32 v32, v68, v64, s40
    v_perm_b32 v36, v68, v64, s41
    v_perm_b32 v40, v69, v65, s40
    v_perm_b32 v44, v69, v65, s41
    v_perm_b32 v48, v70, v66, s40
    v_perm_b32 v52, v70, v66, s41
    v_perm_b32 v56, v71, v67, s40
    v_perm_b32 v60, v71, v67, s41
    s_mov_b32 s7, 65536
    buffer_load_dwordx4 v[64:67], v11, s[36:39], s7 offen
    buffer_load_dwordx4 v[68:71], v11, s[36:39], s7 offen offset:1024
    s_waitcnt vmcnt(20)
    v_perm_b32 v33, v76, v72, s40
    v_perm_b32 v37, v76, v72, s41
    v_perm_b32 v41, v77, v73, s40
    v_perm_b32 v45, v77, v73, s41
    v_perm_b32 v49, v78, v74, s40
    v_perm_b32 v53, v78, v74, s41
    v_perm_b32 v57, v79, v75, s40
    v_perm_b32 v61, v79, v75, s41
    s_mov_b32 s7, 73728
    buffer_load_dwordx4 v[72:75], v11, s[36:39], s7 offen
    buffer_load_dwordx4 v[76:79], v11, s[36:39], s7 offen offset:1024
    s_waitcnt vmcnt(20)
    v_perm_b32 v34, v84, v80, s40
    v_perm_b32 v38, v84, v80, s41
    v_perm_b32 v42, v85, v81, s40
    v_perm_b32 v46, v85, v81, s41
    v_perm_b32 v50, v86, v82, s40
    v_perm_b32 v54, v86, v82, s41
    v_perm_b32 v58, v87, v83, s40
    v_perm_b32 v62, v87, v83, s41
    s_mov_b32 s7, 67584
    buffer_load_dwordx4 v[80:83], v11, s[36:39], s7 offen
    buffer_load_dwordx4 v[84:87], v11, s[36:39], s7 offen offset:1024
    s_waitcnt vmcnt(20)
    v_perm_b32 v35, v92, v88, s40
    v_perm_b32 v39, v92, v88, s41
    v_perm_b32 v43, v93, v89, s40
    v_perm_b32 v47, v93, v89, s41
    v_perm_b32 v51, v94, v90, s40
    v_perm_b32 v55, v94, v90, s41
    v_perm_b32 v59, v95, v91, s40
    v_perm_b32 v63, v95, v91, s41
    s_mov_b32 s7, 75776
    buffer_load_dwordx4 v[88:91], v11, s[36:39], s7 offen
    buffer_load_dwordx4 v[92:95], v11, s[36:39], s7 offen offset:1024
    s_cmp_ge_u32 s3, 2
    s_cbranch_scc1 OV_14
    v_accvgpr_write_b32 a128, v32
    v_accvgpr_write_b32 a129, v33
    v_accvgpr_write_b32 a130, v34
    v_accvgpr_write_b32 a131, v35
    v_accvgpr_write_b32 a144, v36
    v_accvgpr_write_b32 a145, v37
    v_accvgpr_write_b32 a146, v38
    v_accvgpr_write_b32 a147, v39
    v_accvgpr_write_b32 a160, v40
    v_accvgpr_write_b32 a161, v41
    v_accvgpr_write_b32 a162, v42
    v_accvgpr_write_b32 a163, v43
    v_accvgpr_write_b32 a176, v44
    v_accvgpr_write_b32 a177, v45
    v_accvgpr_write_b32 a178, v46
    v_accvgpr_write_b32 a179, v47
    v_accvgpr_write_b32 a192, v48
    v_accvgpr_write_b32 a193, v49
    v_accvgpr_write_b32 a194, v50
    v_accvgpr_write_b32 a195, v51
    v_accvgpr_write_b32 a208, v52
    v_accvgpr_write_b32 a209, v53
    v_accvgpr_write_b32 a210, v54
    v_accvgpr_write_b32 a211, v55
    ds_write_b128 v3, v[56:59] offset:16384
    ds_write_b128 v3, v[60:63] offset:24576
    s_branch OE_15
OV_14:
    ds_write_b128 v18, v[32:35] offset:0
    ds_write_b128 v18, v[36:39] offset:4096
    ds_write_b128 v18, v[40:43] offset:8192
    ds_write_b128 v18, v[44:47] offset:12288
    ds_write_b128 v18, v[48:51] offset:16384
    ds_write_b128 v18, v[52:55] offset:20480
    ds_write_b128 v18, v[56:59] offset:24576
    ds_write_b128 v18, v[60:63] offset:28672
OE_15:
    s_waitcnt vmcnt(20)
    v_perm_b32 v32, v100, v96, s40
    v_perm_b32 v36, v100, v96, s41
    v_perm_b32 v40, v101, v97, s40
    v_perm_b32 v44, v101, v97, s41
    v_perm_b32 v48, v102, v98, s40
    v_perm_b32 v52, v102, v98, s41
    v_perm_b32 v56, v103, v99, s40
    v_perm_b32 v60, v103, v99, s41
    s_mov_b32 s7, 98304
    buffer_load_dwordx4 v[96:99], v11, s[36:39], s7 offen
    buffer_load_dwordx4 v[100:103], v11, s[36:39], s7 offen offset:1024
    s_waitcnt vmcnt(20)
    v_perm_b32 v33, v108, v104, s40
    v_perm_b32 v37, v108, v104, s41
    v_perm_b32 v41, v109, v105, s40
    v_perm_b32 v45, v109, v105, s41
    v_perm_b32 v49, v110, v106, s40
    v_perm_b32 v53, v110, v106, s41
    v_perm_b32 v57, v111, v107, s40
    v_perm_b32 v61, v111, v107, s41
    s_mov_b32 s7, 106496
    buffer_load_dwordx4 v[104:107], v11, s[36:39], s7 offen
    buffer_load_dwordx4 v[108:111], v11, s[36:39], s7 offen offset:1024
    s_waitcnt vmcnt(20)
    v_perm_b32 v34, v116, v112, s40
    v_perm_b32 v38, v116, v112, s41
    v_perm_b32 v42, v117, v113, s40
    v_perm_b32 v46, v117, v113, s41
    v_perm_b32 v50, v118, v114, s40
    v_perm_b32 v54, v118, v114, s41
    v_perm_b32 v58, v119, v115, s40
    v_perm_b32 v62, v119, v115, s41
    s_mov_b32 s7, 100352
    buffer_load_dwordx4 v[112:115], v11, s[36:39], s7 offen
    buffer_load_dwordx4 v[116:119], v11, s[36:39], s7 offen offset:1024
    s_waitcnt vmcnt(20)
    v_perm_b32 v35, v124, v120, s40
    v_perm_b32 v39, v124, v120, s41
    v_perm_b32 v43, v125, v121, s40
    v_perm_b32 v47, v125, v121, s41
    v_perm_b32 v51, v126, v122, s40
    v_perm_b32 v55, v126, v122, s41
    v_perm_b32 v59, v127, v123, s40
    v_perm_b32 v63, v127, v123, s41
    s_mov_b32 s7, 108544
    buffer_load_dwordx4 v[120:123], v11, s[36:39], s7 offen
    buffer_load_dwordx4 v[124:127], v11, s[36:39], s7 offen offset:1024
    s_cmp_ge_u32 s3, 2
    s_cbranch_scc1 OV_16
    v_accvgpr_write_b32 a132, v32
    v_accvgpr_write_b32 a133, v33
    v_accvgpr_write_b32 a134, v34
    v_accvgpr_write_b32 a135, v35
    v_accvgpr_write_b32 a148, v36
    v_accvgpr_write_b32 a149, v37
    v_accvgpr_write_b32 a150, v38
    v_accvgpr_write_b32 a151, v39
    v_accvgpr_write_b32 a164, v40
    v_accvgpr_write_b32 a165, v41
    v_accvgpr_write_b32 a166, v42
    v_accvgpr_write_b32 a167, v43
    v_accvgpr_write_b32 a180, v44
    v_accvgpr_write_b32 a181, v45
    v_accvgpr_write_b32 a182, v46
    v_accvgpr_write_b32 a183, v47
    v_accvgpr_write_b32 a196, v48
    v_accvgpr_write_b32 a197, v49
    v_accvgpr_write_b32 a198, v50
    v_accvgpr_write_b32 a199, v51
    v_accvgpr_write_b32 a212, v52
    v_accvgpr_write_b32 a213, v53
    v_accvgpr_write_b32 a214, v54
    v_accvgpr_write_b32 a215, v55
    ds_write_b128 v3, v[56:59] offset:18432
    ds_write_b128 v3, v[60:63] offset:26624
    s_branch OE_17
OV_16:
    ds_write_b128 v18, v[32:35] offset:1024
    ds_write_b128 v18, v[36:39] offset:5120
    ds_write_b128 v18, v[40:43] offset:9216
    ds_write_b128 v18, v[44:47] offset:13312
    ds_write_b128 v18, v[48:51] offset:17408
    ds_write_b128 v18, v[52:55] offset:21504
    ds_write_b128 v18, v[56:59] offset:25600
    ds_write_b128 v18, v[60:63] offset:29696
OE_17:
    s_waitcnt vmcnt(14)
    v_perm_b32 v32, v68, v64, s40
    v_perm_b32 v36, v68, v64, s41
    v_perm_b32 v40, v69, v65, s40
    v_perm_b32 v44, v69, v65, s41
    v_perm_b32 v48, v70, v66, s40
    v_perm_b32 v52, v70, v66, s41
    v_perm_b32 v56, v71, v67, s40
    v_perm_b32 v60, v71, v67, s41
    s_waitcnt vmcnt(12)
    v_perm_b32 v33, v76, v72, s40
    v_perm_b32 v37, v76, v72, s41
    v_perm_b32 v41, v77, v73, s40
    v_perm_b32 v45, v77, v73, s41
    v_perm_b32 v49, v78, v74, s40
    v_perm_b32 v53, v78, v74, s41
    v_perm_b32 v57, v79, v75, s40
    v_perm_b32 v61, v79, v75, s41
    s_waitcnt vmcnt(10)
    v_perm_b32 v34, v84, v80, s40
    v_perm_b32 v38, v84, v80, s41
    v_perm_b32 v42, v85, v81, s40
    v_perm_b32 v46, v85, v81, s41
    v_perm_b32 v50, v86, v82, s40
    v_perm_b32 v54, v86, v82, s41
    v_perm_b32 v58, v87, v83, s40
    v_perm_b32 v62, v87, v83, s41
    s_waitcnt vmcnt(8)
    v_perm_b32 v35, v92, v88, s40
    v_perm_b32 v39, v92, v88, s41
    v_perm_b32 v43, v93, v89, s40
    v_perm_b32 v47, v93, v89, s41
    v_perm_b32 v51, v94, v90, s40
    v_perm_b32 v55, v94, v90, s41
    v_perm_b32 v59, v95, v91, s40
    v_perm_b32 v63, v95, v91, s41
    buffer_load_dwordx2 v[30:31], off, s[12:15], s55 sc1
    v_lshlrev_b32 v64, 1, v0
    v_lshlrev_b32 v65, 3, v0
    s_add_u32 s7, s44, 0x40000
    s_lshl_b32 s90, s3, 13
    s_add_u32 s90, s90, 65536
    buffer_load_dword v66, v64, s[12:15], s44 offen sc1
    buffer_load_dword v67, v64, s[12:15], s7 offen sc1
    buffer_load_dword v68, v65, s[12:15], s90 offen sc1
    s_cmp_ge_u32 s3, 2
    s_cbranch_scc1 OV_18
    v_accvgpr_write_b32 a136, v32
    v_accvgpr_write_b32 a137, v33
    v_accvgpr_write_b32 a138, v34
    v_accvgpr_write_b32 a139, v35
    v_accvgpr_write_b32 a152, v36
    v_accvgpr_write_b32 a153, v37
    v_accvgpr_write_b32 a154, v38
    v_accvgpr_write_b32 a155, v39
    v_accvgpr_write_b32 a168, v40
    v_accvgpr_write_b32 a169, v41
    v_accvgpr_write_b32 a170, v42
    v_accvgpr_write_b32 a171, v43
    v_accvgpr_write_b32 a184, v44
    v_accvgpr_write_b32 a185, v45
    v_accvgpr_write_b32 a186, v46
    v_accvgpr_write_b32 a187, v47
    v_accvgpr_write_b32 a200, v48
    v_accvgpr_write_b32 a201, v49
    v_accvgpr_write_b32 a202, v50
    v_accvgpr_write_b32 a203, v51
    v_accvgpr_write_b32 a216, v52
    v_accvgpr_write_b32 a217, v53
    v_accvgpr_write_b32 a218, v54
    v_accvgpr_write_b32 a219, v55
    ds_write_b128 v3, v[56:59] offset:20480
    ds_write_b128 v3, v[60:63] offset:28672
    s_branch OE_19
OV_18:
    ds_write_b128 v18, v[32:35] offset:2048
    ds_write_b128 v18, v[36:39] offset:6144
    ds_write_b128 v18, v[40:43] offset:10240
    ds_write_b128 v18, v[44:47] offset:14336
    ds_write_b128 v18, v[48:51] offset:18432
    ds_write_b128 v18, v[52:55] offset:22528
    ds_write_b128 v18, v[56:59] offset:26624
    ds_write_b128 v18, v[60:63] offset:30720
OE_19:
    s_waitcnt vmcnt(10)
    v_perm_b32 v32, v100, v96, s40
    v_perm_b32 v36, v100, v96, s41
    v_perm_b32 v40, v101, v97, s40
    v_perm_b32 v44, v101, v97, s41
    v_perm_b32 v48, v102, v98, s40
    v_perm_b32 v52, v102, v98, s41
    v_perm_b32 v56, v103, v99, s40
    v_perm_b32 v60, v103, v99, s41
    s_waitcnt vmcnt(8)
    v_perm_b32 v33, v108, v104, s40
    v_perm_b32 v37, v108, v104, s41
    v_perm_b32 v41, v109, v105, s40
    v_perm_b32 v45, v109, v105, s41
    v_perm_b32 v49, v110, v106, s40
    v_perm_b32 v53, v110, v106, s41
    v_perm_b32 v57, v111, v107, s40
    v_perm_b32 v61, v111, v107, s41
    s_waitcnt vmcnt(6)
    v_perm_b32 v34, v116, v112, s40
    v_perm_b32 v38, v116, v112, s41
    v_perm_b32 v42, v117, v113, s40
    v_perm_b32 v46, v117, v113, s41
    v_perm_b32 v50, v118, v114, s40
    v_perm_b32 v54, v118, v114, s41
    v_perm_b32 v58, v119, v115, s40
    v_perm_b32 v62, v119, v115, s41
    s_waitcnt vmcnt(4)
    v_perm_b32 v35, v124, v120, s40
    v_perm_b32 v39, v124, v120, s41
    v_perm_b32 v43, v125, v121, s40
    v_perm_b32 v47, v125, v121, s41
    v_perm_b32 v51, v126, v122, s40
    v_perm_b32 v55, v126, v122, s41
    v_perm_b32 v59, v127, v123, s40
    v_perm_b32 v63, v127, v123, s41
    s_cmp_ge_u32 s3, 2
    s_cbranch_scc1 OV_20
    v_accvgpr_write_b32 a140, v32
    v_accvgpr_write_b32 a141, v33
    v_accvgpr_write_b32 a142, v34
    v_accvgpr_write_b32 a143, v35
    v_accvgpr_write_b32 a156, v36
    v_accvgpr_write_b32 a157, v37
    v_accvgpr_write_b32 a158, v38
    v_accvgpr_write_b32 a159, v39
    v_accvgpr_write_b32 a172, v40
    v_accvgpr_write_b32 a173, v41
    v_accvgpr_write_b32 a174, v42
    v_accvgpr_write_b32 a175, v43
    v_accvgpr_write_b32 a188, v44
    v_accvgpr_write_b32 a189, v45
    v_accvgpr_write_b32 a190, v46
    v_accvgpr_write_b32 a191, v47
    v_accvgpr_write_b32 a204, v48
    v_accvgpr_write_b32 a205, v49
    v_accvgpr_write_b32 a206, v50
    v_accvgpr_write_b32 a207, v51
    v_accvgpr_write_b32 a220, v52
    v_accvgpr_write_b32 a221, v53
    v_accvgpr_write_b32 a222, v54
    v_accvgpr_write_b32 a223, v55
    ds_write_b128 v3, v[56:59] offset:22528
    ds_write_b128 v3, v[60:63] offset:30720
    s_branch OE_21
OV_20:
    ds_write_b128 v18, v[32:35] offset:3072
    ds_write_b128 v18, v[36:39] offset:7168
    ds_write_b128 v18, v[40:43] offset:11264
    ds_write_b128 v18, v[44:47] offset:15360
    ds_write_b128 v18, v[48:51] offset:19456
    ds_write_b128 v18, v[52:55] offset:23552
    ds_write_b128 v18, v[56:59] offset:27648
    ds_write_b128 v18, v[60:63] offset:31744
OE_21:
    s_waitcnt vmcnt(0)
    v_mov_b32 v33, v24
    v_readfirstlane_b32 s7, v16
    v_readfirstlane_b32 s43, v17
    v_mov_b64 v[40:41], v[26:27]
    v_mov_b64 v[42:43], v[28:29]
    v_mov_b64 v[24:25], v[20:21]
    v_mov_b64 v[26:27], v[22:23]
    s_cmp_ge_u32 s7, 1
    s_cbranch_scc1 L_chain_up
    s_mov_b32 s90, 224
    s_mov_b32 s96, 0
WS_22:
    buffer_load_dword v2, off, s[16:19], s90 sc1
    s_waitcnt vmcnt(0)
    v_readfirstlane_b32 s7, v2
    s_nop 3
    s_cmp_ge_u32 s7, 1
    s_cbranch_scc1 WSOK_23
    s_sleep 2
    s_add_u32 s96, s96, 1
    s_cmp_lt_u32 s96, 418410
    s_cbranch_scc1 WS_22
    s_branch L_bail
WSOK_23:
    s_mov_b32 s96, 0
WS_24:
    buffer_load_dword v2, off, s[16:19], 0 sc1
    s_waitcnt vmcnt(0)
    v_readfirstlane_b32 s43, v2
    s_nop 3
    s_cmp_ge_u32 s43, 0
    s_cbranch_scc1 WSOK_25
    s_sleep 2
    s_add_u32 s96, s96, 1
    s_cmp_lt_u32 s96, 418410
    s_cbranch_scc1 WS_24
    s_branch L_bail
WSOK_25:
    buffer_load_dwordx2 v[30:31], off, s[12:15], s55 sc1
    s_waitcnt vmcnt(0)
L_chain_up:
    v_mov_b64 v[10:11], v[30:31]
    s_lshl_b32 s52, s4, 14
    s_add_u32 s52, s52, 16236544
    s_and_b32 s7, s3, 1
    s_lshl_b32 s95, s7, 12
    s_add_u32 s95, s95, 0x2000
    s_mov_b32 s56, 0
    s_lshl_b32 s53, s4, 12
    s_add_u32 s53, s53, 3014656
    s_lshl_b32 s7, s7, 10
    s_add_u32 s53, s53, s7
    s_mov_b32 s50, 65536
    s_mov_b32 s80, 0
    s_mov_b32 s78, 1094713344
    s_mov_b64 s[88:89], 0
    s_mov_b32 s48, 90112
    s_waitcnt lgkmcnt(0)
    s_mov_b32 s6, -2
    s_cmp_ge_u32 s3, 2
    s_cbranch_scc1 L_nokx
    v_readfirstlane_b32 s84, v10
    v_readfirstlane_b32 s85, v11
    s_mov_b32 s57, s56
    s_add_u32 s90, s6, 2
    s_cmp_lt_u32 s90, 64
    s_cselect_b32 s7, 540672, 0
    s_add_u32 s52, s52, s7
    s_min_u32 s90, s90, 63
    s_lshr_b32 s91, s90, 1
    s_bitcmp1_b32 s90, 0
    s_cselect_b32 s7, s85, s84
    s_cmp_gt_u32 s7, s91
    s_cbranch_scc0 C1_fbwait
C1_fbok:
    s_add_u32 s87, s52, 0x1000
    s_add_u32 s56, s52, s95
    buffer_load_dwordx4 v[72:75], v0, s[12:15], s52 offen offset:0 sc1
    buffer_load_dwordx4 v[76:79], v0, s[12:15], s52 offen offset:1024 sc1
    buffer_load_dwordx4 v[80:83], v0, s[12:15], s52 offen offset:2048 sc1
    buffer_load_dwordx4 v[84:87], v0, s[12:15], s52 offen offset:3072 sc1
    buffer_load_dwordx4 v[88:91], v0, s[12:15], s87 offen offset:0 sc1
    buffer_load_dwordx4 v[92:95], v0, s[12:15], s87 offen offset:1024 sc1
    buffer_load_dwordx4 v[96:99], v0, s[12:15], s87 offen offset:2048 sc1
    buffer_load_dwordx4 v[100:103], v0, s[12:15], s87 offen offset:3072 sc1
    s_mov_b32 s6, -1
    v_readfirstlane_b32 s84, v10
    v_readfirstlane_b32 s85, v11
    s_mov_b32 s57, s56
    s_add_u32 s90, s6, 2
    s_cmp_lt_u32 s90, 64
    s_cselect_b32 s7, 540672, 0
    s_add_u32 s52, s52, s7
    s_min_u32 s90, s90, 63
    s_lshr_b32 s91, s90, 1
    s_bitcmp1_b32 s90, 0
    s_cselect_b32 s7, s85, s84
    s_cmp_gt_u32 s7, s91
    s_cbranch_scc0 C0_fbwait
C0_fbok:
    s_add_u32 s87, s52, 0x1000
    s_add_u32 s56, s52, s95
L_nokx:
    s_mov_b32 s6, 0
    s_mov_b32 s51, s48
    s_and_b32 s7, s6, 3
    s_lshl_b32 s48, s7, 13
    s_add_u32 s48, s48, 65536
    s_lshr_b32 s97, s7, 1
    s_sub_u32 s98, s97, 1
    s_mov_b32 s99, s98
    s_and_b32 s7, s7, 1
    s_lshl_b32 s7, s7, 18
    s_add_u32 s45, s7, 1048576
    s_add_u32 s46, s45, 0x1000
    s_add_u32 s47, s44, s7
    v_add_u32 v44, s81, v0
    v_add_u32 v48, s82, v0
    v_add_u32 v52, s83, v0
    s_cmp_ge_u32 s3, 2
    s_cbranch_scc1 L_vstart
    v_mov_b32 v16, 0x3f803f80
    v_mov_b32 v17, 0x3f803f80
    v_mov_b32 v18, 0x3f803f80
    v_mov_b32 v19, 0x3f803f80
    v_mov_b64 v[56:57], 0
    v_mov_b64 v[58:59], 0
    v_mov_b64 v[60:61], 0
    v_mov_b64 v[62:63], 0
    v_mov_b64 v[64:65], 0
    v_mov_b64 v[66:67], 0
    v_mov_b64 v[68:69], 0
    v_mov_b64 v[70:71], 0
    v_mov_b32 v22, v33
    v_mov_b32 v23, -1
    v_mov_b64 v[120:121], -1
    v_mov_b64 v[122:123], -1
    ds_write_b128 v3, v[120:123] offset:14336
    s_waitcnt lgkmcnt(0)
    v_and_b32 v20, 32, v0
    v_lshlrev_b32 v20, 26, v20
    v_or_b32 v20, 0x7f800000, v20
    s_nop 2
    s_cmp_lt_u32 s43, 32
    s_cbranch_scc1 SA_loop
    s_branch FA_loop
L_vstart:
    v_mov_b32 v8, v18
    v_mov_b32 v9, v33
    v_mov_b64 v[16:17], -1
    v_mov_b64 v[18:19], -1
    ds_read_b128 v[88:91], v8 offset:32768
    ds_read_b128 v[92:95], v8 offset:33792
    ds_read_b128 v[96:99], v8 offset:34816
    ds_read_b128 v[100:103], v8 offset:35840
    ds_read_b128 v[104:107], v8 offset:36864
    ds_read_b128 v[108:111], v8 offset:37888
    ds_read_b128 v[112:115], v8 offset:38912
    ds_read_b128 v[116:119], v8 offset:39936
    ds_read_b128 v[120:123], v8 offset:40960
    ds_read_b128 v[124:127], v8 offset:41984
    v_mov_b64 v[56:57], 0
    v_mov_b64 v[58:59], 0
    v_mov_b64 v[60:61], 0
    v_mov_b64 v[62:63], 0
    v_mov_b64 v[64:65], 0
    v_mov_b64 v[66:67], 0
    v_mov_b64 v[68:69], 0
    v_mov_b64 v[70:71], 0
    v_mov_b64 v[72:73], 0
    v_mov_b64 v[74:75], 0
    v_mov_b64 v[76:77], 0
    v_mov_b64 v[78:79], 0
    v_mov_b64 v[80:81], 0
    v_mov_b64 v[82:83], 0
    v_mov_b64 v[84:85], 0
    v_mov_b64 v[86:87], 0
    s_waitcnt lgkmcnt(0)
    s_nop 1
    s_cmp_lt_u32 s43, 32
    s_cbranch_scc1 SV_loop
    s_branch FV_loop
C0_fbwait:
    s_and_b32 s92, s90, 1
    s_lshl_b32 s92, s92, 2
    s_add_u32 s92, s92, s55
    s_add_u32 s93, s91, 1
    s_mov_b32 s96, 0
WS_26:
    buffer_load_dword v2, off, s[12:15], s92 sc1
    s_waitcnt vmcnt(0)
    v_readfirstlane_b32 s7, v2
    s_nop 3
    s_cmp_ge_u32 s7, s93
    s_cbranch_scc1 WSOK_27
    s_sleep 1
    s_add_u32 s96, s96, 1
    s_cmp_lt_u32 s96, 483091
    s_cbranch_scc1 WS_26
    s_branch L_bail
WSOK_27:
    s_branch C0_fbok
C1_fbwait:
    s_and_b32 s92, s90, 1
    s_lshl_b32 s92, s92, 2
    s_add_u32 s92, s92, s55
    s_add_u32 s93, s91, 1
    s_mov_b32 s96, 0
WS_28:
    buffer_load_dword v2, off, s[12:15], s92 sc1
    s_waitcnt vmcnt(0)
    v_readfirstlane_b32 s7, v2
    s_nop 3
    s_cmp_ge_u32 s7, s93
    s_cbranch_scc1 WSOK_29
    s_sleep 1
    s_add_u32 s96, s96, 1
    s_cmp_lt_u32 s96, 483091
    s_cbranch_scc1 WS_28
    s_branch L_bail
WSOK_29:
    s_branch C1_fbok
.p2align 6
    s_nop 0
    s_nop 0
    s_nop 0
    s_nop 0
FA_loop:
    ds_write_b128 v3, v[24:27]
    v_smfmac_f32_16x16x64_bf16 v[56:59], v[24:27], v[128:135], v4
    v_add_u32 v44, s81, v0
    v_smfmac_f32_16x16x64_bf16 v[64:67], v[24:27], a[0:7], v4
    v_add_u32 v48, s82, v0
    v_smfmac_f32_16x16x64_bf16 v[60:63], v[24:27], v[136:143], v4
    s_mov_b64 exec, s[88:89]
    buffer_load_dwordx4 v[40:43], v0, s[12:15], s50 offen sc1
    s_mov_b64 exec, -1
    v_add_u32 v52, s83, v0
    v_smfmac_f32_16x16x64_bf16 v[68:71], v[24:27], a[8:15], v4
    s_waitcnt lgkmcnt(0)
    s_barrier
    ds_read_b128 v[28:31], v44 offset:0
    ds_read_b128 v[32:35], v48 offset:0
    ds_read_b128 v[36:39], v52 offset:0
    buffer_load_dwordx4 v[104:107], v0, s[12:15], s57 offen offset:0
    buffer_load_dwordx4 v[108:111], v0, s[12:15], s57 offen offset:1024
    buffer_load_dwordx4 v[112:115], v0, s[12:15], s57 offen offset:2048
    buffer_load_dwordx4 v[116:119], v0, s[12:15], s57 offen offset:3072
    s_waitcnt lgkmcnt(2)
    v_smfmac_f32_16x16x64_bf16 v[56:59], v[28:31], v[144:151], v4
    v_lshlrev_b32 v21, 2, v0
    v_smfmac_f32_16x16x64_bf16 v[60:63], v[28:31], v[152:159], v4
    buffer_load_dword v21, v21, s[12:15], s56 offen
    s_waitcnt lgkmcnt(0)
    v_smfmac_f32_16x16x64_bf16 v[56:59], v[32:35], v[160:167], v4
    buffer_load_dwordx4 a[224:227], v0, s[12:15], s52 offen offset:0
    v_smfmac_f32_16x16x64_bf16 v[60:63], v[32:35], v[168:175], v4
    buffer_load_dwordx4 a[228:231], v0, s[12:15], s52 offen offset:1024
    v_smfmac_f32_16x16x64_bf16 v[56:59], v[36:39], v[176:183], v4
    buffer_load_dwordx4 a[232:235], v0, s[12:15], s52 offen offset:2048
    v_smfmac_f32_16x16x64_bf16 v[60:63], v[36:39], v[184:191], v4
    buffer_load_dwordx4 a[236:239], v0, s[12:15], s52 offen offset:3072
    v_smfmac_f32_16x16x64_bf16 v[64:67], v[28:31], a[16:23], v4
    s_waitcnt vmcnt(9)
    ds_write_b128 v3, v[40:43] offset:4096
    v_smfmac_f32_16x16x64_bf16 v[68:71], v[28:31], a[24:31], v4
    buffer_load_dwordx4 a[240:243], v0, s[12:15], s87 offen offset:0
    v_max3_u32 v2, v40, v41, v42
    v_smfmac_f32_16x16x64_bf16 v[64:67], v[32:35], a[32:39], v4
    buffer_load_dwordx4 a[244:247], v0, s[12:15], s87 offen offset:1024
    v_max_u32 v2, v2, v43
    v_smfmac_f32_16x16x64_bf16 v[68:71], v[32:35], a[40:47], v4
    buffer_load_dwordx4 a[248:251], v0, s[12:15], s87 offen offset:2048
    v_cmp_eq_u32 vcc, -1, v2
    v_smfmac_f32_16x16x64_bf16 v[64:67], v[36:39], a[48:55], v4
    buffer_load_dwordx4 a[252:255], v0, s[12:15], s87 offen offset:3072
    v_smfmac_f32_16x16x64_bf16 v[68:71], v[36:39], a[56:63], v4
    s_cbranch_vccnz FA_lretry
FA_lok:
    s_waitcnt lgkmcnt(0)
    s_barrier
    ds_read_b128 v[44:47], v44 offset:4096
    v_smfmac_f32_16x16x64_bf16 v[56:59], v[40:43], v[192:199], v4
    buffer_load_dwordx2 v[10:11], off, s[12:15], s55 sc1
    ds_read_b128 v[48:51], v48 offset:4096
    ds_read_b128 v[52:55], v52 offset:4096
    v_smfmac_f32_16x16x64_bf16 v[60:63], v[40:43], v[200:207], v4
    s_waitcnt lgkmcnt(2)
    v_mov_b32 v2, s80
    v_smfmac_f32_16x16x64_bf16 v[56:59], v[44:47], v[208:215], v4
    s_mov_b64 exec, 1
    buffer_store_dword v2, off, s[12:15], s54 sc1
    s_mov_b64 exec, -1
    v_mov_b64 v[24:25], -1
    v_smfmac_f32_16x16x64_bf16 v[60:63], v[44:47], v[216:223], v4
    s_waitcnt lgkmcnt(0)
    v_mov_b64 v[26:27], -1
    v_smfmac_f32_16x16x64_bf16 v[56:59], v[48:51], v[224:231], v4
    ds_write_b128 v3, v[24:27] offset:12288
    v_smfmac_f32_16x16x64_bf16 v[60:63], v[48:51], v[232:239], v4
    v_smfmac_f32_16x16x64_bf16 v[56:59], v[52:55], v[240:247], v4
    ds_write_b128 v3, v[24:27] offset:14336
    v_smfmac_f32_16x16x64_bf16 v[60:63], v[52:55], v[248:255], v4
    v_smfmac_f32_16x16x64_bf16 v[64:67], v[40:43], a[64:71], v4
    v_add_f32 v56, v56, v57
    v_add_f32 v58, v58, v59
    v_smfmac_f32_16x16x64_bf16 v[68:71], v[40:43], a[72:79], v4
    v_add_f32 v60, v60, v61
    v_add_f32 v62, v62, v63
    v_cvt_pk_bf16_f32 v56, v56, v60
    v_cvt_pk_bf16_f32 v57, v58, v62
    v_smfmac_f32_16x16x64_bf16 v[64:67], v[44:47], a[80:87], v4
    ds_write2_b32 v5, v56, v57 offset0:0 offset1:4
    v_smfmac_f32_16x16x64_bf16 v[68:71], v[44:47], a[88:95], v4
    s_nop 0
    s_nop 0
    s_nop 0
    v_smfmac_f32_16x16x64_bf16 v[64:67], v[48:51], a[96:103], v4
    s_add_u32 s49, s48, s86
    s_add_u32 s50, s49, 0x1000
    v_smfmac_f32_16x16x64_bf16 v[68:71], v[48:51], a[104:111], v4
    s_mov_b64 s[88:89], -1
    s_nop 0
    v_smfmac_f32_16x16x64_bf16 v[64:67], v[52:55], a[112:119], v4
    s_nop 0
    s_nop 0
    s_nop 0
    v_smfmac_f32_16x16x64_bf16 v[68:71], v[52:55], a[120:127], v4
    s_waitcnt lgkmcnt(0)
    s_barrier
    ds_read_b128 v[24:27], v8 offset:0
    ds_read_b128 v[28:31], v8 offset:1024
    ds_read_b128 v[32:35], v8 offset:2048
    ds_read_b128 v[36:39], v8 offset:3072
    v_add_f32 v64, v64, v65
    v_add_f32 v66, v66, v67
    v_add_f32 v68, v68, v69
    v_add_f32 v70, v70, v71
    v_cvt_pk_bf16_f32 v64, v64, v68
    v_cvt_pk_bf16_f32 v65, v66, v70
    ds_write2_b32 v5, v64, v65 offset0:128 offset1:132
    s_waitcnt lgkmcnt(4)
    v_mfma_f32_16x16x32_bf16 v[56:59], v[72:75], v[24:27], 0
    s_waitcnt lgkmcnt(3)
    v_mov_b32 v65, 0
    v_mov_b32 v67, 0
    v_mfma_f32_16x16x32_bf16 v[56:59], v[76:79], v[28:31], v[56:59]
    buffer_store_dwordx4 v[124:127], v0, s[12:15], s53 offen offset:2048 sc1
    s_waitcnt lgkmcnt(2)
    v_mfma_f32_16x16x32_bf16 v[56:59], v[80:83], v[32:35], v[56:59]
    s_waitcnt lgkmcnt(1)
    v_mov_b32 v68, 0
    v_mov_b32 v70, 0
    v_mfma_f32_16x16x32_bf16 v[56:59], v[84:87], v[36:39], v[56:59]
    buffer_store_dwordx4 v[120:123], v0, s[12:15], s53 offen offset:0 sc1
    v_mfma_f32_16x16x32_bf16 v[60:63], v[88:91], v[24:27], 0
    s_waitcnt lgkmcnt(0)
    s_barrier
    ds_read_b128 v[40:43], v8 offset:512
    v_mfma_f32_16x16x32_bf16 v[60:63], v[92:95], v[28:31], v[60:63]
    ds_read_b128 v[44:47], v8 offset:1536
    ds_read_b128 v[48:51], v8 offset:2560
    s_waitcnt vmcnt(13)
    v_mfma_f32_16x16x32_bf16 v[60:63], v[96:99], v[32:35], v[60:63]
    ds_read_b128 v[52:55], v8 offset:3584
    v_max3_f32 v124, v56, v57, v58
    v_mfma_f32_16x16x32_bf16 v[60:63], v[100:103], v[36:39], v[60:63]
    s_waitcnt lgkmcnt(3)
    v_mfma_f32_16x16x32_bf16 v[120:123], v[40:43], v[24:27], 0
    s_nop 0
    s_nop 0
    s_waitcnt lgkmcnt(2)
    v_mfma_f32_16x16x32_bf16 v[120:123], v[44:47], v[28:31], v[120:123]
    s_waitcnt lgkmcnt(1)
    v_max3_f32 v125, v59, v60, v61
    v_max3_f32 v124, v124, v62, v63
    v_mfma_f32_16x16x32_bf16 v[120:123], v[48:51], v[32:35], v[120:123]
    s_waitcnt lgkmcnt(0)
    v_max_f32 v126, v124, v125
    v_max_f32 v127, v124, v125
    v_mfma_f32_16x16x32_bf16 v[120:123], v[52:55], v[36:39], v[120:123]
    s_cmp_eq_u32 s6, 63
    s_cbranch_scc1 L_chain_end
    v_permlane16_swap_b32 v126, v127
    v_max_f32 v124, v126, v127
    v_max_f32 v125, v126, v127
    v_mov_b64 v[40:41], 0
    v_mov_b64 v[42:43], 0
    v_permlane32_swap_b32 v124, v125
    v_max3_f32 v124, v124, v125, v20
    v_mul_f32 v124, s42, v124
    v_fma_f32 v56, v56, s42, -v124
    v_fma_f32 v57, v57, s42, -v124
    v_fma_f32 v58, v58, s42, -v124
    v_fma_f32 v59, v59, s42, -v124
    v_fma_f32 v60, v60, s42, -v124
    v_fma_f32 v61, v61, s42, -v124
    v_fma_f32 v62, v62, s42, -v124
    v_fma_f32 v63, v63, s42, -v124
    v_exp_f32 v56, v56
    v_exp_f32 v57, v57
    v_exp_f32 v58, v58
    v_cvt_pk_bf16_f32 v48, v56, v57
    v_exp_f32 v59, v59
    v_exp_f32 v60, v60
    v_cvt_pk_bf16_f32 v49, v58, v59
    v_exp_f32 v61, v61
    v_exp_f32 v62, v62
    v_cvt_pk_bf16_f32 v50, v60, v61
    v_exp_f32 v63, v63
    v_fma_f32 v120, v120, s42, -v124
    v_cvt_pk_bf16_f32 v51, v62, v63
    v_fma_f32 v121, v121, s42, -v124
    v_exp_f32 v122, v120
    v_mfma_f32_16x16x32_bf16 v[44:47], v[16:19], v[48:51], 0
    v_mov_b32_dpp v52, v48 quad_perm:[2,3,0,1] row_mask:0xf bank_mask:0xf
    v_mov_b32_dpp v53, v49 quad_perm:[2,3,0,1] row_mask:0xf bank_mask:0xf
    v_mfma_f32_16x16x32_bf16 v[28:31], v[104:107], v[48:51], 0
    v_mov_b32_dpp v54, v50 quad_perm:[2,3,0,1] row_mask:0xf bank_mask:0xf
    v_mov_b32_dpp v55, v51 quad_perm:[2,3,0,1] row_mask:0xf bank_mask:0xf
    v_mfma_f32_16x16x32_bf16 v[32:35], v[108:111], v[48:51], 0
    v_exp_f32 v123, v121
    v_max_f32 v125, v120, v121
    v_mfma_f32_16x16x32_bf16 v[28:31], v[112:115], v[52:55], v[28:31]
    s_barrier
    ds_read_b128 v[24:27], v3 offset:14336
    v_cvt_pk_bf16_f32 v64, v122, v123
    v_cvt_pk_bf16_f32 v69, v122, v123
    v_mfma_f32_16x16x32_bf16 v[32:35], v[116:119], v[52:55], v[32:35]
    v_mov_b32_dpp v66, v64 quad_perm:[2,3,0,1] row_mask:0xf bank_mask:0xf
    v_mov_b32_dpp v71, v64 quad_perm:[2,3,0,1] row_mask:0xf bank_mask:0xf
    v_mfma_f32_16x16x16_bf16 v[44:47], v[16:17], v[64:65], v[44:47]
    v_cmp_lt_f32 vcc, s78, v125
    v_mov_b64 v[36:37], 0
    v_mov_b64 v[38:39], 0
    v_cndmask_b32 v126, 0, v23, vcc
    s_waitcnt lgkmcnt(0)
    v_mfma_f32_16x16x32_bf16 v[28:31], v[24:27], v[64:67], v[28:31]
    v_max3_u32 v2, v24, v25, v26
    v_max3_u32 v2, v2, v27, v126
    v_mfma_f32_16x16x32_bf16 v[32:35], v[24:27], v[68:71], v[32:35]
    v_cmp_eq_u32 vcc, -1, v2
    v_add_f32_dpp v124, v44, v44 quad_perm:[2,3,0,1] row_mask:0xf bank_mask:0xf
    v_rcp_f32 v124, v124
    s_cbranch_vccnz FA_vredo
FA_vok:
    v_mul_f32 v28, v28, v124
    v_mul_f32 v29, v29, v124
    v_mul_f32 v30, v30, v124
    v_mul_f32 v31, v31, v124
    v_pk_mul_f32 v[32:33], v[32:33], v[124:125] op_sel_hi:[1,0]
    v_pk_mul_f32 v[34:35], v[34:35], v[124:125] op_sel_hi:[1,0]
    v_cvt_pk_bf16_f32 v120, v28, v32
    v_cvt_pk_bf16_f32 v121, v29, v33
    v_cvt_pk_bf16_f32 v122, v30, v34
    v_cvt_pk_bf16_f32 v123, v31, v35
    ds_write_b128 v9, v[120:123]
    s_barrier
    ds_read_b128 v[120:123], v6 offset:0
    ds_read_b128 v[124:127], v6 offset:1024
    v_mov_b64 v[56:57], 0
    v_mov_b64 v[58:59], 0
    v_mov_b64 v[60:61], 0
    v_mov_b64 v[62:63], 0
    v_mov_b64 v[28:29], 0
    v_mov_b64 v[30:31], 0
    v_mov_b64 v[32:33], 0
    v_mov_b64 v[34:35], 0
    s_waitcnt lgkmcnt(1)
FA_wo:
    v_smfmac_f32_16x16x64_bf16 v[56:59], v[120:123], a[128:135], v4
    s_waitcnt lgkmcnt(0)
    v_mov_b64 v[24:25], 0
    v_smfmac_f32_16x16x64_bf16 v[56:59], v[124:127], a[136:143], v4
    s_nop 0
    s_nop 0
    v_mov_b64 v[26:27], 0
    v_smfmac_f32_16x16x64_bf16 v[60:63], v[120:123], a[144:151], v4
    s_nop 0
    ds_read_b128 v[72:75], v3 offset:16384
    v_mov_b64 v[44:45], 0
    v_smfmac_f32_16x16x64_bf16 v[60:63], v[124:127], a[152:159], v4
    s_nop 0
    ds_read_b128 v[76:79], v3 offset:18432
    v_add_f32 v56, v56, v57
    v_smfmac_f32_16x16x64_bf16 v[28:31], v[120:123], a[160:167], v4
    ds_read_b128 v[80:83], v3 offset:20480
    v_add_f32 v58, v58, v59
    v_smfmac_f32_16x16x64_bf16 v[28:31], v[124:127], a[168:175], v4
    ds_read_b128 v[84:87], v3 offset:22528
    v_add_f32 v60, v60, v61
    v_add_f32 v62, v62, v63
    v_cmp_u_f32 vcc, v56, v58
    v_smfmac_f32_16x16x64_bf16 v[32:35], v[120:123], a[176:183], v4
    ds_read_b128 v[88:91], v3 offset:24576
    v_cvt_pk_bf16_f32 v64, v56, v60
    v_cvt_pk_bf16_f32 v66, v58, v62
    v_smfmac_f32_16x16x64_bf16 v[32:35], v[124:127], a[184:191], v4
    ds_read_b128 v[92:95], v3 offset:26624
    v_add_f32 v28, v28, v29
    v_add_f32 v30, v30, v31
    v_smfmac_f32_16x16x64_bf16 v[24:27], v[120:123], a[192:199], v4
    s_cbranch_vccnz FA_oredo
FA_ook:
    ds_read_b128 v[96:99], v3 offset:28672
    v_and_or_b32 v64, v64, -2, s97
    v_and_or_b32 v66, v66, -2, s97
    v_smfmac_f32_16x16x64_bf16 v[24:27], v[124:127], a[200:207], v4
    ds_read_b128 v[100:103], v3 offset:30720
    v_add_f32 v32, v32, v33
    v_add_f32 v34, v34, v35
    v_cvt_pk_bf16_f32 v65, v28, v32
    v_cvt_pk_bf16_f32 v67, v30, v34
    v_and_or_b32 v65, v65, -2, s97
    v_and_or_b32 v67, v67, -2, s97
    buffer_store_dwordx4 v[64:67], v7, s[12:15], s45 offen
    v_smfmac_f32_16x16x64_bf16 v[36:39], v[120:123], a[208:215], v4
    s_nop 0
    s_nop 0
    v_mov_b64 v[46:47], 0
    v_smfmac_f32_16x16x64_bf16 v[36:39], v[124:127], a[216:223], v4
    s_waitcnt lgkmcnt(0)
    v_add_f32 v24, v24, v25
    v_smfmac_f32_16x16x64_bf16 v[40:43], v[120:123], v[72:79], v4
    s_nop 0
    v_add_f32 v26, v26, v27
    v_smfmac_f32_16x16x64_bf16 v[40:43], v[124:127], v[80:87], v4
    v_add_f32 v36, v36, v37
    v_add_f32 v38, v38, v39
    v_smfmac_f32_16x16x64_bf16 v[44:47], v[120:123], v[88:95], v4
    v_cvt_pk_bf16_f32 v68, v24, v36
    v_cvt_pk_bf16_f32 v70, v26, v38
    v_smfmac_f32_16x16x64_bf16 v[44:47], v[124:127], v[96:103], v4
    v_add_f32 v40, v40, v41
    v_add_f32 v42, v42, v43
    v_and_or_b32 v68, v68, -2, s97
    v_and_or_b32 v70, v70, -2, s97
    s_nop 3
    v_add_f32 v44, v44, v45
    v_add_f32 v46, v46, v47
    v_cvt_pk_bf16_f32 v69, v40, v44
    v_cvt_pk_bf16_f32 v71, v42, v46
    v_and_or_b32 v69, v69, -2, s97
    v_and_or_b32 v71, v71, -2, s97
    buffer_store_dwordx4 v[68:71], v7, s[12:15], s46 offen
    v_mov_b64 v[36:37], -1
    ds_read_b128 v[120:123], v22
    ds_read_b128 v[124:127], v3 offset:14336
    v_mov_b64 v[24:25], -1
    v_mov_b64 v[26:27], -1
    v_mov_b64 v[56:57], 0
    v_mov_b64 v[58:59], 0
    v_mov_b64 v[60:61], 0
    v_mov_b64 v[62:63], 0
    v_mov_b64 v[64:65], 0
    v_mov_b64 v[66:67], 0
    v_mov_b64 v[68:69], 0
    v_mov_b64 v[70:71], 0
    v_mov_b32 v2, 0
    s_nop 2
    v_mov_b32 v2, 0
    s_nop 2
    buffer_load_dwordx4 v[28:31], v0, s[12:15], s47 offen sc1
    buffer_load_dwordx4 v[32:35], v0, s[12:15], s47 offen offset:1024 sc1
    v_mov_b32 v2, 0
    s_nop 2
    v_mov_b32 v2, 0
    s_nop 2
    v_mov_b32 v2, 0
    s_nop 2
    v_mov_b32 v2, 0
    s_nop 2
    v_mov_b32 v2, 0
    s_nop 2
    v_mov_b32 v2, 0
    s_nop 2
    v_mov_b32 v2, 0
    s_nop 2
    v_mov_b32 v2, 0
    s_nop 2
    v_mov_b32 v2, 0
    s_nop 2
    buffer_load_dwordx4 v[48:51], v0, s[12:15], s47 offen sc1
    buffer_load_dwordx4 v[52:55], v0, s[12:15], s47 offen offset:1024 sc1
    v_readfirstlane_b32 s84, v10
    v_readfirstlane_b32 s85, v11
    s_mov_b32 s57, s56
    s_add_u32 s90, s6, 2
    s_cmp_lt_u32 s90, 64
    s_cselect_b32 s7, 540672, 0
    s_add_u32 s52, s52, s7
    s_min_u32 s90, s90, 63
    s_lshr_b32 s91, s90, 1
    s_bitcmp1_b32 s90, 0
    s_cselect_b32 s7, s85, s84
    s_cmp_gt_u32 s7, s91
    s_cbranch_scc0 FA_fbwait
FA_fbok:
    s_add_u32 s87, s52, 0x1000
    s_add_u32 s56, s52, s95
    s_waitcnt lgkmcnt(0)
    s_mov_b32 s96, 0
    s_nop 0
    s_nop 0
    s_nop 0
    s_nop 0
    s_nop 0
    s_nop 0
    s_nop 0
    s_waitcnt vmcnt(2)
FA_r10:
    v_mfma_f32_16x16x32_bf16 v[40:43], v[12:15], v[28:31], 0
    v_bitop3_b32 v44, v28, v29, s98 bitop3:0xbd
    v_bitop3_b32 v45, v30, v31, s98 bitop3:0xbd
    v_mfma_f32_16x16x32_bf16 v[40:43], v[12:15], v[32:35], v[40:43]
    v_bitop3_b32 v46, v32, v33, s98 bitop3:0xbd
    v_bitop3_b32 v47, v34, v35, s98 bitop3:0xbd
    v_or3_b32 v44, v44, v45, v46
    v_bitop3_b32 v44, v44, v47, 1 bitop3:0xa8
    v_cmp_ne_u32 vcc, 0, v44
    s_nop 2
    v_add_f32_dpp v38, v40, v40 row_ror:4 row_mask:0xf bank_mask:0x5
    v_add_f32_dpp v39, v41, v41 row_ror:4 row_mask:0xf bank_mask:0x5
    v_add_f32_dpp v38, v42, v42 row_ror:4 row_mask:0xf bank_mask:0xa
    v_add_f32_dpp v39, v43, v43 row_ror:4 row_mask:0xf bank_mask:0xa
    s_cbranch_vccnz FA_r11
FA_r1ok:
    v_add_f32_dpp v38, v38, v38 row_ror:8 row_mask:0xf bank_mask:0xf
    v_add_f32_dpp v39, v39, v39 row_ror:8 row_mask:0xf bank_mask:0xf
    s_mov_b64 exec, s[58:59]
    v_cvt_pk_bf16_f32 v38, v38, v39
    buffer_store_dword v38, v1, s[12:15], s48 offen
    buffer_store_dword v36, v1, s[12:15], s51 offen
    s_mov_b64 exec, -1
    s_waitcnt vmcnt(9)
    v_accvgpr_read_b32 v72, a224
    v_accvgpr_read_b32 v73, a225
    v_accvgpr_read_b32 v74, a226
    v_accvgpr_read_b32 v75, a227
    v_accvgpr_read_b32 v76, a228
    v_accvgpr_read_b32 v77, a229
    v_accvgpr_read_b32 v78, a230
    v_accvgpr_read_b32 v79, a231
    v_accvgpr_read_b32 v80, a232
    v_accvgpr_read_b32 v81, a233
    v_accvgpr_read_b32 v82, a234
    v_accvgpr_read_b32 v83, a235
    v_accvgpr_read_b32 v84, a236
    v_accvgpr_read_b32 v85, a237
    v_accvgpr_read_b32 v86, a238
    v_accvgpr_read_b32 v87, a239
    v_accvgpr_read_b32 v88, a240
    v_accvgpr_read_b32 v89, a241
    v_accvgpr_read_b32 v90, a242
    v_accvgpr_read_b32 v91, a243
    v_accvgpr_read_b32 v92, a244
    v_accvgpr_read_b32 v93, a245
    v_accvgpr_read_b32 v94, a246
    v_accvgpr_read_b32 v95, a247
    buffer_load_dwordx4 v[24:27], v0, s[12:15], s49 offen sc1
    v_accvgpr_read_b32 v96, a248
    v_accvgpr_read_b32 v97, a249
    v_accvgpr_read_b32 v98, a250
    v_accvgpr_read_b32 v99, a251
    v_accvgpr_read_b32 v100, a252
    v_accvgpr_read_b32 v101, a253
    v_accvgpr_read_b32 v102, a254
    v_accvgpr_read_b32 v103, a255
    s_mov_b32 s80, s6
    s_add_u32 s6, s6, 1
    s_add_u32 s53, s53, 0x20000
    s_mov_b32 s96, 0
    v_mov_b32 v2, 0
    s_mov_b32 s51, s48
    s_and_b32 s7, s6, 3
    s_lshl_b32 s48, s7, 13
    s_add_u32 s48, s48, 65536
    s_lshr_b32 s97, s7, 1
    s_sub_u32 s98, s97, 1
    s_mov_b32 s99, s98
    s_and_b32 s7, s7, 1
    s_lshl_b32 s7, s7, 18
    s_add_u32 s45, s7, 1048576
    s_add_u32 s46, s45, 0x1000
    s_add_u32 s47, s44, s7
    buffer_load_dwordx4 v[24:27], v0, s[12:15], s49 offen sc1
    s_waitcnt lgkmcnt(0)
    s_nop 0
FA_r2:
    v_max3_u32 v2, v24, v25, v26
    v_max_u32 v2, v2, v27
    v_cmp_eq_u32 vcc, -1, v2
    s_cbranch_vccz FA_loop
    v_max3_u32 v2, v24, v25, v26
    v_max_u32 v2, v2, v27
    v_cmp_eq_u32 vcc, -1, v2
    s_cbranch_vccz FA_loop
    s_mov_b64 exec, vcc
    buffer_load_dwordx4 v[24:27], v0, s[12:15], s49 offen sc1
    s_mov_b64 exec, -1
    s_add_u32 s96, s96, 1
    s_cmp_lt_u32 s96, 1333333
    s_cbranch_scc1 FA_r2
    s_branch L_bail
FA_r11:
    s_mov_b64 exec, vcc
    buffer_load_dwordx4 v[28:31], v0, s[12:15], s47 offen sc1
    buffer_load_dwordx4 v[32:35], v0, s[12:15], s47 offen offset:1024 sc1
    s_mov_b64 exec, -1
    s_waitcnt vmcnt(2)
    v_mfma_f32_16x16x32_bf16 v[40:43], v[12:15], v[48:51], 0
    v_bitop3_b32 v44, v48, v49, s98 bitop3:0xbd
    v_bitop3_b32 v45, v50, v51, s98 bitop3:0xbd
    v_mfma_f32_16x16x32_bf16 v[40:43], v[12:15], v[52:55], v[40:43]
    v_bitop3_b32 v46, v52, v53, s98 bitop3:0xbd
    v_bitop3_b32 v47, v54, v55, s98 bitop3:0xbd
    v_or3_b32 v44, v44, v45, v46
    v_bitop3_b32 v44, v44, v47, 1 bitop3:0xa8
    v_cmp_ne_u32 vcc, 0, v44
    s_nop 2
    v_add_f32_dpp v38, v40, v40 row_ror:4 row_mask:0xf bank_mask:0x5
    v_add_f32_dpp v39, v41, v41 row_ror:4 row_mask:0xf bank_mask:0x5
    v_add_f32_dpp v38, v42, v42 row_ror:4 row_mask:0xf bank_mask:0xa
    v_add_f32_dpp v39, v43, v43 row_ror:4 row_mask:0xf bank_mask:0xa
    s_cbranch_vccz FA_r1ok
    s_mov_b64 exec, vcc
    buffer_load_dwordx4 v[48:51], v0, s[12:15], s47 offen sc1
    buffer_load_dwordx4 v[52:55], v0, s[12:15], s47 offen offset:1024 sc1
    s_mov_b64 exec, -1
    s_waitcnt vmcnt(2)
    s_add_u32 s96, s96, 1
    s_cmp_lt_u32 s96, 1333333
    s_cbranch_scc1 FA_r10
    s_branch L_bail
FA_lretry:
FA_lr2:
    s_mov_b64 exec, vcc
    buffer_load_dwordx4 v[40:43], v0, s[12:15], s50 offen sc1
    s_mov_b64 exec, -1
    s_waitcnt vmcnt(0)
    v_max3_u32 v2, v40, v41, v42
    v_max_u32 v2, v2, v43
    v_cmp_eq_u32 vcc, -1, v2
    ds_write_b128 v3, v[40:43] offset:4096
    s_waitcnt lgkmcnt(0)
    s_cbranch_vccz FA_lok
    s_add_u32 s96, s96, 1
    s_cmp_lt_u32 s96, 1333333
    s_cbranch_scc1 FA_lr2
    s_branch L_bail
FA_fbwait:
    s_and_b32 s92, s90, 1
    s_lshl_b32 s92, s92, 2
    s_add_u32 s92, s92, s55
    s_add_u32 s93, s91, 1
    s_mov_b32 s96, 0
WS_30:
    buffer_load_dword v2, off, s[12:15], s92 sc1
    s_waitcnt vmcnt(0)
    v_readfirstlane_b32 s7, v2
    s_nop 3
    s_cmp_ge_u32 s7, s93
    s_cbranch_scc1 WSOK_31
    s_sleep 1
    s_add_u32 s96, s96, 1
    s_cmp_lt_u32 s96, 483091
    s_cbranch_scc1 WS_30
    s_branch L_bail
WSOK_31:
    s_branch FA_fbok
FA_vredo:
    s_mov_b32 s96, 0
FA_vr1:
    ds_read_b128 v[24:27], v3 offset:14336
    s_waitcnt lgkmcnt(0)
    v_max3_u32 v2, v24, v25, v26
    v_max_u32 v2, v2, v27
    v_cmp_eq_u32 vcc, -1, v2
    s_cbranch_vccz FA_vr2
    s_add_u32 s96, s96, 1
    s_cmp_lt_u32 s96, 1333333
    s_cbranch_scc1 FA_vr1
    s_branch L_bail
FA_vr2:
    v_cmp_lt_f32 vcc, s78, v125
    s_cbranch_vccz FA_vr3
    v_max_f32 v125, 0, v125
    v_mov_b32 v126, v125
    s_nop 1
    v_permlane16_swap_b32 v125, v126
    v_max_f32 v125, v125, v126
    v_mov_b32 v126, v125
    s_nop 1
    v_permlane32_swap_b32 v125, v126
    v_max_f32 v125, v125, v126
    s_nop 1
    v_max_f32_dpp v125, v125, v125 quad_perm:[2,3,0,1] row_mask:0xf bank_mask:0xf
    v_sub_f32 v120, v120, v125
    v_sub_f32 v121, v121, v125
    v_sub_f32 v125, 0, v125
    v_exp_f32 v122, v120
    v_exp_f32 v123, v121
    v_exp_f32 v125, v125
    v_cvt_pk_bf16_f32 v64, v122, v123
    v_cvt_pk_bf16_f32 v69, v122, v123
    s_nop 0
    v_mov_b32_dpp v66, v64 quad_perm:[2,3,0,1] row_mask:0xf bank_mask:0xf
    v_mov_b32_dpp v71, v64 quad_perm:[2,3,0,1] row_mask:0xf bank_mask:0xf
    v_mul_f32 v56, v56, v125
    v_mul_f32 v57, v57, v125
    v_mul_f32 v58, v58, v125
    v_mul_f32 v59, v59, v125
    v_mul_f32 v60, v60, v125
    v_mul_f32 v61, v61, v125
    v_mul_f32 v62, v62, v125
    v_mul_f32 v63, v63, v125
    v_cvt_pk_bf16_f32 v48, v56, v57
    v_cvt_pk_bf16_f32 v49, v58, v59
    v_cvt_pk_bf16_f32 v50, v60, v61
    v_cvt_pk_bf16_f32 v51, v62, v63
    v_mov_b32_dpp v52, v48 quad_perm:[2,3,0,1] row_mask:0xf bank_mask:0xf
    v_mov_b32_dpp v53, v49 quad_perm:[2,3,0,1] row_mask:0xf bank_mask:0xf
    v_mov_b32_dpp v54, v50 quad_perm:[2,3,0,1] row_mask:0xf bank_mask:0xf
    v_mov_b32_dpp v55, v51 quad_perm:[2,3,0,1] row_mask:0xf bank_mask:0xf
FA_vr3:
    v_mfma_f32_16x16x32_bf16 v[44:47], v[16:19], v[48:51], 0
    v_mfma_f32_16x16x32_bf16 v[28:31], v[104:107], v[48:51], 0
    v_mfma_f32_16x16x32_bf16 v[32:35], v[108:111], v[48:51], 0
    v_mfma_f32_16x16x32_bf16 v[28:31], v[112:115], v[52:55], v[28:31]
    v_mfma_f32_16x16x32_bf16 v[32:35], v[116:119], v[52:55], v[32:35]
    v_mfma_f32_16x16x16_bf16 v[44:47], v[16:17], v[64:65], v[44:47]
    v_mfma_f32_16x16x32_bf16 v[28:31], v[24:27], v[64:67], v[28:31]
    v_mfma_f32_16x16x32_bf16 v[32:35], v[24:27], v[68:71], v[32:35]
    v_add_f32_dpp v124, v44, v44 quad_perm:[2,3,0,1] row_mask:0xf bank_mask:0xf
    v_rcp_f32 v124, v124
    s_nop 5
    s_branch FA_vok
FA_oredo:
    v_max3_u32 v2, v120, v121, v122
    v_max_u32 v2, v2, v123
    v_max_u32 v2, v2, v124
    v_max_u32 v2, v2, v125
    v_max_u32 v2, v2, v126
    v_max_u32 v2, v2, v127
    v_cmp_eq_u32 vcc, -1, v2
    s_cbranch_vccz FA_ook
    s_mov_b32 s96, 0
FA_or1:
    ds_read_b128 v[120:123], v6 offset:0
    ds_read_b128 v[124:127], v6 offset:1024
    s_waitcnt lgkmcnt(0)
    v_max3_u32 v2, v120, v121, v122
    v_max_u32 v2, v2, v123
    v_max_u32 v2, v2, v124
    v_max_u32 v2, v2, v125
    v_max_u32 v2, v2, v126
    v_max_u32 v2, v2, v127
    v_cmp_eq_u32 vcc, -1, v2
    s_cbranch_vccz FA_or2
    s_add_u32 s96, s96, 1
    s_cmp_lt_u32 s96, 1333333
    s_cbranch_scc1 FA_or1
    s_branch L_bail
FA_or2:
    v_mov_b64 v[56:57], 0
    v_mov_b64 v[58:59], 0
    v_mov_b64 v[60:61], 0
    v_mov_b64 v[62:63], 0
    v_mov_b64 v[28:29], 0
    v_mov_b64 v[30:31], 0
    v_mov_b64 v[32:33], 0
    v_mov_b64 v[34:35], 0
    v_mov_b64 v[24:25], 0
    v_mov_b64 v[26:27], 0
    s_nop 2
    s_branch FA_wo
.p2align 6
    s_nop 0
FV_loop:
    ds_write_b128 v3, v[24:27]
    v_smfmac_f32_16x16x64_bf16 v[56:59], v[24:27], v[128:135], v4
    s_nop 0
    s_nop 0
    v_add_u32 v44, s81, v0
    v_smfmac_f32_16x16x64_bf16 v[64:67], v[24:27], a[0:7], v4
    v_add_u32 v48, s82, v0
    v_smfmac_f32_16x16x64_bf16 v[60:63], v[24:27], v[136:143], v4
    s_mov_b64 exec, s[88:89]
    buffer_load_dwordx4 v[40:43], v0, s[12:15], s50 offen sc1
    s_mov_b64 exec, -1
    v_add_u32 v52, s83, v0
    v_smfmac_f32_16x16x64_bf16 v[68:71], v[24:27], a[8:15], v4
    s_waitcnt lgkmcnt(0)
    s_barrier
    ds_read_b128 v[28:31], v44 offset:0
    ds_read_b128 v[32:35], v48 offset:0
    ds_read_b128 v[36:39], v52 offset:0
    v_smfmac_f32_16x16x64_bf16 v[80:83], v[24:27], v[88:95], v4
    ds_read_b128 v[88:91], v8 offset:43008
    v_smfmac_f32_16x16x64_bf16 v[72:75], v[24:27], a[128:135], v4
    ds_read_b128 v[92:95], v8 offset:44032
    v_smfmac_f32_16x16x64_bf16 v[84:87], v[24:27], v[96:103], v4
    ds_read_b128 v[96:99], v8 offset:45056
    v_smfmac_f32_16x16x64_bf16 v[76:79], v[24:27], a[136:143], v4
    ds_read_b128 v[100:103], v8 offset:46080
    s_waitcnt lgkmcnt(6)
    v_smfmac_f32_16x16x64_bf16 v[56:59], v[28:31], v[144:151], v4
    v_smfmac_f32_16x16x64_bf16 v[60:63], v[28:31], v[152:159], v4
    s_waitcnt lgkmcnt(4)
    v_smfmac_f32_16x16x64_bf16 v[56:59], v[32:35], v[160:167], v4
    v_smfmac_f32_16x16x64_bf16 v[60:63], v[32:35], v[168:175], v4
    v_smfmac_f32_16x16x64_bf16 v[56:59], v[36:39], v[176:183], v4
    v_smfmac_f32_16x16x64_bf16 v[60:63], v[36:39], v[184:191], v4
    v_smfmac_f32_16x16x64_bf16 v[64:67], v[28:31], a[16:23], v4
    s_waitcnt vmcnt(0)
    ds_write_b128 v3, v[40:43] offset:4096
    v_smfmac_f32_16x16x64_bf16 v[68:71], v[28:31], a[24:31], v4
    v_max3_u32 v2, v40, v41, v42
    v_smfmac_f32_16x16x64_bf16 v[64:67], v[32:35], a[32:39], v4
    v_max_u32 v2, v2, v43
    v_smfmac_f32_16x16x64_bf16 v[68:71], v[32:35], a[40:47], v4
    v_cmp_eq_u32 vcc, -1, v2
    v_smfmac_f32_16x16x64_bf16 v[64:67], v[36:39], a[48:55], v4
    v_smfmac_f32_16x16x64_bf16 v[68:71], v[36:39], a[56:63], v4
    s_cbranch_vccnz FV_lretry
FV_lok:
    s_waitcnt lgkmcnt(0)
    s_barrier
    ds_read_b128 v[44:47], v44 offset:4096
    v_smfmac_f32_16x16x64_bf16 v[56:59], v[40:43], v[192:199], v4
    ds_read_b128 v[48:51], v48 offset:4096
    ds_read_b128 v[52:55], v52 offset:4096
    v_smfmac_f32_16x16x64_bf16 v[60:63], v[40:43], v[200:207], v4
    v_smfmac_f32_16x16x64_bf16 v[80:83], v[28:31], v[104:111], v4
    ds_read_b128 v[104:107], v8 offset:47104
    s_waitcnt lgkmcnt(3)
    v_smfmac_f32_16x16x64_bf16 v[56:59], v[44:47], v[208:215], v4
    s_nop 0
    v_smfmac_f32_16x16x64_bf16 v[60:63], v[44:47], v[216:223], v4
    s_waitcnt lgkmcnt(1)
    v_smfmac_f32_16x16x64_bf16 v[56:59], v[48:51], v[224:231], v4
    v_smfmac_f32_16x16x64_bf16 v[60:63], v[48:51], v[232:239], v4
    v_smfmac_f32_16x16x64_bf16 v[56:59], v[52:55], v[240:247], v4
    v_smfmac_f32_16x16x64_bf16 v[60:63], v[52:55], v[248:255], v4
    v_smfmac_f32_16x16x64_bf16 v[64:67], v[40:43], a[64:71], v4
    v_add_f32 v56, v56, v57
    v_add_f32 v58, v58, v59
    v_smfmac_f32_16x16x64_bf16 v[68:71], v[40:43], a[72:79], v4
    v_add_f32 v60, v60, v61
    v_add_f32 v62, v62, v63
    v_cvt_pk_bf16_f32 v56, v56, v60
    v_cvt_pk_bf16_f32 v57, v58, v62
    v_smfmac_f32_16x16x64_bf16 v[64:67], v[44:47], a[80:87], v4
    ds_write2_b32 v5, v56, v57 offset0:0 offset1:4
    v_smfmac_f32_16x16x64_bf16 v[68:71], v[44:47], a[88:95], v4
    s_nop 0
    s_nop 0
    v_smfmac_f32_16x16x64_bf16 v[64:67], v[48:51], a[96:103], v4
    s_add_u32 s49, s48, s86
    s_add_u32 s50, s49, 0x1000
    v_smfmac_f32_16x16x64_bf16 v[68:71], v[48:51], a[104:111], v4
    s_mov_b64 s[88:89], -1
    s_nop 0
    v_smfmac_f32_16x16x64_bf16 v[64:67], v[52:55], a[112:119], v4
    s_nop 0
    s_nop 0
    v_smfmac_f32_16x16x64_bf16 v[68:71], v[52:55], a[120:127], v4
    v_smfmac_f32_16x16x64_bf16 v[72:75], v[28:31], a[144:151], v4
    ds_read_b128 v[108:111], v8 offset:48128
    v_smfmac_f32_16x16x64_bf16 v[84:87], v[28:31], v[112:119], v4
    ds_read_b128 v[112:115], v8 offset:49152
    s_waitcnt lgkmcnt(2)
    s_barrier
    v_smfmac_f32_16x16x64_bf16 v[76:79], v[28:31], a[152:159], v4
    ds_read_b128 v[116:119], v8 offset:50176
    v_add_f32 v64, v64, v65
    v_add_f32 v66, v66, v67
    v_smfmac_f32_16x16x64_bf16 v[80:83], v[32:35], v[120:127], v4
    ds_read_b128 v[120:123], v8 offset:51200
    v_add_f32 v68, v68, v69
    v_add_f32 v70, v70, v71
    v_cvt_pk_bf16_f32 v64, v64, v68
    v_cvt_pk_bf16_f32 v65, v66, v70
    v_smfmac_f32_16x16x64_bf16 v[72:75], v[32:35], a[160:167], v4
    ds_read_b128 v[124:127], v8 offset:52224
    ds_write2_b32 v5, v64, v65 offset0:128 offset1:132
    v_smfmac_f32_16x16x64_bf16 v[84:87], v[32:35], v[88:95], v4
    ds_read_b128 v[88:91], v8 offset:53248
    v_smfmac_f32_16x16x64_bf16 v[76:79], v[32:35], a[168:175], v4
    ds_read_b128 v[92:95], v8 offset:54272
    s_nop 0
    v_smfmac_f32_16x16x64_bf16 v[80:83], v[36:39], v[96:103], v4
    ds_read_b128 v[96:99], v8 offset:55296
    v_smfmac_f32_16x16x64_bf16 v[72:75], v[36:39], a[176:183], v4
    ds_read_b128 v[100:103], v8 offset:56320
    s_waitcnt lgkmcnt(9)
    v_smfmac_f32_16x16x64_bf16 v[84:87], v[36:39], v[104:111], v4
    ds_read_b128 v[104:107], v8 offset:57344
    v_smfmac_f32_16x16x64_bf16 v[76:79], v[36:39], a[184:191], v4
    ds_read_b128 v[108:111], v8 offset:58368
    s_waitcnt lgkmcnt(6)
    s_barrier
    v_smfmac_f32_16x16x64_bf16 v[80:83], v[40:43], v[112:119], v4
    ds_read_b128 v[112:115], v8 offset:59392
    v_smfmac_f32_16x16x64_bf16 v[72:75], v[40:43], a[192:199], v4
    ds_read_b128 v[116:119], v8 offset:60416
    v_smfmac_f32_16x16x64_bf16 v[84:87], v[40:43], v[120:127], v4
    ds_read_b128 v[120:123], v8 offset:61440
    v_smfmac_f32_16x16x64_bf16 v[76:79], v[40:43], a[200:207], v4
    ds_read_b128 v[124:127], v8 offset:62464
    s_waitcnt lgkmcnt(8)
    v_smfmac_f32_16x16x64_bf16 v[80:83], v[44:47], v[88:95], v4
    ds_read_b128 v[88:91], v8 offset:63488
    v_smfmac_f32_16x16x64_bf16 v[72:75], v[44:47], a[208:215], v4
    ds_read_b128 v[92:95], v8 offset:64512
    s_waitcnt lgkmcnt(8)
    v_smfmac_f32_16x16x64_bf16 v[84:87], v[44:47], v[96:103], v4
    ds_read_b128 v[16:19], v8 offset:10240
    v_smfmac_f32_16x16x64_bf16 v[76:79], v[44:47], a[216:223], v4
    ds_read_b128 v[20:23], v8 offset:11264
    s_waitcnt lgkmcnt(8)
    v_smfmac_f32_16x16x64_bf16 v[80:83], v[48:51], v[104:111], v4
    ds_read_b128 v[56:59], v8 offset:12288
    v_smfmac_f32_16x16x64_bf16 v[72:75], v[48:51], a[224:231], v4
    ds_read_b128 v[60:63], v8 offset:13312
    s_waitcnt lgkmcnt(8)
    v_smfmac_f32_16x16x64_bf16 v[84:87], v[48:51], v[112:119], v4
    ds_read_b128 v[96:99], v8 offset:2048
    s_waitcnt lgkmcnt(7)
    v_smfmac_f32_16x16x64_bf16 v[80:83], v[52:55], v[120:127], v4
    ds_read_b128 v[100:103], v8 offset:3072
    s_waitcnt lgkmcnt(6)
    v_smfmac_f32_16x16x64_bf16 v[84:87], v[52:55], v[88:95], v4
    ds_read_b128 v[104:107], v8 offset:4096
    v_smfmac_f32_16x16x64_bf16 v[72:75], v[52:55], a[240:247], v4
    ds_read_b128 v[108:111], v8 offset:5120
    v_add_f32 v80, v80, v81
    v_add_f32 v82, v82, v83
    v_smfmac_f32_16x16x64_bf16 v[76:79], v[48:51], a[232:239], v4
    ds_read_b128 v[112:115], v8 offset:6144
    v_add_f32 v84, v84, v85
    v_add_f32 v86, v86, v87
    v_smfmac_f32_16x16x64_bf16 v[76:79], v[52:55], a[248:255], v4
    v_cvt_pk_bf16_f32 v66, v80, v82
    v_cvt_pk_bf16_f32 v67, v84, v86
    v_add_f32 v72, v72, v73
    v_add_f32 v74, v74, v75
    v_cvt_pk_bf16_f32 v64, v72, v74
    s_nop 2
    v_add_f32 v76, v76, v77
    v_add_f32 v78, v78, v79
    v_cvt_pk_bf16_f32 v65, v76, v78
    ds_write_b128 v3, v[64:67] offset:12288
    s_cmp_eq_u32 s6, 63
    s_cbranch_scc1 L_chain_done
    s_barrier
    v_mov_b64 v[28:29], 0
    v_mov_b64 v[30:31], 0
    v_mov_b64 v[32:33], 0
    ds_read_b128 v[88:91], v8 offset:0
    v_mov_b64 v[34:35], 0
    ds_read_b128 v[92:95], v8 offset:1024
    v_mov_b64 v[36:37], 0
    ds_read_b128 v[116:119], v8 offset:7168
    v_mov_b64 v[38:39], 0
    ds_read_b128 v[120:123], v8 offset:8192
    v_mov_b64 v[40:41], 0
    ds_read_b128 v[124:127], v8 offset:9216
    v_mov_b64 v[42:43], 0
    ds_read_b128 v[64:67], v8 offset:14336
    v_mov_b64 v[44:45], 0
    ds_read_b128 v[68:71], v8 offset:15360
    v_mov_b64 v[46:47], 0
    v_mov_b64 v[48:49], 0
    v_mov_b64 v[50:51], 0
    v_mov_b64 v[52:53], 0
    v_mov_b64 v[54:55], 0
    v_mov_b64 v[72:73], 0
    v_mov_b64 v[74:75], 0
    s_barrier
    ds_read_b128 v[76:79], v6 offset:0
    ds_read_b128 v[80:83], v6 offset:1024
    s_waitcnt lgkmcnt(1)
FV_wo:
    v_smfmac_f32_16x16x64_bf16 v[28:31], v[76:79], v[88:95], v4
    s_waitcnt lgkmcnt(0)
    ds_read_b128 v[88:91], v8 offset:16384
    ds_read_b128 v[92:95], v8 offset:17408
    v_smfmac_f32_16x16x64_bf16 v[28:31], v[80:83], v[96:103], v4
    s_nop 0
    ds_read_b128 v[96:99], v8 offset:18432
    ds_read_b128 v[100:103], v8 offset:19456
    v_smfmac_f32_16x16x64_bf16 v[32:35], v[76:79], v[104:111], v4
    s_nop 0
    ds_read_b128 v[104:107], v8 offset:20480
    ds_read_b128 v[108:111], v8 offset:21504
    v_smfmac_f32_16x16x64_bf16 v[32:35], v[80:83], v[112:119], v4
    ds_read_b128 v[112:115], v8 offset:22528
    v_add_f32 v28, v28, v29
    v_smfmac_f32_16x16x64_bf16 v[36:39], v[76:79], v[120:127], v4
    ds_read_b128 v[116:119], v8 offset:23552
    v_add_f32 v30, v30, v31
    v_smfmac_f32_16x16x64_bf16 v[36:39], v[80:83], v[16:23], v4
    ds_read_b128 v[120:123], v8 offset:24576
    v_add_f32 v32, v32, v33
    v_add_f32 v34, v34, v35
    v_cmp_u_f32 vcc, v28, v30
    v_smfmac_f32_16x16x64_bf16 v[40:43], v[76:79], v[56:63], v4
    ds_read_b128 v[124:127], v8 offset:25600
    v_cvt_pk_bf16_f32 v84, v28, v32
    v_cvt_pk_bf16_f32 v86, v30, v34
    v_smfmac_f32_16x16x64_bf16 v[40:43], v[80:83], v[64:71], v4
    s_waitcnt lgkmcnt(8)
    ds_read_b128 v[16:19], v8 offset:26624
    v_add_f32 v36, v36, v37
    v_add_f32 v38, v38, v39
    v_smfmac_f32_16x16x64_bf16 v[44:47], v[76:79], v[88:95], v4
    s_cbranch_vccnz FV_oredo
FV_ook:
    s_waitcnt lgkmcnt(7)
    ds_read_b128 v[20:23], v8 offset:27648
    v_and_or_b32 v84, v84, -2, s97
    v_and_or_b32 v86, v86, -2, s97
    v_smfmac_f32_16x16x64_bf16 v[44:47], v[80:83], v[96:103], v4
    s_waitcnt lgkmcnt(6)
    v_add_f32 v40, v40, v41
    v_add_f32 v42, v42, v43
    v_cvt_pk_bf16_f32 v85, v36, v40
    v_cvt_pk_bf16_f32 v87, v38, v42
    v_and_or_b32 v85, v85, -2, s97
    v_and_or_b32 v87, v87, -2, s97
    buffer_store_dwordx4 v[84:87], v7, s[12:15], s45 offen
    ds_read_b128 v[56:59], v8 offset:28672
    ds_read_b128 v[60:63], v8 offset:29696
    v_smfmac_f32_16x16x64_bf16 v[48:51], v[76:79], v[104:111], v4
    s_waitcnt lgkmcnt(6)
    ds_read_b128 v[64:67], v8 offset:30720
    ds_read_b128 v[68:71], v8 offset:31744
    v_smfmac_f32_16x16x64_bf16 v[48:51], v[80:83], v[112:119], v4
    s_waitcnt lgkmcnt(6)
    v_add_f32 v44, v44, v45
    v_smfmac_f32_16x16x64_bf16 v[52:55], v[76:79], v[120:127], v4
    s_waitcnt lgkmcnt(4)
    v_add_f32 v46, v46, v47
    v_smfmac_f32_16x16x64_bf16 v[52:55], v[80:83], v[16:23], v4
    s_waitcnt lgkmcnt(2)
    v_add_f32 v48, v48, v49
    v_add_f32 v50, v50, v51
    v_smfmac_f32_16x16x64_bf16 v[72:75], v[76:79], v[56:63], v4
    s_waitcnt lgkmcnt(0)
    v_cvt_pk_bf16_f32 v24, v44, v48
    v_cvt_pk_bf16_f32 v26, v46, v50
    v_smfmac_f32_16x16x64_bf16 v[72:75], v[80:83], v[64:71], v4
    v_add_f32 v52, v52, v53
    v_add_f32 v54, v54, v55
    v_and_or_b32 v24, v24, -2, s97
    v_and_or_b32 v26, v26, -2, s97
    s_nop 3
    v_add_f32 v72, v72, v73
    v_add_f32 v74, v74, v75
    v_cvt_pk_bf16_f32 v25, v52, v72
    v_cvt_pk_bf16_f32 v27, v54, v74
    v_and_or_b32 v25, v25, -2, s97
    v_and_or_b32 v27, v27, -2, s97
    buffer_store_dwordx4 v[24:27], v7, s[12:15], s46 offen
    v_mov_b64 v[36:37], -1
    ds_read_b128 v[88:91], v8 offset:32768
    ds_read_b128 v[92:95], v8 offset:33792
    v_mov_b64 v[56:57], 0
    v_mov_b64 v[58:59], 0
    ds_read_b128 v[96:99], v8 offset:34816
    ds_read_b128 v[100:103], v8 offset:35840
    v_mov_b64 v[60:61], 0
    v_mov_b64 v[62:63], 0
    ds_read_b128 v[104:107], v8 offset:36864
    ds_read_b128 v[108:111], v8 offset:37888
    v_mov_b64 v[64:65], 0
    v_mov_b64 v[66:67], 0
    ds_read_b128 v[112:115], v8 offset:38912
    ds_read_b128 v[116:119], v8 offset:39936
    v_mov_b64 v[68:69], 0
    v_mov_b64 v[70:71], 0
    ds_read_b128 v[120:123], v8 offset:40960
    ds_read_b128 v[124:127], v8 offset:41984
    v_mov_b64 v[72:73], 0
    v_mov_b64 v[74:75], 0
    v_mov_b64 v[24:25], -1
    v_mov_b64 v[26:27], -1
    v_mov_b64 v[76:77], 0
    v_mov_b64 v[78:79], 0
    v_mov_b64 v[80:81], 0
    v_mov_b64 v[82:83], 0
    v_mov_b64 v[84:85], 0
    v_mov_b64 v[86:87], 0
    v_mov_b64 v[16:17], -1
    v_mov_b64 v[18:19], -1
    v_mov_b32 v2, 0
    s_nop 2
    v_mov_b32 v2, 0
    s_nop 2
    v_mov_b32 v2, 0
    s_nop 2
    v_mov_b32 v2, 0
    s_nop 2
    v_mov_b32 v2, 0
    s_nop 2
    v_mov_b32 v2, 0
    s_nop 2
    v_mov_b32 v2, 0
    s_nop 2
    buffer_load_dwordx4 v[28:31], v0, s[12:15], s47 offen sc1
    buffer_load_dwordx4 v[32:35], v0, s[12:15], s47 offen offset:1024 sc1
    v_mov_b32 v2, 0
    s_nop 2
    v_mov_b32 v2, 0
    s_nop 2
    v_mov_b32 v2, 0
    s_nop 2
    v_mov_b32 v2, 0
    s_nop 2
    v_mov_b32 v2, 0
    s_nop 2
    v_mov_b32 v2, 0
    s_nop 2
    v_mov_b32 v2, 0
    s_nop 2
    v_mov_b32 v2, 0
    s_nop 2
    v_mov_b32 v2, 0
    s_nop 2
    buffer_load_dwordx4 v[48:51], v0, s[12:15], s47 offen sc1
    buffer_load_dwordx4 v[52:55], v0, s[12:15], s47 offen offset:1024 sc1
    s_mov_b32 s96, 0
    v_mov_b32 v2, 0
    s_nop 2
    v_mov_b32 v2, 0
    s_nop 2
    v_mov_b32 v2, 0
    s_nop 2
    v_mov_b32 v2, 0
    s_nop 2
    s_nop 0
    s_nop 0
    s_nop 0
    s_nop 0
    s_nop 0
    s_nop 0
    s_nop 0
    s_waitcnt vmcnt(2)
FV_r10:
    v_mfma_f32_16x16x32_bf16 v[40:43], v[12:15], v[28:31], 0
    v_bitop3_b32 v44, v28, v29, s98 bitop3:0xbd
    v_bitop3_b32 v45, v30, v31, s98 bitop3:0xbd
    v_mfma_f32_16x16x32_bf16 v[40:43], v[12:15], v[32:35], v[40:43]
    v_bitop3_b32 v46, v32, v33, s98 bitop3:0xbd
    v_bitop3_b32 v47, v34, v35, s98 bitop3:0xbd
    v_or3_b32 v44, v44, v45, v46
    v_bitop3_b32 v44, v44, v47, 1 bitop3:0xa8
    v_cmp_ne_u32 vcc, 0, v44
    s_nop 2
    v_add_f32_dpp v38, v40, v40 row_ror:4 row_mask:0xf bank_mask:0x5
    v_add_f32_dpp v39, v41, v41 row_ror:4 row_mask:0xf bank_mask:0x5
    v_add_f32_dpp v38, v42, v42 row_ror:4 row_mask:0xf bank_mask:0xa
    v_add_f32_dpp v39, v43, v43 row_ror:4 row_mask:0xf bank_mask:0xa
    s_cbranch_vccnz FV_r11
FV_r1ok:
    v_add_f32_dpp v38, v38, v38 row_ror:8 row_mask:0xf bank_mask:0xf
    v_add_f32_dpp v39, v39, v39 row_ror:8 row_mask:0xf bank_mask:0xf
    s_mov_b64 exec, s[58:59]
    v_cvt_pk_bf16_f32 v38, v38, v39
    buffer_store_dword v38, v1, s[12:15], s48 offen
    buffer_store_dword v36, v1, s[12:15], s51 offen
    s_mov_b64 exec, -1
    buffer_load_dwordx4 v[24:27], v0, s[12:15], s49 offen sc1
    v_mov_b32 v2, 0
    s_nop 2
    v_mov_b32 v2, 0
    s_nop 2
    v_mov_b32 v2, 0
    s_nop 2
    buffer_load_dwordx4 v[24:27], v0, s[12:15], s49 offen sc1
    s_mov_b32 s80, s6
    s_add_u32 s6, s6, 1
    s_add_u32 s53, s53, 0x20000
    s_mov_b32 s96, 0
    v_mov_b32 v2, 0
    s_mov_b32 s51, s48
    s_and_b32 s7, s6, 3
    s_lshl_b32 s48, s7, 13
    s_add_u32 s48, s48, 65536
    s_lshr_b32 s97, s7, 1
    s_sub_u32 s98, s97, 1
    s_mov_b32 s99, s98
    s_and_b32 s7, s7, 1
    s_lshl_b32 s7, s7, 18
    s_add_u32 s45, s7, 1048576
    s_add_u32 s46, s45, 0x1000
    s_add_u32 s47, s44, s7
    s_waitcnt lgkmcnt(0)
    s_nop 0
    s_nop 0
    v_mov_b32_e64 v11, 0
    s_nop 0
FV_r2:
    v_max3_u32 v2, v24, v25, v26
    v_max_u32 v2, v2, v27
    v_cmp_eq_u32 vcc, -1, v2
    s_cbranch_vccz FV_loop
    v_max3_u32 v2, v24, v25, v26
    v_max_u32 v2, v2, v27
    v_cmp_eq_u32 vcc, -1, v2
    s_cbranch_vccz FV_loop
    s_mov_b64 exec, vcc
    buffer_load_dwordx4 v[24:27], v0, s[12:15], s49 offen sc1
    s_mov_b64 exec, -1
    s_add_u32 s96, s96, 1
    s_cmp_lt_u32 s96, 1333333
    s_cbranch_scc1 FV_r2
    s_branch L_bail
FV_r11:
    s_mov_b64 exec, vcc
    buffer_load_dwordx4 v[28:31], v0, s[12:15], s47 offen sc1
    buffer_load_dwordx4 v[32:35], v0, s[12:15], s47 offen offset:1024 sc1
    s_mov_b64 exec, -1
    s_waitcnt vmcnt(2)
    v_mfma_f32_16x16x32_bf16 v[40:43], v[12:15], v[48:51], 0
    v_bitop3_b32 v44, v48, v49, s98 bitop3:0xbd
    v_bitop3_b32 v45, v50, v51, s98 bitop3:0xbd
    v_mfma_f32_16x16x32_bf16 v[40:43], v[12:15], v[52:55], v[40:43]
    v_bitop3_b32 v46, v52, v53, s98 bitop3:0xbd
    v_bitop3_b32 v47, v54, v55, s98 bitop3:0xbd
    v_or3_b32 v44, v44, v45, v46
    v_bitop3_b32 v44, v44, v47, 1 bitop3:0xa8
    v_cmp_ne_u32 vcc, 0, v44
    s_nop 2
    v_add_f32_dpp v38, v40, v40 row_ror:4 row_mask:0xf bank_mask:0x5
    v_add_f32_dpp v39, v41, v41 row_ror:4 row_mask:0xf bank_mask:0x5
    v_add_f32_dpp v38, v42, v42 row_ror:4 row_mask:0xf bank_mask:0xa
    v_add_f32_dpp v39, v43, v43 row_ror:4 row_mask:0xf bank_mask:0xa
    s_cbranch_vccz FV_r1ok
    s_mov_b64 exec, vcc
    buffer_load_dwordx4 v[48:51], v0, s[12:15], s47 offen sc1
    buffer_load_dwordx4 v[52:55], v0, s[12:15], s47 offen offset:1024 sc1
    s_mov_b64 exec, -1
    s_waitcnt vmcnt(2)
    s_add_u32 s96, s96, 1
    s_cmp_lt_u32 s96, 1333333
    s_cbranch_scc1 FV_r10
    s_branch L_bail
FV_lretry:
FV_lr2:
    s_mov_b64 exec, vcc
    buffer_load_dwordx4 v[40:43], v0, s[12:15], s50 offen sc1
    s_mov_b64 exec, -1
    s_waitcnt vmcnt(0)
    v_max3_u32 v2, v40, v41, v42
    v_max_u32 v2, v2, v43
    v_cmp_eq_u32 vcc, -1, v2
    ds_write_b128 v3, v[40:43] offset:4096
    s_waitcnt lgkmcnt(0)
    s_cbranch_vccz FV_lok
    s_add_u32 s96, s96, 1
    s_cmp_lt_u32 s96, 1333333
    s_cbranch_scc1 FV_lr2
    s_branch L_bail
FV_oredo:
    v_max3_u32 v2, v76, v77, v78
    v_max_u32 v2, v2, v79
    v_max_u32 v2, v2, v80
    v_max_u32 v2, v2, v81
    v_max_u32 v2, v2, v82
    v_max_u32 v2, v2, v83
    v_cmp_eq_u32 vcc, -1, v2
    s_cbranch_vccz FV_ook
    s_mov_b32 s96, 0
FV_or1:
    ds_read_b128 v[76:79], v6 offset:0
    ds_read_b128 v[80:83], v6 offset:1024
    s_waitcnt lgkmcnt(0)
    v_max3_u32 v2, v76, v77, v78
    v_max_u32 v2, v2, v79
    v_max_u32 v2, v2, v80
    v_max_u32 v2, v2, v81
    v_max_u32 v2, v2, v82
    v_max_u32 v2, v2, v83
    v_cmp_eq_u32 vcc, -1, v2
    s_cbranch_vccz FV_or2
    s_add_u32 s96, s96, 1
    s_cmp_lt_u32 s96, 1333333
    s_cbranch_scc1 FV_or1
    s_branch L_bail
FV_or2:
    v_mov_b64 v[28:29], 0
    v_mov_b64 v[30:31], 0
    v_mov_b64 v[32:33], 0
    v_mov_b64 v[34:35], 0
    v_mov_b64 v[36:37], 0
    v_mov_b64 v[38:39], 0
    v_mov_b64 v[40:41], 0
    v_mov_b64 v[42:43], 0
    v_mov_b64 v[44:45], 0
    v_mov_b64 v[46:47], 0
    ds_read_b128 v[88:91], v8 offset:0
    ds_read_b128 v[92:95], v8 offset:1024
    ds_read_b128 v[96:99], v8 offset:2048
    ds_read_b128 v[100:103], v8 offset:3072
    ds_read_b128 v[104:107], v8 offset:4096
    ds_read_b128 v[108:111], v8 offset:5120
    ds_read_b128 v[112:115], v8 offset:6144
    ds_read_b128 v[116:119], v8 offset:7168
    ds_read_b128 v[120:123], v8 offset:8192
    ds_read_b128 v[124:127], v8 offset:9216
    ds_read_b128 v[16:19], v8 offset:10240
    ds_read_b128 v[20:23], v8 offset:11264
    ds_read_b128 v[56:59], v8 offset:12288
    ds_read_b128 v[60:63], v8 offset:13312
    ds_read_b128 v[64:67], v8 offset:14336
    ds_read_b128 v[68:71], v8 offset:15360
    s_waitcnt lgkmcnt(0)
    s_branch FV_wo
.p2align 6
    s_nop 0
    s_nop 0
    s_nop 0
    s_nop 0
SA_loop:
    ds_write_b128 v3, v[24:27]
    v_smfmac_f32_16x16x64_bf16 v[56:59], v[24:27], v[128:135], v4
    v_add_u32 v44, s81, v0
    v_smfmac_f32_16x16x64_bf16 v[64:67], v[24:27], a[0:7], v4
    v_add_u32 v48, s82, v0
    v_smfmac_f32_16x16x64_bf16 v[60:63], v[24:27], v[136:143], v4
    s_mov_b64 exec, s[88:89]
    buffer_load_dwordx4 v[40:43], v0, s[12:15], s50 offen sc1
    s_mov_b64 exec, -1
    v_add_u32 v52, s83, v0
    v_smfmac_f32_16x16x64_bf16 v[68:71], v[24:27], a[8:15], v4
    s_waitcnt lgkmcnt(0)
    s_barrier
    ds_read_b128 v[28:31], v44 offset:0
    ds_read_b128 v[32:35], v48 offset:0
    ds_read_b128 v[36:39], v52 offset:0
    buffer_load_dwordx4 v[104:107], v0, s[12:15], s57 offen offset:0
    buffer_load_dwordx4 v[108:111], v0, s[12:15], s57 offen offset:1024
    buffer_load_dwordx4 v[112:115], v0, s[12:15], s57 offen offset:2048
    buffer_load_dwordx4 v[116:119], v0, s[12:15], s57 offen offset:3072
    s_waitcnt lgkmcnt(2)
    v_smfmac_f32_16x16x64_bf16 v[56:59], v[28:31], v[144:151], v4
    v_lshlrev_b32 v21, 2, v0
    v_smfmac_f32_16x16x64_bf16 v[60:63], v[28:31], v[152:159], v4
    buffer_load_dword v21, v21, s[12:15], s56 offen
    s_waitcnt lgkmcnt(0)
    v_smfmac_f32_16x16x64_bf16 v[56:59], v[32:35], v[160:167], v4
    buffer_load_dwordx4 a[224:227], v0, s[12:15], s52 offen offset:0
    v_smfmac_f32_16x16x64_bf16 v[60:63], v[32:35], v[168:175], v4
    buffer_load_dwordx4 a[228:231], v0, s[12:15], s52 offen offset:1024
    v_smfmac_f32_16x16x64_bf16 v[56:59], v[36:39], v[176:183], v4
    buffer_load_dwordx4 a[232:235], v0, s[12:15], s52 offen offset:2048
    v_smfmac_f32_16x16x64_bf16 v[60:63], v[36:39], v[184:191], v4
    buffer_load_dwordx4 a[236:239], v0, s[12:15], s52 offen offset:3072
    v_smfmac_f32_16x16x64_bf16 v[64:67], v[28:31], a[16:23], v4
    s_waitcnt vmcnt(9)
    ds_write_b128 v3, v[40:43] offset:4096
    v_smfmac_f32_16x16x64_bf16 v[68:71], v[28:31], a[24:31], v4
    buffer_load_dwordx4 a[240:243], v0, s[12:15], s87 offen offset:0
    v_max3_u32 v2, v40, v41, v42
    v_smfmac_f32_16x16x64_bf16 v[64:67], v[32:35], a[32:39], v4
    buffer_load_dwordx4 a[244:247], v0, s[12:15], s87 offen offset:1024
    v_max_u32 v2, v2, v43
    v_smfmac_f32_16x16x64_bf16 v[68:71], v[32:35], a[40:47], v4
    buffer_load_dwordx4 a[248:251], v0, s[12:15], s87 offen offset:2048
    v_cmp_eq_u32 vcc, -1, v2
    v_smfmac_f32_16x16x64_bf16 v[64:67], v[36:39], a[48:55], v4
    buffer_load_dwordx4 a[252:255], v0, s[12:15], s87 offen offset:3072
    v_smfmac_f32_16x16x64_bf16 v[68:71], v[36:39], a[56:63], v4
    s_cbranch_vccnz SA_lretry
SA_lok:
    s_waitcnt lgkmcnt(0)
    s_barrier
    ds_read_b128 v[44:47], v44 offset:4096
    v_smfmac_f32_16x16x64_bf16 v[56:59], v[40:43], v[192:199], v4
    buffer_load_dwordx2 v[10:11], off, s[12:15], s55 sc1
    ds_read_b128 v[48:51], v48 offset:4096
    ds_read_b128 v[52:55], v52 offset:4096
    v_smfmac_f32_16x16x64_bf16 v[60:63], v[40:43], v[200:207], v4
    s_waitcnt lgkmcnt(2)
    v_mov_b32 v2, s80
    v_smfmac_f32_16x16x64_bf16 v[56:59], v[44:47], v[208:215], v4
    s_mov_b64 exec, 1
    buffer_store_dword v2, off, s[12:15], s54 sc1
    s_mov_b64 exec, -1
    v_mov_b64 v[24:25], -1
    v_smfmac_f32_16x16x64_bf16 v[60:63], v[44:47], v[216:223], v4
    s_waitcnt lgkmcnt(0)
    v_mov_b64 v[26:27], -1
    v_smfmac_f32_16x16x64_bf16 v[56:59], v[48:51], v[224:231], v4
    ds_write_b128 v3, v[24:27] offset:12288
    v_smfmac_f32_16x16x64_bf16 v[60:63], v[48:51], v[232:239], v4
    v_smfmac_f32_16x16x64_bf16 v[56:59], v[52:55], v[240:247], v4
    ds_write_b128 v3, v[24:27] offset:14336
    v_smfmac_f32_16x16x64_bf16 v[60:63], v[52:55], v[248:255], v4
    v_smfmac_f32_16x16x64_bf16 v[64:67], v[40:43], a[64:71], v4
    v_add_f32 v56, v56, v57
    v_add_f32 v58, v58, v59
    v_smfmac_f32_16x16x64_bf16 v[68:71], v[40:43], a[72:79], v4
    v_add_f32 v60, v60, v61
    v_add_f32 v62, v62, v63
    v_cvt_pk_bf16_f32 v56, v56, v60
    v_cvt_pk_bf16_f32 v57, v58, v62
    v_smfmac_f32_16x16x64_bf16 v[64:67], v[44:47], a[80:87], v4
    ds_write2_b32 v5, v56, v57 offset0:0 offset1:4
    v_smfmac_f32_16x16x64_bf16 v[68:71], v[44:47], a[88:95], v4
    s_nop 0
    s_nop 0
    s_nop 0
    v_smfmac_f32_16x16x64_bf16 v[64:67], v[48:51], a[96:103], v4
    s_add_u32 s49, s48, s86
    s_add_u32 s50, s49, 0x1000
    v_smfmac_f32_16x16x64_bf16 v[68:71], v[48:51], a[104:111], v4
    s_mov_b64 s[88:89], -1
    s_nop 0
    v_smfmac_f32_16x16x64_bf16 v[64:67], v[52:55], a[112:119], v4
    s_nop 0
    s_nop 0
    s_nop 0
    v_smfmac_f32_16x16x64_bf16 v[68:71], v[52:55], a[120:127], v4
    s_waitcnt lgkmcnt(0)
    s_barrier
    ds_read_b128 v[24:27], v8 offset:0
    ds_read_b128 v[28:31], v8 offset:1024
    ds_read_b128 v[32:35], v8 offset:2048
    ds_read_b128 v[36:39], v8 offset:3072
    v_add_f32 v64, v64, v65
    v_add_f32 v66, v66, v67
    v_add_f32 v68, v68, v69
    v_add_f32 v70, v70, v71
    v_cvt_pk_bf16_f32 v64, v64, v68
    v_cvt_pk_bf16_f32 v65, v66, v70
    ds_write2_b32 v5, v64, v65 offset0:128 offset1:132
    s_waitcnt lgkmcnt(4)
    v_mfma_f32_16x16x32_bf16 v[56:59], v[72:75], v[24:27], 0
    s_waitcnt lgkmcnt(3)
    v_mov_b32 v65, 0
    v_mov_b32 v67, 0
    v_mfma_f32_16x16x32_bf16 v[56:59], v[76:79], v[28:31], v[56:59]
    buffer_store_dwordx4 v[124:127], v0, s[12:15], s53 offen offset:2048 sc1
    s_waitcnt lgkmcnt(2)
    v_mfma_f32_16x16x32_bf16 v[56:59], v[80:83], v[32:35], v[56:59]
    s_waitcnt lgkmcnt(1)
    v_mov_b32 v68, 0
    v_mov_b32 v70, 0
    v_mfma_f32_16x16x32_bf16 v[56:59], v[84:87], v[36:39], v[56:59]
    buffer_store_dwordx4 v[120:123], v0, s[12:15], s53 offen offset:0 sc1
    v_mfma_f32_16x16x32_bf16 v[60:63], v[88:91], v[24:27], 0
    s_waitcnt lgkmcnt(0)
    s_barrier
    ds_read_b128 v[40:43], v8 offset:512
    v_mfma_f32_16x16x32_bf16 v[60:63], v[92:95], v[28:31], v[60:63]
    ds_read_b128 v[44:47], v8 offset:1536
    ds_read_b128 v[48:51], v8 offset:2560
    s_waitcnt vmcnt(13)
    v_mfma_f32_16x16x32_bf16 v[60:63], v[96:99], v[32:35], v[60:63]
    ds_read_b128 v[52:55], v8 offset:3584
    v_max3_f32 v124, v56, v57, v58
    v_mfma_f32_16x16x32_bf16 v[60:63], v[100:103], v[36:39], v[60:63]
    s_waitcnt lgkmcnt(3)
    v_mfma_f32_16x16x32_bf16 v[120:123], v[40:43], v[24:27], 0
    s_nop 0
    s_nop 0
    s_waitcnt lgkmcnt(2)
    v_mfma_f32_16x16x32_bf16 v[120:123], v[44:47], v[28:31], v[120:123]
    s_waitcnt lgkmcnt(1)
    v_max3_f32 v125, v59, v60, v61
    v_max3_f32 v124, v124, v62, v63
    v_mfma_f32_16x16x32_bf16 v[120:123], v[48:51], v[32:35], v[120:123]
    s_waitcnt lgkmcnt(0)
    v_max_f32 v126, v124, v125
    v_max_f32 v127, v124, v125
    v_mfma_f32_16x16x32_bf16 v[120:123], v[52:55], v[36:39], v[120:123]
    s_cmp_eq_u32 s6, 63
    s_cbranch_scc1 L_chain_end
    v_permlane16_swap_b32 v126, v127
    v_max_f32 v124, v126, v127
    v_max_f32 v125, v126, v127
    v_mov_b64 v[40:41], 0
    v_mov_b64 v[42:43], 0
    v_permlane32_swap_b32 v124, v125
    v_max3_f32 v124, v124, v125, v20
    v_mul_f32 v124, s42, v124
    v_fma_f32 v56, v56, s42, -v124
    v_fma_f32 v57, v57, s42, -v124
    v_fma_f32 v58, v58, s42, -v124
    v_fma_f32 v59, v59, s42, -v124
    v_fma_f32 v60, v60, s42, -v124
    v_fma_f32 v61, v61, s42, -v124
    v_fma_f32 v62, v62, s42, -v124
    v_fma_f32 v63, v63, s42, -v124
    v_exp_f32 v56, v56
    v_exp_f32 v57, v57
    v_exp_f32 v58, v58
    v_cvt_pk_bf16_f32 v48, v56, v57
    v_exp_f32 v59, v59
    v_exp_f32 v60, v60
    v_cvt_pk_bf16_f32 v49, v58, v59
    v_exp_f32 v61, v61
    v_exp_f32 v62, v62
    v_cvt_pk_bf16_f32 v50, v60, v61
    v_exp_f32 v63, v63
    v_fma_f32 v120, v120, s42, -v124
    v_cvt_pk_bf16_f32 v51, v62, v63
    v_fma_f32 v121, v121, s42, -v124
    v_exp_f32 v122, v120
    v_mfma_f32_16x16x32_bf16 v[44:47], v[16:19], v[48:51], 0
    v_mov_b32_dpp v52, v48 quad_perm:[2,3,0,1] row_mask:0xf bank_mask:0xf
    v_mov_b32_dpp v53, v49 quad_perm:[2,3,0,1] row_mask:0xf bank_mask:0xf
    v_mfma_f32_16x16x32_bf16 v[28:31], v[104:107], v[48:51], 0
    v_mov_b32_dpp v54, v50 quad_perm:[2,3,0,1] row_mask:0xf bank_mask:0xf
    v_mov_b32_dpp v55, v51 quad_perm:[2,3,0,1] row_mask:0xf bank_mask:0xf
    v_mfma_f32_16x16x32_bf16 v[32:35], v[108:111], v[48:51], 0
    v_exp_f32 v123, v121
    v_max_f32 v125, v120, v121
    v_mfma_f32_16x16x32_bf16 v[28:31], v[112:115], v[52:55], v[28:31]
    s_barrier
    ds_read_b128 v[24:27], v3 offset:14336
    v_cvt_pk_bf16_f32 v64, v122, v123
    v_cvt_pk_bf16_f32 v69, v122, v123
    v_mfma_f32_16x16x32_bf16 v[32:35], v[116:119], v[52:55], v[32:35]
    v_mov_b32_dpp v66, v64 quad_perm:[2,3,0,1] row_mask:0xf bank_mask:0xf
    v_mov_b32_dpp v71, v64 quad_perm:[2,3,0,1] row_mask:0xf bank_mask:0xf
    v_mfma_f32_16x16x16_bf16 v[44:47], v[16:17], v[64:65], v[44:47]
    v_cmp_lt_f32 vcc, s78, v125
    v_mov_b64 v[36:37], 0
    v_mov_b64 v[38:39], 0
    v_cndmask_b32 v126, 0, v23, vcc
    s_waitcnt lgkmcnt(0)
    v_mfma_f32_16x16x32_bf16 v[28:31], v[24:27], v[64:67], v[28:31]
    v_max3_u32 v2, v24, v25, v26
    v_max3_u32 v2, v2, v27, v126
    v_mfma_f32_16x16x32_bf16 v[32:35], v[24:27], v[68:71], v[32:35]
    v_cmp_eq_u32 vcc, -1, v2
    v_add_f32_dpp v124, v44, v44 quad_perm:[2,3,0,1] row_mask:0xf bank_mask:0xf
    v_rcp_f32 v124, v124
    s_cbranch_vccnz SA_vredo
SA_vok:
    v_mul_f32 v28, v28, v124
    v_mul_f32 v29, v29, v124
    v_mul_f32 v30, v30, v124
    v_mul_f32 v31, v31, v124
    v_pk_mul_f32 v[32:33], v[32:33], v[124:125] op_sel_hi:[1,0]
    v_pk_mul_f32 v[34:35], v[34:35], v[124:125] op_sel_hi:[1,0]
    v_cvt_pk_bf16_f32 v120, v28, v32
    v_cvt_pk_bf16_f32 v121, v29, v33
    v_cvt_pk_bf16_f32 v122, v30, v34
    v_cvt_pk_bf16_f32 v123, v31, v35
    ds_write_b128 v9, v[120:123]
    s_barrier
    ds_read_b128 v[120:123], v6 offset:0
    ds_read_b128 v[124:127], v6 offset:1024
    v_mov_b64 v[56:57], 0
    v_mov_b64 v[58:59], 0
    v_mov_b64 v[60:61], 0
    v_mov_b64 v[62:63], 0
    v_mov_b64 v[28:29], 0
    v_mov_b64 v[30:31], 0
    v_mov_b64 v[32:33], 0
    v_mov_b64 v[34:35], 0
    s_waitcnt lgkmcnt(1)
SA_wo:
    v_smfmac_f32_16x16x64_bf16 v[56:59], v[120:123], a[128:135], v4
    s_waitcnt lgkmcnt(0)
    v_mov_b64 v[24:25], 0
    v_smfmac_f32_16x16x64_bf16 v[56:59], v[124:127], a[136:143], v4
    s_nop 0
    s_nop 0
    v_mov_b64 v[26:27], 0
    v_smfmac_f32_16x16x64_bf16 v[60:63], v[120:123], a[144:151], v4
    s_nop 0
    ds_read_b128 v[72:75], v3 offset:16384
    v_mov_b64 v[44:45], 0
    v_smfmac_f32_16x16x64_bf16 v[60:63], v[124:127], a[152:159], v4
    s_nop 0
    ds_read_b128 v[76:79], v3 offset:18432
    v_add_f32 v56, v56, v57
    v_smfmac_f32_16x16x64_bf16 v[28:31], v[120:123], a[160:167], v4
    ds_read_b128 v[80:83], v3 offset:20480
    v_add_f32 v58, v58, v59
    v_smfmac_f32_16x16x64_bf16 v[28:31], v[124:127], a[168:175], v4
    ds_read_b128 v[84:87], v3 offset:22528
    v_add_f32 v60, v60, v61
    v_add_f32 v62, v62, v63
    v_cmp_u_f32 vcc, v56, v58
    v_smfmac_f32_16x16x64_bf16 v[32:35], v[120:123], a[176:183], v4
    ds_read_b128 v[88:91], v3 offset:24576
    v_cvt_pk_bf16_f32 v64, v56, v60
    v_cvt_pk_bf16_f32 v66, v58, v62
    v_smfmac_f32_16x16x64_bf16 v[32:35], v[124:127], a[184:191], v4
    ds_read_b128 v[92:95], v3 offset:26624
    v_add_f32 v28, v28, v29
    v_add_f32 v30, v30, v31
    v_smfmac_f32_16x16x64_bf16 v[24:27], v[120:123], a[192:199], v4
    s_cbranch_vccnz SA_oredo
SA_ook:
    ds_read_b128 v[96:99], v3 offset:28672
    v_and_or_b32 v64, v64, -2, s97
    v_and_or_b32 v66, v66, -2, s97
    v_smfmac_f32_16x16x64_bf16 v[24:27], v[124:127], a[200:207], v4
    ds_read_b128 v[100:103], v3 offset:30720
    v_add_f32 v32, v32, v33
    v_add_f32 v34, v34, v35
    v_cvt_pk_bf16_f32 v65, v28, v32
    v_cvt_pk_bf16_f32 v67, v30, v34
    v_and_or_b32 v65, v65, -2, s97
    v_and_or_b32 v67, v67, -2, s97
    buffer_store_dwordx4 v[64:67], v7, s[12:15], s45 offen sc1
    v_smfmac_f32_16x16x64_bf16 v[36:39], v[120:123], a[208:215], v4
    s_nop 0
    s_nop 0
    v_mov_b64 v[46:47], 0
    v_smfmac_f32_16x16x64_bf16 v[36:39], v[124:127], a[216:223], v4
    s_waitcnt lgkmcnt(0)
    v_add_f32 v24, v24, v25
    v_smfmac_f32_16x16x64_bf16 v[40:43], v[120:123], v[72:79], v4
    s_nop 0
    v_add_f32 v26, v26, v27
    v_smfmac_f32_16x16x64_bf16 v[40:43], v[124:127], v[80:87], v4
    v_add_f32 v36, v36, v37
    v_add_f32 v38, v38, v39
    v_smfmac_f32_16x16x64_bf16 v[44:47], v[120:123], v[88:95], v4
    v_cvt_pk_bf16_f32 v68, v24, v36
    v_cvt_pk_bf16_f32 v70, v26, v38
    v_smfmac_f32_16x16x64_bf16 v[44:47], v[124:127], v[96:103], v4
    v_add_f32 v40, v40, v41
    v_add_f32 v42, v42, v43
    v_and_or_b32 v68, v68, -2, s97
    v_and_or_b32 v70, v70, -2, s97
    s_nop 3
    v_add_f32 v44, v44, v45
    v_add_f32 v46, v46, v47
    v_cvt_pk_bf16_f32 v69, v40, v44
    v_cvt_pk_bf16_f32 v71, v42, v46
    v_and_or_b32 v69, v69, -2, s97
    v_and_or_b32 v71, v71, -2, s97
    buffer_store_dwordx4 v[68:71], v7, s[12:15], s46 offen sc1
    v_mov_b64 v[36:37], -1
    ds_read_b128 v[120:123], v22
    ds_read_b128 v[124:127], v3 offset:14336
    v_mov_b64 v[24:25], -1
    v_mov_b64 v[26:27], -1
    v_mov_b64 v[56:57], 0
    v_mov_b64 v[58:59], 0
    v_mov_b64 v[60:61], 0
    v_mov_b64 v[62:63], 0
    v_mov_b64 v[64:65], 0
    v_mov_b64 v[66:67], 0
    v_mov_b64 v[68:69], 0
    v_mov_b64 v[70:71], 0
    v_mov_b32 v2, 0
    s_nop 2
    v_mov_b32 v2, 0
    s_nop 2
    buffer_load_dwordx4 v[28:31], v0, s[12:15], s47 offen sc1
    buffer_load_dwordx4 v[32:35], v0, s[12:15], s47 offen offset:1024 sc1
    v_mov_b32 v2, 0
    s_nop 2
    v_mov_b32 v2, 0
    s_nop 2
    v_mov_b32 v2, 0
    s_nop 2
    v_mov_b32 v2, 0
    s_nop 2
    v_mov_b32 v2, 0
    s_nop 2
    v_mov_b32 v2, 0
    s_nop 2
    v_mov_b32 v2, 0
    s_nop 2
    v_mov_b32 v2, 0
    s_nop 2
    v_mov_b32 v2, 0
    s_nop 2
    buffer_load_dwordx4 v[48:51], v0, s[12:15], s47 offen sc1
    buffer_load_dwordx4 v[52:55], v0, s[12:15], s47 offen offset:1024 sc1
    v_readfirstlane_b32 s84, v10
    v_readfirstlane_b32 s85, v11
    s_mov_b32 s57, s56
    s_add_u32 s90, s6, 2
    s_cmp_lt_u32 s90, 64
    s_cselect_b32 s7, 540672, 0
    s_add_u32 s52, s52, s7
    s_min_u32 s90, s90, 63
    s_lshr_b32 s91, s90, 1
    s_bitcmp1_b32 s90, 0
    s_cselect_b32 s7, s85, s84
    s_cmp_gt_u32 s7, s91
    s_cbranch_scc0 SA_fbwait
SA_fbok:
    s_add_u32 s87, s52, 0x1000
    s_add_u32 s56, s52, s95
    s_waitcnt lgkmcnt(0)
    s_mov_b32 s96, 0
    s_nop 0
    s_nop 0
    s_nop 0
    s_nop 0
    s_nop 0
    s_nop 0
    s_nop 0
    s_waitcnt vmcnt(2)
SA_r10:
    v_mfma_f32_16x16x32_bf16 v[40:43], v[12:15], v[28:31], 0
    v_bitop3_b32 v44, v28, v29, s98 bitop3:0xbd
    v_bitop3_b32 v45, v30, v31, s98 bitop3:0xbd
    v_mfma_f32_16x16x32_bf16 v[40:43], v[12:15], v[32:35], v[40:43]
    v_bitop3_b32 v46, v32, v33, s98 bitop3:0xbd
    v_bitop3_b32 v47, v34, v35, s98 bitop3:0xbd
    v_or3_b32 v44, v44, v45, v46
    v_bitop3_b32 v44, v44, v47, 1 bitop3:0xa8
    v_cmp_ne_u32 vcc, 0, v44
    s_nop 2
    v_add_f32_dpp v38, v40, v40 row_ror:4 row_mask:0xf bank_mask:0x5
    v_add_f32_dpp v39, v41, v41 row_ror:4 row_mask:0xf bank_mask:0x5
    v_add_f32_dpp v38, v42, v42 row_ror:4 row_mask:0xf bank_mask:0xa
    v_add_f32_dpp v39, v43, v43 row_ror:4 row_mask:0xf bank_mask:0xa
    s_cbranch_vccnz SA_r11
SA_r1ok:
    v_add_f32_dpp v38, v38, v38 row_ror:8 row_mask:0xf bank_mask:0xf
    v_add_f32_dpp v39, v39, v39 row_ror:8 row_mask:0xf bank_mask:0xf
    s_mov_b64 exec, s[58:59]
    v_cvt_pk_bf16_f32 v38, v38, v39
    buffer_store_dword v38, v1, s[12:15], s48 offen sc1
    buffer_store_dword v36, v1, s[12:15], s51 offen sc1
    s_mov_b64 exec, -1
    s_waitcnt vmcnt(9)
    v_accvgpr_read_b32 v72, a224
    v_accvgpr_read_b32 v73, a225
    v_accvgpr_read_b32 v74, a226
    v_accvgpr_read_b32 v75, a227
    v_accvgpr_read_b32 v76, a228
    v_accvgpr_read_b32 v77, a229
    v_accvgpr_read_b32 v78, a230
    v_accvgpr_read_b32 v79, a231
    v_accvgpr_read_b32 v80, a232
    v_accvgpr_read_b32 v81, a233
    v_accvgpr_read_b32 v82, a234
    v_accvgpr_read_b32 v83, a235
    v_accvgpr_read_b32 v84, a236
    v_accvgpr_read_b32 v85, a237
    v_accvgpr_read_b32 v86, a238
    v_accvgpr_read_b32 v87, a239
    v_accvgpr_read_b32 v88, a240
    v_accvgpr_read_b32 v89, a241
    v_accvgpr_read_b32 v90, a242
    v_accvgpr_read_b32 v91, a243
    v_accvgpr_read_b32 v92, a244
    v_accvgpr_read_b32 v93, a245
    v_accvgpr_read_b32 v94, a246
    v_accvgpr_read_b32 v95, a247
    buffer_load_dwordx4 v[24:27], v0, s[12:15], s49 offen sc1
    v_accvgpr_read_b32 v96, a248
    v_accvgpr_read_b32 v97, a249
    v_accvgpr_read_b32 v98, a250
    v_accvgpr_read_b32 v99, a251
    v_accvgpr_read_b32 v100, a252
    v_accvgpr_read_b32 v101, a253
    v_accvgpr_read_b32 v102, a254
    v_accvgpr_read_b32 v103, a255
    s_mov_b32 s80, s6
    s_add_u32 s6, s6, 1
    s_add_u32 s53, s53, 0x20000
    s_mov_b32 s96, 0
    v_mov_b32 v2, 0
    s_mov_b32 s51, s48
    s_and_b32 s7, s6, 3
    s_lshl_b32 s48, s7, 13
    s_add_u32 s48, s48, 65536
    s_lshr_b32 s97, s7, 1
    s_sub_u32 s98, s97, 1
    s_mov_b32 s99, s98
    s_and_b32 s7, s7, 1
    s_lshl_b32 s7, s7, 18
    s_add_u32 s45, s7, 1048576
    s_add_u32 s46, s45, 0x1000
    s_add_u32 s47, s44, s7
    buffer_load_dwordx4 v[24:27], v0, s[12:15], s49 offen sc1
    s_waitcnt lgkmcnt(0)
    s_nop 0
SA_r2:
    v_max3_u32 v2, v24, v25, v26
    v_max_u32 v2, v2, v27
    v_cmp_eq_u32 vcc, -1, v2
    s_cbranch_vccz SA_loop
    v_max3_u32 v2, v24, v25, v26
    v_max_u32 v2, v2, v27
    v_cmp_eq_u32 vcc, -1, v2
    s_cbranch_vccz SA_loop
    s_mov_b64 exec, vcc
    buffer_load_dwordx4 v[24:27], v0, s[12:15], s49 offen sc1
    s_mov_b64 exec, -1
    s_add_u32 s96, s96, 1
    s_cmp_lt_u32 s96, 1333333
    s_cbranch_scc1 SA_r2
    s_branch L_bail
SA_r11:
    s_mov_b64 exec, vcc
    buffer_load_dwordx4 v[28:31], v0, s[12:15], s47 offen sc1
    buffer_load_dwordx4 v[32:35], v0, s[12:15], s47 offen offset:1024 sc1
    s_mov_b64 exec, -1
    s_waitcnt vmcnt(2)
    v_mfma_f32_16x16x32_bf16 v[40:43], v[12:15], v[48:51], 0
    v_bitop3_b32 v44, v48, v49, s98 bitop3:0xbd
    v_bitop3_b32 v45, v50, v51, s98 bitop3:0xbd
    v_mfma_f32_16x16x32_bf16 v[40:43], v[12:15], v[52:55], v[40:43]
    v_bitop3_b32 v46, v52, v53, s98 bitop3:0xbd
    v_bitop3_b32 v47, v54, v55, s98 bitop3:0xbd
    v_or3_b32 v44, v44, v45, v46
    v_bitop3_b32 v44, v44, v47, 1 bitop3:0xa8
    v_cmp_ne_u32 vcc, 0, v44
    s_nop 2
    v_add_f32_dpp v38, v40, v40 row_ror:4 row_mask:0xf bank_mask:0x5
    v_add_f32_dpp v39, v41, v41 row_ror:4 row_mask:0xf bank_mask:0x5
    v_add_f32_dpp v38, v42, v42 row_ror:4 row_mask:0xf bank_mask:0xa
    v_add_f32_dpp v39, v43, v43 row_ror:4 row_mask:0xf bank_mask:0xa
    s_cbranch_vccz SA_r1ok
    s_mov_b64 exec, vcc
    buffer_load_dwordx4 v[48:51], v0, s[12:15], s47 offen sc1
    buffer_load_dwordx4 v[52:55], v0, s[12:15], s47 offen offset:1024 sc1
    s_mov_b64 exec, -1
    s_waitcnt vmcnt(2)
    s_add_u32 s96, s96, 1
    s_cmp_lt_u32 s96, 1333333
    s_cbranch_scc1 SA_r10
    s_branch L_bail
SA_lretry:
SA_lr2:
    s_mov_b64 exec, vcc
    buffer_load_dwordx4 v[40:43], v0, s[12:15], s50 offen sc1
    s_mov_b64 exec, -1
    s_waitcnt vmcnt(0)
    v_max3_u32 v2, v40, v41, v42
    v_max_u32 v2, v2, v43
    v_cmp_eq_u32 vcc, -1, v2
    ds_write_b128 v3, v[40:43] offset:4096
    s_waitcnt lgkmcnt(0)
    s_cbranch_vccz SA_lok
    s_add_u32 s96, s96, 1
    s_cmp_lt_u32 s96, 1333333
    s_cbranch_scc1 SA_lr2
    s_branch L_bail
SA_fbwait:
    s_and_b32 s92, s90, 1
    s_lshl_b32 s92, s92, 2
    s_add_u32 s92, s92, s55
    s_add_u32 s93, s91, 1
    s_mov_b32 s96, 0
WS_32:
    buffer_load_dword v2, off, s[12:15], s92 sc1
    s_waitcnt vmcnt(0)
    v_readfirstlane_b32 s7, v2
    s_nop 3
    s_cmp_ge_u32 s7, s93
    s_cbranch_scc1 WSOK_33
    s_sleep 1
    s_add_u32 s96, s96, 1
    s_cmp_lt_u32 s96, 483091
    s_cbranch_scc1 WS_32
    s_branch L_bail
WSOK_33:
    s_branch SA_fbok
SA_vredo:
    s_mov_b32 s96, 0
SA_vr1:
    ds_read_b128 v[24:27], v3 offset:14336
    s_waitcnt lgkmcnt(0)
    v_max3_u32 v2, v24, v25, v26
    v_max_u32 v2, v2, v27
    v_cmp_eq_u32 vcc, -1, v2
    s_cbranch_vccz SA_vr2
    s_add_u32 s96, s96, 1
    s_cmp_lt_u32 s96, 1333333
    s_cbranch_scc1 SA_vr1
    s_branch L_bail
SA_vr2:
    v_cmp_lt_f32 vcc, s78, v125
    s_cbranch_vccz SA_vr3
    v_max_f32 v125, 0, v125
    v_mov_b32 v126, v125
    s_nop 1
    v_permlane16_swap_b32 v125, v126
    v_max_f32 v125, v125, v126
    v_mov_b32 v126, v125
    s_nop 1
    v_permlane32_swap_b32 v125, v126
    v_max_f32 v125, v125, v126
    s_nop 1
    v_max_f32_dpp v125, v125, v125 quad_perm:[2,3,0,1] row_mask:0xf bank_mask:0xf
    v_sub_f32 v120, v120, v125
    v_sub_f32 v121, v121, v125
    v_sub_f32 v125, 0, v125
    v_exp_f32 v122, v120
    v_exp_f32 v123, v121
    v_exp_f32 v125, v125
    v_cvt_pk_bf16_f32 v64, v122, v123
    v_cvt_pk_bf16_f32 v69, v122, v123
    s_nop 0
    v_mov_b32_dpp v66, v64 quad_perm:[2,3,0,1] row_mask:0xf bank_mask:0xf
    v_mov_b32_dpp v71, v64 quad_perm:[2,3,0,1] row_mask:0xf bank_mask:0xf
    v_mul_f32 v56, v56, v125
    v_mul_f32 v57, v57, v125
    v_mul_f32 v58, v58, v125
    v_mul_f32 v59, v59, v125
    v_mul_f32 v60, v60, v125
    v_mul_f32 v61, v61, v125
    v_mul_f32 v62, v62, v125
    v_mul_f32 v63, v63, v125
    v_cvt_pk_bf16_f32 v48, v56, v57
    v_cvt_pk_bf16_f32 v49, v58, v59
    v_cvt_pk_bf16_f32 v50, v60, v61
    v_cvt_pk_bf16_f32 v51, v62, v63
    v_mov_b32_dpp v52, v48 quad_perm:[2,3,0,1] row_mask:0xf bank_mask:0xf
    v_mov_b32_dpp v53, v49 quad_perm:[2,3,0,1] row_mask:0xf bank_mask:0xf
    v_mov_b32_dpp v54, v50 quad_perm:[2,3,0,1] row_mask:0xf bank_mask:0xf
    v_mov_b32_dpp v55, v51 quad_perm:[2,3,0,1] row_mask:0xf bank_mask:0xf
SA_vr3:
    v_mfma_f32_16x16x32_bf16 v[44:47], v[16:19], v[48:51], 0
    v_mfma_f32_16x16x32_bf16 v[28:31], v[104:107], v[48:51], 0
    v_mfma_f32_16x16x32_bf16 v[32:35], v[108:111], v[48:51], 0
    v_mfma_f32_16x16x32_bf16 v[28:31], v[112:115], v[52:55], v[28:31]
    v_mfma_f32_16x16x32_bf16 v[32:35], v[116:119], v[52:55], v[32:35]
    v_mfma_f32_16x16x16_bf16 v[44:47], v[16:17], v[64:65], v[44:47]
    v_mfma_f32_16x16x32_bf16 v[28:31], v[24:27], v[64:67], v[28:31]
    v_mfma_f32_16x16x32_bf16 v[32:35], v[24:27], v[68:71], v[32:35]
    v_add_f32_dpp v124, v44, v44 quad_perm:[2,3,0,1] row_mask:0xf bank_mask:0xf
    v_rcp_f32 v124, v124
    s_nop 5
    s_branch SA_vok
SA_oredo:
    v_max3_u32 v2, v120, v121, v122
    v_max_u32 v2, v2, v123
    v_max_u32 v2, v2, v124
    v_max_u32 v2, v2, v125
    v_max_u32 v2, v2, v126
    v_max_u32 v2, v2, v127
    v_cmp_eq_u32 vcc, -1, v2
    s_cbranch_vccz SA_ook
    s_mov_b32 s96, 0
SA_or1:
    ds_read_b128 v[120:123], v6 offset:0
    ds_read_b128 v[124:127], v6 offset:1024
    s_waitcnt lgkmcnt(0)
    v_max3_u32 v2, v120, v121, v122
    v_max_u32 v2, v2, v123
    v_max_u32 v2, v2, v124
    v_max_u32 v2, v2, v125
    v_max_u32 v2, v2, v126
    v_max_u32 v2, v2, v127
    v_cmp_eq_u32 vcc, -1, v2
    s_cbranch_vccz SA_or2
    s_add_u32 s96, s96, 1
    s_cmp_lt_u32 s96, 1333333
    s_cbranch_scc1 SA_or1
    s_branch L_bail
SA_or2:
    v_mov_b64 v[56:57], 0
    v_mov_b64 v[58:59], 0
    v_mov_b64 v[60:61], 0
    v_mov_b64 v[62:63], 0
    v_mov_b64 v[28:29], 0
    v_mov_b64 v[30:31], 0
    v_mov_b64 v[32:33], 0
    v_mov_b64 v[34:35], 0
    v_mov_b64 v[24:25], 0
    v_mov_b64 v[26:27], 0
    s_nop 2
    s_branch SA_wo
.p2align 6
    s_nop 0
SV_loop:
    ds_write_b128 v3, v[24:27]
    v_smfmac_f32_16x16x64_bf16 v[56:59], v[24:27], v[128:135], v4
    s_nop 0
    s_nop 0
    v_add_u32 v44, s81, v0
    v_smfmac_f32_16x16x64_bf16 v[64:67], v[24:27], a[0:7], v4
    v_add_u32 v48, s82, v0
    v_smfmac_f32_16x16x64_bf16 v[60:63], v[24:27], v[136:143], v4
    s_mov_b64 exec, s[88:89]
    buffer_load_dwordx4 v[40:43], v0, s[12:15], s50 offen sc1
    s_mov_b64 exec, -1
    v_add_u32 v52, s83, v0
    v_smfmac_f32_16x16x64_bf16 v[68:71], v[24:27], a[8:15], v4
    s_waitcnt lgkmcnt(0)
    s_barrier
    ds_read_b128 v[28:31], v44 offset:0
    ds_read_b128 v[32:35], v48 offset:0
    ds_read_b128 v[36:39], v52 offset:0
    v_smfmac_f32_16x16x64_bf16 v[80:83], v[24:27], v[88:95], v4
    ds_read_b128 v[88:91], v8 offset:43008
    v_smfmac_f32_16x16x64_bf16 v[72:75], v[24:27], a[128:135], v4
    ds_read_b128 v[92:95], v8 offset:44032
    v_smfmac_f32_16x16x64_bf16 v[84:87], v[24:27], v[96:103], v4
    ds_read_b128 v[96:99], v8 offset:45056
    v_smfmac_f32_16x16x64_bf16 v[76:79], v[24:27], a[136:143], v4
    ds_read_b128 v[100:103], v8 offset:46080
    s_waitcnt lgkmcnt(6)
    v_smfmac_f32_16x16x64_bf16 v[56:59], v[28:31], v[144:151], v4
    v_smfmac_f32_16x16x64_bf16 v[60:63], v[28:31], v[152:159], v4
    s_waitcnt lgkmcnt(4)
    v_smfmac_f32_16x16x64_bf16 v[56:59], v[32:35], v[160:167], v4
    v_smfmac_f32_16x16x64_bf16 v[60:63], v[32:35], v[168:175], v4
    v_smfmac_f32_16x16x64_bf16 v[56:59], v[36:39], v[176:183], v4
    v_smfmac_f32_16x16x64_bf16 v[60:63], v[36:39], v[184:191], v4
    v_smfmac_f32_16x16x64_bf16 v[64:67], v[28:31], a[16:23], v4
    s_waitcnt vmcnt(0)
    ds_write_b128 v3, v[40:43] offset:4096
    v_smfmac_f32_16x16x64_bf16 v[68:71], v[28:31], a[24:31], v4
    v_max3_u32 v2, v40, v41, v42
    v_smfmac_f32_16x16x64_bf16 v[64:67], v[32:35], a[32:39], v4
    v_max_u32 v2, v2, v43
    v_smfmac_f32_16x16x64_bf16 v[68:71], v[32:35], a[40:47], v4
    v_cmp_eq_u32 vcc, -1, v2
    v_smfmac_f32_16x16x64_bf16 v[64:67], v[36:39], a[48:55], v4
    v_smfmac_f32_16x16x64_bf16 v[68:71], v[36:39], a[56:63], v4
    s_cbranch_vccnz SV_lretry
SV_lok:
    s_waitcnt lgkmcnt(0)
    s_barrier
    ds_read_b128 v[44:47], v44 offset:4096
    v_smfmac_f32_16x16x64_bf16 v[56:59], v[40:43], v[192:199], v4
    ds_read_b128 v[48:51], v48 offset:4096
    ds_read_b128 v[52:55], v52 offset:4096
    v_smfmac_f32_16x16x64_bf16 v[60:63], v[40:43], v[200:207], v4
    v_smfmac_f32_16x16x64_bf16 v[80:83], v[28:31], v[104:111], v4
    ds_read_b128 v[104:107], v8 offset:47104
    s_waitcnt lgkmcnt(3)
    v_smfmac_f32_16x16x64_bf16 v[56:59], v[44:47], v[208:215], v4
    s_nop 0
    v_smfmac_f32_16x16x64_bf16 v[60:63], v[44:47], v[216:223], v4
    s_waitcnt lgkmcnt(1)
    v_smfmac_f32_16x16x64_bf16 v[56:59], v[48:51], v[224:231], v4
    v_smfmac_f32_16x16x64_bf16 v[60:63], v[48:51], v[232:239], v4
    v_smfmac_f32_16x16x64_bf16 v[56:59], v[52:55], v[240:247], v4
    v_smfmac_f32_16x16x64_bf16 v[60:63], v[52:55], v[248:255], v4
    v_smfmac_f32_16x16x64_bf16 v[64:67], v[40:43], a[64:71], v4
    v_add_f32 v56, v56, v57
    v_add_f32 v58, v58, v59
    v_smfmac_f32_16x16x64_bf16 v[68:71], v[40:43], a[72:79], v4
    v_add_f32 v60, v60, v61
    v_add_f32 v62, v62, v63
    v_cvt_pk_bf16_f32 v56, v56, v60
    v_cvt_pk_bf16_f32 v57, v58, v62
    v_smfmac_f32_16x16x64_bf16 v[64:67], v[44:47], a[80:87], v4
    ds_write2_b32 v5, v56, v57 offset0:0 offset1:4
    v_smfmac_f32_16x16x64_bf16 v[68:71], v[44:47], a[88:95], v4
    s_nop 0
    s_nop 0
    v_smfmac_f32_16x16x64_bf16 v[64:67], v[48:51], a[96:103], v4
    s_add_u32 s49, s48, s86
    s_add_u32 s50, s49, 0x1000
    v_smfmac_f32_16x16x64_bf16 v[68:71], v[48:51], a[104:111], v4
    s_mov_b64 s[88:89], -1
    s_nop 0
    v_smfmac_f32_16x16x64_bf16 v[64:67], v[52:55], a[112:119], v4
    s_nop 0
    s_nop 0
    v_smfmac_f32_16x16x64_bf16 v[68:71], v[52:55], a[120:127], v4
    v_smfmac_f32_16x16x64_bf16 v[72:75], v[28:31], a[144:151], v4
    ds_read_b128 v[108:111], v8 offset:48128
    v_smfmac_f32_16x16x64_bf16 v[84:87], v[28:31], v[112:119], v4
    ds_read_b128 v[112:115], v8 offset:49152
    s_waitcnt lgkmcnt(2)
    s_barrier
    v_smfmac_f32_16x16x64_bf16 v[76:79], v[28:31], a[152:159], v4
    ds_read_b128 v[116:119], v8 offset:50176
    v_add_f32 v64, v64, v65
    v_add_f32 v66, v66, v67
    v_smfmac_f32_16x16x64_bf16 v[80:83], v[32:35], v[120:127], v4
    ds_read_b128 v[120:123], v8 offset:51200
    v_add_f32 v68, v68, v69
    v_add_f32 v70, v70, v71
    v_cvt_pk_bf16_f32 v64, v64, v68
    v_cvt_pk_bf16_f32 v65, v66, v70
    v_smfmac_f32_16x16x64_bf16 v[72:75], v[32:35], a[160:167], v4
    ds_read_b128 v[124:127], v8 offset:52224
    ds_write2_b32 v5, v64, v65 offset0:128 offset1:132
    v_smfmac_f32_16x16x64_bf16 v[84:87], v[32:35], v[88:95], v4
    ds_read_b128 v[88:91], v8 offset:53248
    v_smfmac_f32_16x16x64_bf16 v[76:79], v[32:35], a[168:175], v4
    ds_read_b128 v[92:95], v8 offset:54272
    s_nop 0
    v_smfmac_f32_16x16x64_bf16 v[80:83], v[36:39], v[96:103], v4
    ds_read_b128 v[96:99], v8 offset:55296
    v_smfmac_f32_16x16x64_bf16 v[72:75], v[36:39], a[176:183], v4
    ds_read_b128 v[100:103], v8 offset:56320
    s_waitcnt lgkmcnt(9)
    v_smfmac_f32_16x16x64_bf16 v[84:87], v[36:39], v[104:111], v4
    ds_read_b128 v[104:107], v8 offset:57344
    v_smfmac_f32_16x16x64_bf16 v[76:79], v[36:39], a[184:191], v4
    ds_read_b128 v[108:111], v8 offset:58368
    s_waitcnt lgkmcnt(6)
    s_barrier
    v_smfmac_f32_16x16x64_bf16 v[80:83], v[40:43], v[112:119], v4
    ds_read_b128 v[112:115], v8 offset:59392
    v_smfmac_f32_16x16x64_bf16 v[72:75], v[40:43], a[192:199], v4
    ds_read_b128 v[116:119], v8 offset:60416
    v_smfmac_f32_16x16x64_bf16 v[84:87], v[40:43], v[120:127], v4
    ds_read_b128 v[120:123], v8 offset:61440
    v_smfmac_f32_16x16x64_bf16 v[76:79], v[40:43], a[200:207], v4
    ds_read_b128 v[124:127], v8 offset:62464
    s_waitcnt lgkmcnt(8)
    v_smfmac_f32_16x16x64_bf16 v[80:83], v[44:47], v[88:95], v4
    ds_read_b128 v[88:91], v8 offset:63488
    v_smfmac_f32_16x16x64_bf16 v[72:75], v[44:47], a[208:215], v4
    ds_read_b128 v[92:95], v8 offset:64512
    s_waitcnt lgkmcnt(8)
    v_smfmac_f32_16x16x64_bf16 v[84:87], v[44:47], v[96:103], v4
    ds_read_b128 v[16:19], v8 offset:10240
    v_smfmac_f32_16x16x64_bf16 v[76:79], v[44:47], a[216:223], v4
    ds_read_b128 v[20:23], v8 offset:11264
    s_waitcnt lgkmcnt(8)
    v_smfmac_f32_16x16x64_bf16 v[80:83], v[48:51], v[104:111], v4
    ds_read_b128 v[56:59], v8 offset:12288
    v_smfmac_f32_16x16x64_bf16 v[72:75], v[48:51], a[224:231], v4
    ds_read_b128 v[60:63], v8 offset:13312
    s_waitcnt lgkmcnt(8)
    v_smfmac_f32_16x16x64_bf16 v[84:87], v[48:51], v[112:119], v4
    ds_read_b128 v[96:99], v8 offset:2048
    s_waitcnt lgkmcnt(7)
    v_smfmac_f32_16x16x64_bf16 v[80:83], v[52:55], v[120:127], v4
    ds_read_b128 v[100:103], v8 offset:3072
    s_waitcnt lgkmcnt(6)
    v_smfmac_f32_16x16x64_bf16 v[84:87], v[52:55], v[88:95], v4
    ds_read_b128 v[104:107], v8 offset:4096
    v_smfmac_f32_16x16x64_bf16 v[72:75], v[52:55], a[240:247], v4
    ds_read_b128 v[108:111], v8 offset:5120
    v_add_f32 v80, v80, v81
    v_add_f32 v82, v82, v83
    v_smfmac_f32_16x16x64_bf16 v[76:79], v[48:51], a[232:239], v4
    ds_read_b128 v[112:115], v8 offset:6144
    v_add_f32 v84, v84, v85
    v_add_f32 v86, v86, v87
    v_smfmac_f32_16x16x64_bf16 v[76:79], v[52:55], a[248:255], v4
    v_cvt_pk_bf16_f32 v66, v80, v82
    v_cvt_pk_bf16_f32 v67, v84, v86
    v_add_f32 v72, v72, v73
    v_add_f32 v74, v74, v75
    v_cvt_pk_bf16_f32 v64, v72, v74
    s_nop 2
    v_add_f32 v76, v76, v77
    v_add_f32 v78, v78, v79
    v_cvt_pk_bf16_f32 v65, v76, v78
    ds_write_b128 v3, v[64:67] offset:12288
    s_cmp_eq_u32 s6, 63
    s_cbranch_scc1 L_chain_done
    s_barrier
    v_mov_b64 v[28:29], 0
    v_mov_b64 v[30:31], 0
    v_mov_b64 v[32:33], 0
    ds_read_b128 v[88:91], v8 offset:0
    v_mov_b64 v[34:35], 0
    ds_read_b128 v[92:95], v8 offset:1024
    v_mov_b64 v[36:37], 0
    ds_read_b128 v[116:119], v8 offset:7168
    v_mov_b64 v[38:39], 0
    ds_read_b128 v[120:123], v8 offset:8192
    v_mov_b64 v[40:41], 0
    ds_read_b128 v[124:127], v8 offset:9216
    v_mov_b64 v[42:43], 0
    ds_read_b128 v[64:67], v8 offset:14336
    v_mov_b64 v[44:45], 0
    ds_read_b128 v[68:71], v8 offset:15360
    v_mov_b64 v[46:47], 0
    v_mov_b64 v[48:49], 0
    v_mov_b64 v[50:51], 0
    v_mov_b64 v[52:53], 0
    v_mov_b64 v[54:55], 0
    v_mov_b64 v[72:73], 0
    v_mov_b64 v[74:75], 0
    s_barrier
    ds_read_b128 v[76:79], v6 offset:0
    ds_read_b128 v[80:83], v6 offset:1024
    s_waitcnt lgkmcnt(1)
SV_wo:
    v_smfmac_f32_16x16x64_bf16 v[28:31], v[76:79], v[88:95], v4
    s_waitcnt lgkmcnt(0)
    ds_read_b128 v[88:91], v8 offset:16384
    ds_read_b128 v[92:95], v8 offset:17408
    v_smfmac_f32_16x16x64_bf16 v[28:31], v[80:83], v[96:103], v4
    s_nop 0
    ds_read_b128 v[96:99], v8 offset:18432
    ds_read_b128 v[100:103], v8 offset:19456
    v_smfmac_f32_16x16x64_bf16 v[32:35], v[76:79], v[104:111], v4
    s_nop 0
    ds_read_b128 v[104:107], v8 offset:20480
    ds_read_b128 v[108:111], v8 offset:21504
    v_smfmac_f32_16x16x64_bf16 v[32:35], v[80:83], v[112:119], v4
    ds_read_b128 v[112:115], v8 offset:22528
    v_add_f32 v28, v28, v29
    v_smfmac_f32_16x16x64_bf16 v[36:39], v[76:79], v[120:127], v4
    ds_read_b128 v[116:119], v8 offset:23552
    v_add_f32 v30, v30, v31
    v_smfmac_f32_16x16x64_bf16 v[36:39], v[80:83], v[16:23], v4
    ds_read_b128 v[120:123], v8 offset:24576
    v_add_f32 v32, v32, v33
    v_add_f32 v34, v34, v35
    v_cmp_u_f32 vcc, v28, v30
    v_smfmac_f32_16x16x64_bf16 v[40:43], v[76:79], v[56:63], v4
    ds_read_b128 v[124:127], v8 offset:25600
    v_cvt_pk_bf16_f32 v84, v28, v32
    v_cvt_pk_bf16_f32 v86, v30, v34
    v_smfmac_f32_16x16x64_bf16 v[40:43], v[80:83], v[64:71], v4
    s_waitcnt lgkmcnt(8)
    ds_read_b128 v[16:19], v8 offset:26624
    v_add_f32 v36, v36, v37
    v_add_f32 v38, v38, v39
    v_smfmac_f32_16x16x64_bf16 v[44:47], v[76:79], v[88:95], v4
    s_cbranch_vccnz SV_oredo
SV_ook:
    s_waitcnt lgkmcnt(7)
    ds_read_b128 v[20:23], v8 offset:27648
    v_and_or_b32 v84, v84, -2, s97
    v_and_or_b32 v86, v86, -2, s97
    v_smfmac_f32_16x16x64_bf16 v[44:47], v[80:83], v[96:103], v4
    s_waitcnt lgkmcnt(6)
    v_add_f32 v40, v40, v41
    v_add_f32 v42, v42, v43
    v_cvt_pk_bf16_f32 v85, v36, v40
    v_cvt_pk_bf16_f32 v87, v38, v42
    v_and_or_b32 v85, v85, -2, s97
    v_and_or_b32 v87, v87, -2, s97
    buffer_store_dwordx4 v[84:87], v7, s[12:15], s45 offen sc1
    ds_read_b128 v[56:59], v8 offset:28672
    ds_read_b128 v[60:63], v8 offset:29696
    v_smfmac_f32_16x16x64_bf16 v[48:51], v[76:79], v[104:111], v4
    s_waitcnt lgkmcnt(6)
    ds_read_b128 v[64:67], v8 offset:30720
    ds_read_b128 v[68:71], v8 offset:31744
    v_smfmac_f32_16x16x64_bf16 v[48:51], v[80:83], v[112:119], v4
    s_waitcnt lgkmcnt(6)
    v_add_f32 v44, v44, v45
    v_smfmac_f32_16x16x64_bf16 v[52:55], v[76:79], v[120:127], v4
    s_waitcnt lgkmcnt(4)
    v_add_f32 v46, v46, v47
    v_smfmac_f32_16x16x64_bf16 v[52:55], v[80:83], v[16:23], v4
    s_waitcnt lgkmcnt(2)
    v_add_f32 v48, v48, v49
    v_add_f32 v50, v50, v51
    v_smfmac_f32_16x16x64_bf16 v[72:75], v[76:79], v[56:63], v4
    s_waitcnt lgkmcnt(0)
    v_cvt_pk_bf16_f32 v24, v44, v48
    v_cvt_pk_bf16_f32 v26, v46, v50
    v_smfmac_f32_16x16x64_bf16 v[72:75], v[80:83], v[64:71], v4
    v_add_f32 v52, v52, v53
    v_add_f32 v54, v54, v55
    v_and_or_b32 v24, v24, -2, s97
    v_and_or_b32 v26, v26, -2, s97
    s_nop 3
    v_add_f32 v72, v72, v73
    v_add_f32 v74, v74, v75
    v_cvt_pk_bf16_f32 v25, v52, v72
    v_cvt_pk_bf16_f32 v27, v54, v74
    v_and_or_b32 v25, v25, -2, s97
    v_and_or_b32 v27, v27, -2, s97
    buffer_store_dwordx4 v[24:27], v7, s[12:15], s46 offen sc1
    v_mov_b64 v[36:37], -1
    ds_read_b128 v[88:91], v8 offset:32768
    ds_read_b128 v[92:95], v8 offset:33792
    v_mov_b64 v[56:57], 0
    v_mov_b64 v[58:59], 0
    ds_read_b128 v[96:99], v8 offset:34816
    ds_read_b128 v[100:103], v8 offset:35840
    v_mov_b64 v[60:61], 0
    v_mov_b64 v[62:63], 0
    ds_read_b128 v[104:107], v8 offset:36864
    ds_read_b128 v[108:111], v8 offset:37888
    v_mov_b64 v[64:65], 0
    v_mov_b64 v[66:67], 0
    ds_read_b128 v[112:115], v8 offset:38912
    ds_read_b128 v[116:119], v8 offset:39936
    v_mov_b64 v[68:69], 0
    v_mov_b64 v[70:71], 0
    ds_read_b128 v[120:123], v8 offset:40960
    ds_read_b128 v[124:127], v8 offset:41984
    v_mov_b64 v[72:73], 0
    v_mov_b64 v[74:75], 0
    v_mov_b64 v[24:25], -1
    v_mov_b64 v[26:27], -1
    v_mov_b64 v[76:77], 0
    v_mov_b64 v[78:79], 0
    v_mov_b64 v[80:81], 0
    v_mov_b64 v[82:83], 0
    v_mov_b64 v[84:85], 0
    v_mov_b64 v[86:87], 0
    v_mov_b64 v[16:17], -1
    v_mov_b64 v[18:19], -1
    v_mov_b32 v2, 0
    s_nop 2
    v_mov_b32 v2, 0
    s_nop 2
    v_mov_b32 v2, 0
    s_nop 2
    v_mov_b32 v2, 0
    s_nop 2
    v_mov_b32 v2, 0
    s_nop 2
    v_mov_b32 v2, 0
    s_nop 2
    v_mov_b32 v2, 0
    s_nop 2
    buffer_load_dwordx4 v[28:31], v0, s[12:15], s47 offen sc1
    buffer_load_dwordx4 v[32:35], v0, s[12:15], s47 offen offset:1024 sc1
    v_mov_b32 v2, 0
    s_nop 2
    v_mov_b32 v2, 0
    s_nop 2
    v_mov_b32 v2, 0
    s_nop 2
    v_mov_b32 v2, 0
    s_nop 2
    v_mov_b32 v2, 0
    s_nop 2
    v_mov_b32 v2, 0
    s_nop 2
    v_mov_b32 v2, 0
    s_nop 2
    v_mov_b32 v2, 0
    s_nop 2
    v_mov_b32 v2, 0
    s_nop 2
    buffer_load_dwordx4 v[48:51], v0, s[12:15], s47 offen sc1
    buffer_load_dwordx4 v[52:55], v0, s[12:15], s47 offen offset:1024 sc1
    s_mov_b32 s96, 0
    v_mov_b32 v2, 0
    s_nop 2
    v_mov_b32 v2, 0
    s_nop 2
    v_mov_b32 v2, 0
    s_nop 2
    v_mov_b32 v2, 0
    s_nop 2
    s_nop 0
    s_nop 0
    s_nop 0
    s_nop 0
    s_nop 0
    s_nop 0
    s_nop 0
    s_waitcnt vmcnt(2)
SV_r10:
    v_mfma_f32_16x16x32_bf16 v[40:43], v[12:15], v[28:31], 0
    v_bitop3_b32 v44, v28, v29, s98 bitop3:0xbd
    v_bitop3_b32 v45, v30, v31, s98 bitop3:0xbd
    v_mfma_f32_16x16x32_bf16 v[40:43], v[12:15], v[32:35], v[40:43]
    v_bitop3_b32 v46, v32, v33, s98 bitop3:0xbd
    v_bitop3_b32 v47, v34, v35, s98 bitop3:0xbd
    v_or3_b32 v44, v44, v45, v46
    v_bitop3_b32 v44, v44, v47, 1 bitop3:0xa8
    v_cmp_ne_u32 vcc, 0, v44
    s_nop 2
    v_add_f32_dpp v38, v40, v40 row_ror:4 row_mask:0xf bank_mask:0x5
    v_add_f32_dpp v39, v41, v41 row_ror:4 row_mask:0xf bank_mask:0x5
    v_add_f32_dpp v38, v42, v42 row_ror:4 row_mask:0xf bank_mask:0xa
    v_add_f32_dpp v39, v43, v43 row_ror:4 row_mask:0xf bank_mask:0xa
    s_cbranch_vccnz SV_r11
SV_r1ok:
    v_add_f32_dpp v38, v38, v38 row_ror:8 row_mask:0xf bank_mask:0xf
    v_add_f32_dpp v39, v39, v39 row_ror:8 row_mask:0xf bank_mask:0xf
    s_mov_b64 exec, s[58:59]
    v_cvt_pk_bf16_f32 v38, v38, v39
    buffer_store_dword v38, v1, s[12:15], s48 offen sc1
    buffer_store_dword v36, v1, s[12:15], s51 offen sc1
    s_mov_b64 exec, -1
    buffer_load_dwordx4 v[24:27], v0, s[12:15], s49 offen sc1
    v_mov_b32 v2, 0
    s_nop 2
    v_mov_b32 v2, 0
    s_nop 2
    v_mov_b32 v2, 0
    s_nop 2
    buffer_load_dwordx4 v[24:27], v0, s[12:15], s49 offen sc1
    s_mov_b32 s80, s6
    s_add_u32 s6, s6, 1
    s_add_u32 s53, s53, 0x20000
    s_mov_b32 s96, 0
    v_mov_b32 v2, 0
    s_mov_b32 s51, s48
    s_and_b32 s7, s6, 3
    s_lshl_b32 s48, s7, 13
    s_add_u32 s48, s48, 65536
    s_lshr_b32 s97, s7, 1
    s_sub_u32 s98, s97, 1
    s_mov_b32 s99, s98
    s_and_b32 s7, s7, 1
    s_lshl_b32 s7, s7, 18
    s_add_u32 s45, s7, 1048576
    s_add_u32 s46, s45, 0x1000
    s_add_u32 s47, s44, s7
    s_waitcnt lgkmcnt(0)
    s_nop 0
    s_nop 0
    v_mov_b32_e64 v11, 0
    s_nop 0
SV_r2:
    v_max3_u32 v2, v24, v25, v26
    v_max_u32 v2, v2, v27
    v_cmp_eq_u32 vcc, -1, v2
    s_cbranch_vccz SV_loop
    v_max3_u32 v2, v24, v25, v26
    v_max_u32 v2, v2, v27
    v_cmp_eq_u32 vcc, -1, v2
    s_cbranch_vccz SV_loop
    s_mov_b64 exec, vcc
    buffer_load_dwordx4 v[24:27], v0, s[12:15], s49 offen sc1
    s_mov_b64 exec, -1
    s_add_u32 s96, s96, 1
    s_cmp_lt_u32 s96, 1333333
    s_cbranch_scc1 SV_r2
    s_branch L_bail
SV_r11:
    s_mov_b64 exec, vcc
    buffer_load_dwordx4 v[28:31], v0, s[12:15], s47 offen sc1
    buffer_load_dwordx4 v[32:35], v0, s[12:15], s47 offen offset:1024 sc1
    s_mov_b64 exec, -1
    s_waitcnt vmcnt(2)
    v_mfma_f32_16x16x32_bf16 v[40:43], v[12:15], v[48:51], 0
    v_bitop3_b32 v44, v48, v49, s98 bitop3:0xbd
    v_bitop3_b32 v45, v50, v51, s98 bitop3:0xbd
    v_mfma_f32_16x16x32_bf16 v[40:43], v[12:15], v[52:55], v[40:43]
    v_bitop3_b32 v46, v52, v53, s98 bitop3:0xbd
    v_bitop3_b32 v47, v54, v55, s98 bitop3:0xbd
    v_or3_b32 v44, v44, v45, v46
    v_bitop3_b32 v44, v44, v47, 1 bitop3:0xa8
    v_cmp_ne_u32 vcc, 0, v44
    s_nop 2
    v_add_f32_dpp v38, v40, v40 row_ror:4 row_mask:0xf bank_mask:0x5
    v_add_f32_dpp v39, v41, v41 row_ror:4 row_mask:0xf bank_mask:0x5
    v_add_f32_dpp v38, v42, v42 row_ror:4 row_mask:0xf bank_mask:0xa
    v_add_f32_dpp v39, v43, v43 row_ror:4 row_mask:0xf bank_mask:0xa
    s_cbranch_vccz SV_r1ok
    s_mov_b64 exec, vcc
    buffer_load_dwordx4 v[48:51], v0, s[12:15], s47 offen sc1
    buffer_load_dwordx4 v[52:55], v0, s[12:15], s47 offen offset:1024 sc1
    s_mov_b64 exec, -1
    s_waitcnt vmcnt(2)
    s_add_u32 s96, s96, 1
    s_cmp_lt_u32 s96, 1333333
    s_cbranch_scc1 SV_r10
    s_branch L_bail
SV_lretry:
SV_lr2:
    s_mov_b64 exec, vcc
    buffer_load_dwordx4 v[40:43], v0, s[12:15], s50 offen sc1
    s_mov_b64 exec, -1
    s_waitcnt vmcnt(0)
    v_max3_u32 v2, v40, v41, v42
    v_max_u32 v2, v2, v43
    v_cmp_eq_u32 vcc, -1, v2
    ds_write_b128 v3, v[40:43] offset:4096
    s_waitcnt lgkmcnt(0)
    s_cbranch_vccz SV_lok
    s_add_u32 s96, s96, 1
    s_cmp_lt_u32 s96, 1333333
    s_cbranch_scc1 SV_lr2
    s_branch L_bail
SV_oredo:
    v_max3_u32 v2, v76, v77, v78
    v_max_u32 v2, v2, v79
    v_max_u32 v2, v2, v80
    v_max_u32 v2, v2, v81
    v_max_u32 v2, v2, v82
    v_max_u32 v2, v2, v83
    v_cmp_eq_u32 vcc, -1, v2
    s_cbranch_vccz SV_ook
    s_mov_b32 s96, 0
SV_or1:
    ds_read_b128 v[76:79], v6 offset:0
    ds_read_b128 v[80:83], v6 offset:1024
    s_waitcnt lgkmcnt(0)
    v_max3_u32 v2, v76, v77, v78
    v_max_u32 v2, v2, v79
    v_max_u32 v2, v2, v80
    v_max_u32 v2, v2, v81
    v_max_u32 v2, v2, v82
    v_max_u32 v2, v2, v83
    v_cmp_eq_u32 vcc, -1, v2
    s_cbranch_vccz SV_or2
    s_add_u32 s96, s96, 1
    s_cmp_lt_u32 s96, 1333333
    s_cbranch_scc1 SV_or1
    s_branch L_bail
SV_or2:
    v_mov_b64 v[28:29], 0
    v_mov_b64 v[30:31], 0
    v_mov_b64 v[32:33], 0
    v_mov_b64 v[34:35], 0
    v_mov_b64 v[36:37], 0
    v_mov_b64 v[38:39], 0
    v_mov_b64 v[40:41], 0
    v_mov_b64 v[42:43], 0
    v_mov_b64 v[44:45], 0
    v_mov_b64 v[46:47], 0
    ds_read_b128 v[88:91], v8 offset:0
    ds_read_b128 v[92:95], v8 offset:1024
    ds_read_b128 v[96:99], v8 offset:2048
    ds_read_b128 v[100:103], v8 offset:3072
    ds_read_b128 v[104:107], v8 offset:4096
    ds_read_b128 v[108:111], v8 offset:5120
    ds_read_b128 v[112:115], v8 offset:6144
    ds_read_b128 v[116:119], v8 offset:7168
    ds_read_b128 v[120:123], v8 offset:8192
    ds_read_b128 v[124:127], v8 offset:9216
    ds_read_b128 v[16:19], v8 offset:10240
    ds_read_b128 v[20:23], v8 offset:11264
    ds_read_b128 v[56:59], v8 offset:12288
    ds_read_b128 v[60:63], v8 offset:13312
    ds_read_b128 v[64:67], v8 offset:14336
    ds_read_b128 v[68:71], v8 offset:15360
    s_waitcnt lgkmcnt(0)
    s_branch SV_wo
L_chain_done:
    ds_read_b128 v[60:63], v9
    s_add_u32 s53, s53, 0x20000
    s_waitcnt lgkmcnt(0)
    buffer_store_dwordx4 v[60:63], v0, s[12:15], s53 offen offset:0 sc1
    buffer_store_dwordx4 v[64:67], v0, s[12:15], s53 offen offset:2048 sc1
L_chain_end:
    s_waitcnt vmcnt(0)
    s_waitcnt vmcnt(0)
    s_endpgm
L_B:
    s_sub_u32 s4, s4, 32
    s_cmp_ge_u32 s4, 32
    s_cselect_b32 s5, 1, 0
    s_cselect_b32 s7, 32, 0
    s_sub_u32 s4, s4, s7
    s_mov_b32 s6, 0
    s_mov_b32 s46, 0
    s_mov_b32 s7, 1040
    v_mul_lo_u32 v3, v2, s7
    v_lshl_add_u32 v3, v1, 4, v3
    v_lshlrev_b32 v0, 4, v0
    s_lshl_b32 s47, s4, 7
    s_lshl_b32 s7, s5, 2
    s_add_u32 s47, s47, s7
    s_add_u32 s47, s47, 0
    v_lshrrev_b32 v5, 1, v0
    v_mov_b32 v6, 0
    v_writelane_b32 v6, 0, 0
    s_mov_b64 exec, 3
    buffer_store_dword v6, v5, s[12:15], s47 offen sc1
    s_mov_b64 exec, -1
    s_mov_b32 s24, s66
    s_mov_b32 s25, s67
    s_mov_b32 s26, 4194304
    s_mov_b32 s27, 0x20000
    s_mov_b32 s28, s68
    s_mov_b32 s29, s69
    s_mov_b32 s30, 4194304
    s_mov_b32 s31, 0x20000
    s_mov_b32 s32, s64
    s_mov_b32 s33, s65
    s_mov_b32 s34, 4194304
    s_mov_b32 s35, 0x20000
    s_lshl_b32 s48, s4, 8
    s_mov_b32 s90, 65536
    v_mul_lo_u32 v24, v1, s90
    v_lshl_add_u32 v24, v2, 4, v24
    s_mul_i32 s7, s3, 1048576
    s_add_u32 s7, s7, s48
    v_add_u32 v24, s7, v24
    v_add_u32 v25, 8192, v24
    v_lshrrev_b32 v26, 2, v2
    s_mov_b32 s90, 32784
    v_mul_lo_u32 v26, v26, s90
    v_lshl_add_u32 v26, v1, 8, v26
    v_and_b32 v27, 3, v2
    v_lshl_add_u32 v26, v27, 6, v26
    s_lshl_b32 s7, s3, 13
    v_add_u32 v26, s7, v26
    s_mul_i32 s7, s3, 32784
    v_add_u32 v27, s7, v0
    s_mov_b32 s7, 0
    buffer_load_dwordx4 v[64:67], v24, s[24:27], s7 offen
    buffer_load_dwordx4 v[68:71], v25, s[24:27], s7 offen
    s_mov_b32 s7, 16384
    buffer_load_dwordx4 v[72:75], v24, s[24:27], s7 offen
    buffer_load_dwordx4 v[76:79], v25, s[24:27], s7 offen
    s_mov_b32 s7, 32768
    buffer_load_dwordx4 v[80:83], v24, s[24:27], s7 offen
    buffer_load_dwordx4 v[84:87], v25, s[24:27], s7 offen
    s_mov_b32 s7, 49152
    buffer_load_dwordx4 v[88:91], v24, s[24:27], s7 offen
    buffer_load_dwordx4 v[92:95], v25, s[24:27], s7 offen
    s_mov_b32 s7, 262144
    buffer_load_dwordx4 v[96:99], v24, s[24:27], s7 offen
    buffer_load_dwordx4 v[100:103], v25, s[24:27], s7 offen
    s_mov_b32 s7, 278528
    buffer_load_dwordx4 v[104:107], v24, s[24:27], s7 offen
    buffer_load_dwordx4 v[108:111], v25, s[24:27], s7 offen
    s_mov_b32 s7, 294912
    buffer_load_dwordx4 v[112:115], v24, s[24:27], s7 offen
    buffer_load_dwordx4 v[116:119], v25, s[24:27], s7 offen
    s_mov_b32 s7, 311296
    buffer_load_dwordx4 v[120:123], v24, s[24:27], s7 offen
    buffer_load_dwordx4 v[124:127], v25, s[24:27], s7 offen
    s_waitcnt vmcnt(14)
    v_perm_b32 v32, v68, v64, s40
    v_perm_b32 v36, v68, v64, s41
    v_perm_b32 v40, v69, v65, s40
    v_perm_b32 v44, v69, v65, s41
    v_perm_b32 v48, v70, v66, s40
    v_perm_b32 v52, v70, v66, s41
    v_perm_b32 v56, v71, v67, s40
    v_perm_b32 v60, v71, v67, s41
    s_mov_b32 s7, 524288
    buffer_load_dwordx4 v[64:67], v24, s[24:27], s7 offen
    buffer_load_dwordx4 v[68:71], v25, s[24:27], s7 offen
    s_barrier
    s_cmp_lg_u32 s3, 0
    s_cbranch_scc1 IA_34
    v_mov_b32 v28, 1
    s_mov_b64 exec, 1
    buffer_atomic_add v28, off, s[16:19], 0 offset:64
    s_mov_b64 exec, -1
IA_34:
    s_waitcnt vmcnt(14)
    v_perm_b32 v33, v76, v72, s40
    v_perm_b32 v37, v76, v72, s41
    v_perm_b32 v41, v77, v73, s40
    v_perm_b32 v45, v77, v73, s41
    v_perm_b32 v49, v78, v74, s40
    v_perm_b32 v53, v78, v74, s41
    v_perm_b32 v57, v79, v75, s40
    v_perm_b32 v61, v79, v75, s41
    s_mov_b32 s7, 540672
    buffer_load_dwordx4 v[72:75], v24, s[24:27], s7 offen
    buffer_load_dwordx4 v[76:79], v25, s[24:27], s7 offen
    s_waitcnt vmcnt(14)
    v_perm_b32 v34, v84, v80, s40
    v_perm_b32 v38, v84, v80, s41
    v_perm_b32 v42, v85, v81, s40
    v_perm_b32 v46, v85, v81, s41
    v_perm_b32 v50, v86, v82, s40
    v_perm_b32 v54, v86, v82, s41
    v_perm_b32 v58, v87, v83, s40
    v_perm_b32 v62, v87, v83, s41
    s_mov_b32 s7, 557056
    buffer_load_dwordx4 v[80:83], v24, s[24:27], s7 offen
    buffer_load_dwordx4 v[84:87], v25, s[24:27], s7 offen
    s_waitcnt vmcnt(14)
    v_perm_b32 v35, v92, v88, s40
    v_perm_b32 v39, v92, v88, s41
    v_perm_b32 v43, v93, v89, s40
    v_perm_b32 v47, v93, v89, s41
    v_perm_b32 v51, v94, v90, s40
    v_perm_b32 v55, v94, v90, s41
    v_perm_b32 v59, v95, v91, s40
    v_perm_b32 v63, v95, v91, s41
    s_mov_b32 s7, 573440
    buffer_load_dwordx4 v[88:91], v24, s[24:27], s7 offen
    buffer_load_dwordx4 v[92:95], v25, s[24:27], s7 offen
    ds_write_b128 v26, v[32:35] offset:0
    ds_write_b128 v26, v[36:39] offset:1024
    ds_write_b128 v26, v[40:43] offset:16
    ds_write_b128 v26, v[44:47] offset:1040
    ds_write_b128 v26, v[48:51] offset:32
    ds_write_b128 v26, v[52:55] offset:1056
    ds_write_b128 v26, v[56:59] offset:48
    ds_write_b128 v26, v[60:63] offset:1072
    s_waitcnt vmcnt(14)
    v_perm_b32 v32, v100, v96, s40
    v_perm_b32 v36, v100, v96, s41
    v_perm_b32 v40, v101, v97, s40
    v_perm_b32 v44, v101, v97, s41
    v_perm_b32 v48, v102, v98, s40
    v_perm_b32 v52, v102, v98, s41
    v_perm_b32 v56, v103, v99, s40
    v_perm_b32 v60, v103, v99, s41
    s_mov_b32 s7, 786432
    buffer_load_dwordx4 v[96:99], v24, s[24:27], s7 offen
    buffer_load_dwordx4 v[100:103], v25, s[24:27], s7 offen
    s_waitcnt vmcnt(14)
    v_perm_b32 v33, v108, v104, s40
    v_perm_b32 v37, v108, v104, s41
    v_perm_b32 v41, v109, v105, s40
    v_perm_b32 v45, v109, v105, s41
    v_perm_b32 v49, v110, v106, s40
    v_perm_b32 v53, v110, v106, s41
    v_perm_b32 v57, v111, v107, s40
    v_perm_b32 v61, v111, v107, s41
    s_mov_b32 s7, 802816
    buffer_load_dwordx4 v[104:107], v24, s[24:27], s7 offen
    buffer_load_dwordx4 v[108:111], v25, s[24:27], s7 offen
    s_waitcnt vmcnt(14)
    v_perm_b32 v34, v116, v112, s40
    v_perm_b32 v38, v116, v112, s41
    v_perm_b32 v42, v117, v113, s40
    v_perm_b32 v46, v117, v113, s41
    v_perm_b32 v50, v118, v114, s40
    v_perm_b32 v54, v118, v114, s41
    v_perm_b32 v58, v119, v115, s40
    v_perm_b32 v62, v119, v115, s41
    s_mov_b32 s7, 819200
    buffer_load_dwordx4 v[112:115], v24, s[24:27], s7 offen
    buffer_load_dwordx4 v[116:119], v25, s[24:27], s7 offen
    s_waitcnt vmcnt(14)
    v_perm_b32 v35, v124, v120, s40
    v_perm_b32 v39, v124, v120, s41
    v_perm_b32 v43, v125, v121, s40
    v_perm_b32 v47, v125, v121, s41
    v_perm_b32 v51, v126, v122, s40
    v_perm_b32 v55, v126, v122, s41
    v_perm_b32 v59, v127, v123, s40
    v_perm_b32 v63, v127, v123, s41
    s_mov_b32 s7, 835584
    buffer_load_dwordx4 v[120:123], v24, s[24:27], s7 offen
    buffer_load_dwordx4 v[124:127], v25, s[24:27], s7 offen
    ds_write_b128 v26, v[32:35] offset:2048
    ds_write_b128 v26, v[36:39] offset:3072
    ds_write_b128 v26, v[40:43] offset:2064
    ds_write_b128 v26, v[44:47] offset:3088
    ds_write_b128 v26, v[48:51] offset:2080
    ds_write_b128 v26, v[52:55] offset:3104
    ds_write_b128 v26, v[56:59] offset:2096
    ds_write_b128 v26, v[60:63] offset:3120
    s_waitcnt vmcnt(14)
    v_perm_b32 v32, v68, v64, s40
    v_perm_b32 v36, v68, v64, s41
    v_perm_b32 v40, v69, v65, s40
    v_perm_b32 v44, v69, v65, s41
    v_perm_b32 v48, v70, v66, s40
    v_perm_b32 v52, v70, v66, s41
    v_perm_b32 v56, v71, v67, s40
    v_perm_b32 v60, v71, v67, s41
    s_mov_b32 s7, 0
    buffer_load_dwordx4 v[64:67], v24, s[32:35], s7 offen
    buffer_load_dwordx4 v[68:71], v25, s[32:35], s7 offen
    s_waitcnt vmcnt(14)
    v_perm_b32 v33, v76, v72, s40
    v_perm_b32 v37, v76, v72, s41
    v_perm_b32 v41, v77, v73, s40
    v_perm_b32 v45, v77, v73, s41
    v_perm_b32 v49, v78, v74, s40
    v_perm_b32 v53, v78, v74, s41
    v_perm_b32 v57, v79, v75, s40
    v_perm_b32 v61, v79, v75, s41
    s_mov_b32 s7, 16384
    buffer_load_dwordx4 v[72:75], v24, s[32:35], s7 offen
    buffer_load_dwordx4 v[76:79], v25, s[32:35], s7 offen
    s_waitcnt vmcnt(14)
    v_perm_b32 v34, v84, v80, s40
    v_perm_b32 v38, v84, v80, s41
    v_perm_b32 v42, v85, v81, s40
    v_perm_b32 v46, v85, v81, s41
    v_perm_b32 v50, v86, v82, s40
    v_perm_b32 v54, v86, v82, s41
    v_perm_b32 v58, v87, v83, s40
    v_perm_b32 v62, v87, v83, s41
    s_mov_b32 s7, 32768
    buffer_load_dwordx4 v[80:83], v24, s[32:35], s7 offen
    buffer_load_dwordx4 v[84:87], v25, s[32:35], s7 offen
    s_waitcnt vmcnt(14)
    v_perm_b32 v35, v92, v88, s40
    v_perm_b32 v39, v92, v88, s41
    v_perm_b32 v43, v93, v89, s40
    v_perm_b32 v47, v93, v89, s41
    v_perm_b32 v51, v94, v90, s40
    v_perm_b32 v55, v94, v90, s41
    v_perm_b32 v59, v95, v91, s40
    v_perm_b32 v63, v95, v91, s41
    s_mov_b32 s7, 49152
    buffer_load_dwordx4 v[88:91], v24, s[32:35], s7 offen
    buffer_load_dwordx4 v[92:95], v25, s[32:35], s7 offen
    ds_write_b128 v26, v[32:35] offset:4096
    ds_write_b128 v26, v[36:39] offset:5120
    ds_write_b128 v26, v[40:43] offset:4112
    ds_write_b128 v26, v[44:47] offset:5136
    ds_write_b128 v26, v[48:51] offset:4128
    ds_write_b128 v26, v[52:55] offset:5152
    ds_write_b128 v26, v[56:59] offset:4144
    ds_write_b128 v26, v[60:63] offset:5168
    s_waitcnt vmcnt(14)
    v_perm_b32 v32, v100, v96, s40
    v_perm_b32 v36, v100, v96, s41
    v_perm_b32 v40, v101, v97, s40
    v_perm_b32 v44, v101, v97, s41
    v_perm_b32 v48, v102, v98, s40
    v_perm_b32 v52, v102, v98, s41
    v_perm_b32 v56, v103, v99, s40
    v_perm_b32 v60, v103, v99, s41
    s_mov_b32 s7, 262144
    buffer_load_dwordx4 v[96:99], v24, s[32:35], s7 offen
    buffer_load_dwordx4 v[100:103], v25, s[32:35], s7 offen
    s_waitcnt vmcnt(14)
    v_perm_b32 v33, v108, v104, s40
    v_perm_b32 v37, v108, v104, s41
    v_perm_b32 v41, v109, v105, s40
    v_perm_b32 v45, v109, v105, s41
    v_perm_b32 v49, v110, v106, s40
    v_perm_b32 v53, v110, v106, s41
    v_perm_b32 v57, v111, v107, s40
    v_perm_b32 v61, v111, v107, s41
    s_mov_b32 s7, 278528
    buffer_load_dwordx4 v[104:107], v24, s[32:35], s7 offen
    buffer_load_dwordx4 v[108:111], v25, s[32:35], s7 offen
    s_waitcnt vmcnt(14)
    v_perm_b32 v34, v116, v112, s40
    v_perm_b32 v38, v116, v112, s41
    v_perm_b32 v42, v117, v113, s40
    v_perm_b32 v46, v117, v113, s41
    v_perm_b32 v50, v118, v114, s40
    v_perm_b32 v54, v118, v114, s41
    v_perm_b32 v58, v119, v115, s40
    v_perm_b32 v62, v119, v115, s41
    s_mov_b32 s7, 294912
    buffer_load_dwordx4 v[112:115], v24, s[32:35], s7 offen
    buffer_load_dwordx4 v[116:119], v25, s[32:35], s7 offen
    s_waitcnt vmcnt(14)
    v_perm_b32 v35, v124, v120, s40
    v_perm_b32 v39, v124, v120, s41
    v_perm_b32 v43, v125, v121, s40
    v_perm_b32 v47, v125, v121, s41
    v_perm_b32 v51, v126, v122, s40
    v_perm_b32 v55, v126, v122, s41
    v_perm_b32 v59, v127, v123, s40
    v_perm_b32 v63, v127, v123, s41
    s_mov_b32 s7, 311296
    buffer_load_dwordx4 v[120:123], v24, s[32:35], s7 offen
    buffer_load_dwordx4 v[124:127], v25, s[32:35], s7 offen
    ds_write_b128 v26, v[32:35] offset:6144
    ds_write_b128 v26, v[36:39] offset:7168
    ds_write_b128 v26, v[40:43] offset:6160
    ds_write_b128 v26, v[44:47] offset:7184
    ds_write_b128 v26, v[48:51] offset:6176
    ds_write_b128 v26, v[52:55] offset:7200
    ds_write_b128 v26, v[56:59] offset:6192
    ds_write_b128 v26, v[60:63] offset:7216
    s_waitcnt lgkmcnt(0)
    s_barrier
    ds_read_b128 a[0:3], v27 offset:0
    ds_read_b128 a[4:7], v27 offset:1024
    ds_read_b128 a[8:11], v27 offset:2048
    ds_read_b128 a[12:15], v27 offset:3072
    ds_read_b128 a[16:19], v27 offset:4096
    ds_read_b128 a[20:23], v27 offset:5120
    ds_read_b128 a[24:27], v27 offset:6144
    ds_read_b128 a[28:31], v27 offset:7168
    ds_read_b128 a[32:35], v27 offset:8192
    ds_read_b128 a[36:39], v27 offset:9216
    ds_read_b128 a[40:43], v27 offset:10240
    ds_read_b128 a[44:47], v27 offset:11264
    ds_read_b128 a[48:51], v27 offset:12288
    ds_read_b128 a[52:55], v27 offset:13312
    ds_read_b128 a[56:59], v27 offset:14336
    ds_read_b128 a[60:63], v27 offset:15360
    ds_read_b128 a[64:67], v27 offset:16384
    ds_read_b128 a[68:71], v27 offset:17408
    ds_read_b128 a[72:75], v27 offset:18432
    ds_read_b128 a[76:79], v27 offset:19456
    ds_read_b128 a[80:83], v27 offset:20480
    ds_read_b128 a[84:87], v27 offset:21504
    ds_read_b128 a[88:91], v27 offset:22528
    ds_read_b128 a[92:95], v27 offset:23552
    ds_read_b128 a[96:99], v27 offset:24576
    ds_read_b128 a[100:103], v27 offset:25600
    ds_read_b128 a[104:107], v27 offset:26624
    ds_read_b128 a[108:111], v27 offset:27648
    ds_read_b128 a[112:115], v27 offset:28672
    ds_read_b128 a[116:119], v27 offset:29696
    ds_read_b128 a[120:123], v27 offset:30720
    ds_read_b128 a[124:127], v27 offset:31744
    s_waitcnt lgkmcnt(0)
    s_barrier
    s_waitcnt vmcnt(14)
    v_perm_b32 v32, v68, v64, s40
    v_perm_b32 v36, v68, v64, s41
    v_perm_b32 v40, v69, v65, s40
    v_perm_b32 v44, v69, v65, s41
    v_perm_b32 v48, v70, v66, s40
    v_perm_b32 v52, v70, v66, s41
    v_perm_b32 v56, v71, v67, s40
    v_perm_b32 v60, v71, v67, s41
    s_mov_b32 s7, 524288
    buffer_load_dwordx4 v[64:67], v24, s[32:35], s7 offen
    buffer_load_dwordx4 v[68:71], v25, s[32:35], s7 offen
    s_waitcnt vmcnt(14)
    v_perm_b32 v33, v76, v72, s40
    v_perm_b32 v37, v76, v72, s41
    v_perm_b32 v41, v77, v73, s40
    v_perm_b32 v45, v77, v73, s41
    v_perm_b32 v49, v78, v74, s40
    v_perm_b32 v53, v78, v74, s41
    v_perm_b32 v57, v79, v75, s40
    v_perm_b32 v61, v79, v75, s41
    s_mov_b32 s7, 540672
    buffer_load_dwordx4 v[72:75], v24, s[32:35], s7 offen
    buffer_load_dwordx4 v[76:79], v25, s[32:35], s7 offen
    s_waitcnt vmcnt(14)
    v_perm_b32 v34, v84, v80, s40
    v_perm_b32 v38, v84, v80, s41
    v_perm_b32 v42, v85, v81, s40
    v_perm_b32 v46, v85, v81, s41
    v_perm_b32 v50, v86, v82, s40
    v_perm_b32 v54, v86, v82, s41
    v_perm_b32 v58, v87, v83, s40
    v_perm_b32 v62, v87, v83, s41
    s_mov_b32 s7, 557056
    buffer_load_dwordx4 v[80:83], v24, s[32:35], s7 offen
    buffer_load_dwordx4 v[84:87], v25, s[32:35], s7 offen
    s_waitcnt vmcnt(14)
    v_perm_b32 v35, v92, v88, s40
    v_perm_b32 v39, v92, v88, s41
    v_perm_b32 v43, v93, v89, s40
    v_perm_b32 v47, v93, v89, s41
    v_perm_b32 v51, v94, v90, s40
    v_perm_b32 v55, v94, v90, s41
    v_perm_b32 v59, v95, v91, s40
    v_perm_b32 v63, v95, v91, s41
    s_mov_b32 s7, 573440
    buffer_load_dwordx4 v[88:91], v24, s[32:35], s7 offen
    buffer_load_dwordx4 v[92:95], v25, s[32:35], s7 offen
    ds_write_b128 v26, v[32:35] offset:0
    ds_write_b128 v26, v[36:39] offset:1024
    ds_write_b128 v26, v[40:43] offset:16
    ds_write_b128 v26, v[44:47] offset:1040
    ds_write_b128 v26, v[48:51] offset:32
    ds_write_b128 v26, v[52:55] offset:1056
    ds_write_b128 v26, v[56:59] offset:48
    ds_write_b128 v26, v[60:63] offset:1072
    s_waitcnt vmcnt(14)
    v_perm_b32 v32, v100, v96, s40
    v_perm_b32 v36, v100, v96, s41
    v_perm_b32 v40, v101, v97, s40
    v_perm_b32 v44, v101, v97, s41
    v_perm_b32 v48, v102, v98, s40
    v_perm_b32 v52, v102, v98, s41
    v_perm_b32 v56, v103, v99, s40
    v_perm_b32 v60, v103, v99, s41
    s_mov_b32 s7, 786432
    buffer_load_dwordx4 v[96:99], v24, s[32:35], s7 offen
    buffer_load_dwordx4 v[100:103], v25, s[32:35], s7 offen
    s_waitcnt vmcnt(14)
    v_perm_b32 v33, v108, v104, s40
    v_perm_b32 v37, v108, v104, s41
    v_perm_b32 v41, v109, v105, s40
    v_perm_b32 v45, v109, v105, s41
    v_perm_b32 v49, v110, v106, s40
    v_perm_b32 v53, v110, v106, s41
    v_perm_b32 v57, v111, v107, s40
    v_perm_b32 v61, v111, v107, s41
    s_mov_b32 s7, 802816
    buffer_load_dwordx4 v[104:107], v24, s[32:35], s7 offen
    buffer_load_dwordx4 v[108:111], v25, s[32:35], s7 offen
    s_waitcnt vmcnt(14)
    v_perm_b32 v34, v116, v112, s40
    v_perm_b32 v38, v116, v112, s41
    v_perm_b32 v42, v117, v113, s40
    v_perm_b32 v46, v117, v113, s41
    v_perm_b32 v50, v118, v114, s40
    v_perm_b32 v54, v118, v114, s41
    v_perm_b32 v58, v119, v115, s40
    v_perm_b32 v62, v119, v115, s41
    s_mov_b32 s7, 819200
    buffer_load_dwordx4 v[112:115], v24, s[32:35], s7 offen
    buffer_load_dwordx4 v[116:119], v25, s[32:35], s7 offen
    s_waitcnt vmcnt(14)
    v_perm_b32 v35, v124, v120, s40
    v_perm_b32 v39, v124, v120, s41
    v_perm_b32 v43, v125, v121, s40
    v_perm_b32 v47, v125, v121, s41
    v_perm_b32 v51, v126, v122, s40
    v_perm_b32 v55, v126, v122, s41
    v_perm_b32 v59, v127, v123, s40
    v_perm_b32 v63, v127, v123, s41
    s_mov_b32 s7, 835584
    buffer_load_dwordx4 v[120:123], v24, s[32:35], s7 offen
    buffer_load_dwordx4 v[124:127], v25, s[32:35], s7 offen
    ds_write_b128 v26, v[32:35] offset:2048
    ds_write_b128 v26, v[36:39] offset:3072
    ds_write_b128 v26, v[40:43] offset:2064
    ds_write_b128 v26, v[44:47] offset:3088
    ds_write_b128 v26, v[48:51] offset:2080
    ds_write_b128 v26, v[52:55] offset:3104
    ds_write_b128 v26, v[56:59] offset:2096
    ds_write_b128 v26, v[60:63] offset:3120
    s_waitcnt vmcnt(14)
    v_perm_b32 v32, v68, v64, s40
    v_perm_b32 v36, v68, v64, s41
    v_perm_b32 v40, v69, v65, s40
    v_perm_b32 v44, v69, v65, s41
    v_perm_b32 v48, v70, v66, s40
    v_perm_b32 v52, v70, v66, s41
    v_perm_b32 v56, v71, v67, s40
    v_perm_b32 v60, v71, v67, s41
    s_mov_b32 s7, 0
    buffer_load_dwordx4 v[64:67], v24, s[28:31], s7 offen
    buffer_load_dwordx4 v[68:71], v25, s[28:31], s7 offen
    s_waitcnt vmcnt(14)
    v_perm_b32 v33, v76, v72, s40
    v_perm_b32 v37, v76, v72, s41
    v_perm_b32 v41, v77, v73, s40
    v_perm_b32 v45, v77, v73, s41
    v_perm_b32 v49, v78, v74, s40
    v_perm_b32 v53, v78, v74, s41
    v_perm_b32 v57, v79, v75, s40
    v_perm_b32 v61, v79, v75, s41
    s_mov_b32 s7, 16384
    buffer_load_dwordx4 v[72:75], v24, s[28:31], s7 offen
    buffer_load_dwordx4 v[76:79], v25, s[28:31], s7 offen
    s_waitcnt vmcnt(14)
    v_perm_b32 v34, v84, v80, s40
    v_perm_b32 v38, v84, v80, s41
    v_perm_b32 v42, v85, v81, s40
    v_perm_b32 v46, v85, v81, s41
    v_perm_b32 v50, v86, v82, s40
    v_perm_b32 v54, v86, v82, s41
    v_perm_b32 v58, v87, v83, s40
    v_perm_b32 v62, v87, v83, s41
    s_mov_b32 s7, 32768
    buffer_load_dwordx4 v[80:83], v24, s[28:31], s7 offen
    buffer_load_dwordx4 v[84:87], v25, s[28:31], s7 offen
    s_waitcnt vmcnt(14)
    v_perm_b32 v35, v92, v88, s40
    v_perm_b32 v39, v92, v88, s41
    v_perm_b32 v43, v93, v89, s40
    v_perm_b32 v47, v93, v89, s41
    v_perm_b32 v51, v94, v90, s40
    v_perm_b32 v55, v94, v90, s41
    v_perm_b32 v59, v95, v91, s40
    v_perm_b32 v63, v95, v91, s41
    s_mov_b32 s7, 49152
    buffer_load_dwordx4 v[88:91], v24, s[28:31], s7 offen
    buffer_load_dwordx4 v[92:95], v25, s[28:31], s7 offen
    ds_write_b128 v26, v[32:35] offset:4096
    ds_write_b128 v26, v[36:39] offset:5120
    ds_write_b128 v26, v[40:43] offset:4112
    ds_write_b128 v26, v[44:47] offset:5136
    ds_write_b128 v26, v[48:51] offset:4128
    ds_write_b128 v26, v[52:55] offset:5152
    ds_write_b128 v26, v[56:59] offset:4144
    ds_write_b128 v26, v[60:63] offset:5168
    s_waitcnt vmcnt(14)
    v_perm_b32 v32, v100, v96, s40
    v_perm_b32 v36, v100, v96, s41
    v_perm_b32 v40, v101, v97, s40
    v_perm_b32 v44, v101, v97, s41
    v_perm_b32 v48, v102, v98, s40
    v_perm_b32 v52, v102, v98, s41
    v_perm_b32 v56, v103, v99, s40
    v_perm_b32 v60, v103, v99, s41
    s_mov_b32 s7, 262144
    buffer_load_dwordx4 v[96:99], v24, s[28:31], s7 offen
    buffer_load_dwordx4 v[100:103], v25, s[28:31], s7 offen
    s_waitcnt vmcnt(14)
    v_perm_b32 v33, v108, v104, s40
    v_perm_b32 v37, v108, v104, s41
    v_perm_b32 v41, v109, v105, s40
    v_perm_b32 v45, v109, v105, s41
    v_perm_b32 v49, v110, v106, s40
    v_perm_b32 v53, v110, v106, s41
    v_perm_b32 v57, v111, v107, s40
    v_perm_b32 v61, v111, v107, s41
    s_mov_b32 s7, 278528
    buffer_load_dwordx4 v[104:107], v24, s[28:31], s7 offen
    buffer_load_dwordx4 v[108:111], v25, s[28:31], s7 offen
    s_waitcnt vmcnt(14)
    v_perm_b32 v34, v116, v112, s40
    v_perm_b32 v38, v116, v112, s41
    v_perm_b32 v42, v117, v113, s40
    v_perm_b32 v46, v117, v113, s41
    v_perm_b32 v50, v118, v114, s40
    v_perm_b32 v54, v118, v114, s41
    v_perm_b32 v58, v119, v115, s40
    v_perm_b32 v62, v119, v115, s41
    s_mov_b32 s7, 294912
    buffer_load_dwordx4 v[112:115], v24, s[28:31], s7 offen
    buffer_load_dwordx4 v[116:119], v25, s[28:31], s7 offen
    s_waitcnt vmcnt(14)
    v_perm_b32 v35, v124, v120, s40
    v_perm_b32 v39, v124, v120, s41
    v_perm_b32 v43, v125, v121, s40
    v_perm_b32 v47, v125, v121, s41
    v_perm_b32 v51, v126, v122, s40
    v_perm_b32 v55, v126, v122, s41
    v_perm_b32 v59, v127, v123, s40
    v_perm_b32 v63, v127, v123, s41
    s_mov_b32 s7, 311296
    buffer_load_dwordx4 v[120:123], v24, s[28:31], s7 offen
    buffer_load_dwordx4 v[124:127], v25, s[28:31], s7 offen
    ds_write_b128 v26, v[32:35] offset:6144
    ds_write_b128 v26, v[36:39] offset:7168
    ds_write_b128 v26, v[40:43] offset:6160
    ds_write_b128 v26, v[44:47] offset:7184
    ds_write_b128 v26, v[48:51] offset:6176
    ds_write_b128 v26, v[52:55] offset:7200
    ds_write_b128 v26, v[56:59] offset:6192
    ds_write_b128 v26, v[60:63] offset:7216
    s_waitcnt lgkmcnt(0)
    s_barrier
    ds_read_b128 v[128:131], v27 offset:0
    ds_read_b128 v[132:135], v27 offset:1024
    ds_read_b128 v[136:139], v27 offset:2048
    ds_read_b128 v[140:143], v27 offset:3072
    ds_read_b128 v[144:147], v27 offset:4096
    ds_read_b128 v[148:151], v27 offset:5120
    ds_read_b128 v[152:155], v27 offset:6144
    ds_read_b128 v[156:159], v27 offset:7168
    ds_read_b128 v[160:163], v27 offset:8192
    ds_read_b128 v[164:167], v27 offset:9216
    ds_read_b128 v[168:171], v27 offset:10240
    ds_read_b128 v[172:175], v27 offset:11264
    ds_read_b128 v[176:179], v27 offset:12288
    ds_read_b128 v[180:183], v27 offset:13312
    ds_read_b128 v[184:187], v27 offset:14336
    ds_read_b128 v[188:191], v27 offset:15360
    ds_read_b128 v[192:195], v27 offset:16384
    ds_read_b128 v[196:199], v27 offset:17408
    ds_read_b128 v[200:203], v27 offset:18432
    ds_read_b128 v[204:207], v27 offset:19456
    ds_read_b128 v[208:211], v27 offset:20480
    ds_read_b128 v[212:215], v27 offset:21504
    ds_read_b128 v[216:219], v27 offset:22528
    ds_read_b128 v[220:223], v27 offset:23552
    ds_read_b128 v[224:227], v27 offset:24576
    ds_read_b128 v[228:231], v27 offset:25600
    ds_read_b128 v[232:235], v27 offset:26624
    ds_read_b128 v[236:239], v27 offset:27648
    ds_read_b128 v[240:243], v27 offset:28672
    ds_read_b128 v[244:247], v27 offset:29696
    ds_read_b128 v[248:251], v27 offset:30720
    ds_read_b128 v[252:255], v27 offset:31744
    s_waitcnt lgkmcnt(0)
    s_barrier
    s_waitcnt vmcnt(14)
    v_perm_b32 v32, v68, v64, s40
    v_perm_b32 v36, v68, v64, s41
    v_perm_b32 v40, v69, v65, s40
    v_perm_b32 v44, v69, v65, s41
    v_perm_b32 v48, v70, v66, s40
    v_perm_b32 v52, v70, v66, s41
    v_perm_b32 v56, v71, v67, s40
    v_perm_b32 v60, v71, v67, s41
    s_mov_b32 s7, 524288
    buffer_load_dwordx4 v[64:67], v24, s[28:31], s7 offen
    buffer_load_dwordx4 v[68:71], v25, s[28:31], s7 offen
    s_waitcnt vmcnt(14)
    v_perm_b32 v33, v76, v72, s40
    v_perm_b32 v37, v76, v72, s41
    v_perm_b32 v41, v77, v73, s40
    v_perm_b32 v45, v77, v73, s41
    v_perm_b32 v49, v78, v74, s40
    v_perm_b32 v53, v78, v74, s41
    v_perm_b32 v57, v79, v75, s40
    v_perm_b32 v61, v79, v75, s41
    s_mov_b32 s7, 540672
    buffer_load_dwordx4 v[72:75], v24, s[28:31], s7 offen
    buffer_load_dwordx4 v[76:79], v25, s[28:31], s7 offen
    s_waitcnt vmcnt(14)
    v_perm_b32 v34, v84, v80, s40
    v_perm_b32 v38, v84, v80, s41
    v_perm_b32 v42, v85, v81, s40
    v_perm_b32 v46, v85, v81, s41
    v_perm_b32 v50, v86, v82, s40
    v_perm_b32 v54, v86, v82, s41
    v_perm_b32 v58, v87, v83, s40
    v_perm_b32 v62, v87, v83, s41
    s_mov_b32 s7, 557056
    buffer_load_dwordx4 v[80:83], v24, s[28:31], s7 offen
    buffer_load_dwordx4 v[84:87], v25, s[28:31], s7 offen
    s_waitcnt vmcnt(14)
    v_perm_b32 v35, v92, v88, s40
    v_perm_b32 v39, v92, v88, s41
    v_perm_b32 v43, v93, v89, s40
    v_perm_b32 v47, v93, v89, s41
    v_perm_b32 v51, v94, v90, s40
    v_perm_b32 v55, v94, v90, s41
    v_perm_b32 v59, v95, v91, s40
    v_perm_b32 v63, v95, v91, s41
    s_mov_b32 s7, 573440
    buffer_load_dwordx4 v[88:91], v24, s[28:31], s7 offen
    buffer_load_dwordx4 v[92:95], v25, s[28:31], s7 offen
    ds_write_b128 v26, v[32:35] offset:0
    ds_write_b128 v26, v[36:39] offset:1024
    ds_write_b128 v26, v[40:43] offset:16
    ds_write_b128 v26, v[44:47] offset:1040
    ds_write_b128 v26, v[48:51] offset:32
    ds_write_b128 v26, v[52:55] offset:1056
    ds_write_b128 v26, v[56:59] offset:48
    ds_write_b128 v26, v[60:63] offset:1072
    s_waitcnt vmcnt(14)
    v_perm_b32 v32, v100, v96, s40
    v_perm_b32 v36, v100, v96, s41
    v_perm_b32 v40, v101, v97, s40
    v_perm_b32 v44, v101, v97, s41
    v_perm_b32 v48, v102, v98, s40
    v_perm_b32 v52, v102, v98, s41
    v_perm_b32 v56, v103, v99, s40
    v_perm_b32 v60, v103, v99, s41
    s_mov_b32 s7, 786432
    buffer_load_dwordx4 v[96:99], v24, s[28:31], s7 offen
    buffer_load_dwordx4 v[100:103], v25, s[28:31], s7 offen
    s_waitcnt vmcnt(14)
    v_perm_b32 v33, v108, v104, s40
    v_perm_b32 v37, v108, v104, s41
    v_perm_b32 v41, v109, v105, s40
    v_perm_b32 v45, v109, v105, s41
    v_perm_b32 v49, v110, v106, s40
    v_perm_b32 v53, v110, v106, s41
    v_perm_b32 v57, v111, v107, s40
    v_perm_b32 v61, v111, v107, s41
    s_mov_b32 s7, 802816
    buffer_load_dwordx4 v[104:107], v24, s[28:31], s7 offen
    buffer_load_dwordx4 v[108:111], v25, s[28:31], s7 offen
    s_waitcnt vmcnt(14)
    v_perm_b32 v34, v116, v112, s40
    v_perm_b32 v38, v116, v112, s41
    v_perm_b32 v42, v117, v113, s40
    v_perm_b32 v46, v117, v113, s41
    v_perm_b32 v50, v118, v114, s40
    v_perm_b32 v54, v118, v114, s41
    v_perm_b32 v58, v119, v115, s40
    v_perm_b32 v62, v119, v115, s41
    s_mov_b32 s7, 819200
    buffer_load_dwordx4 v[112:115], v24, s[28:31], s7 offen
    buffer_load_dwordx4 v[116:119], v25, s[28:31], s7 offen
    s_waitcnt vmcnt(14)
    v_perm_b32 v35, v124, v120, s40
    v_perm_b32 v39, v124, v120, s41
    v_perm_b32 v43, v125, v121, s40
    v_perm_b32 v47, v125, v121, s41
    v_perm_b32 v51, v126, v122, s40
    v_perm_b32 v55, v126, v122, s41
    v_perm_b32 v59, v127, v123, s40
    v_perm_b32 v63, v127, v123, s41
    s_mov_b32 s7, 835584
    buffer_load_dwordx4 v[120:123], v24, s[28:31], s7 offen
    buffer_load_dwordx4 v[124:127], v25, s[28:31], s7 offen
    ds_write_b128 v26, v[32:35] offset:2048
    ds_write_b128 v26, v[36:39] offset:3072
    ds_write_b128 v26, v[40:43] offset:2064
    ds_write_b128 v26, v[44:47] offset:3088
    ds_write_b128 v26, v[48:51] offset:2080
    ds_write_b128 v26, v[52:55] offset:3104
    ds_write_b128 v26, v[56:59] offset:2096
    ds_write_b128 v26, v[60:63] offset:3120
    s_waitcnt vmcnt(14)
    v_perm_b32 v32, v68, v64, s40
    v_perm_b32 v36, v68, v64, s41
    v_perm_b32 v40, v69, v65, s40
    v_perm_b32 v44, v69, v65, s41
    v_perm_b32 v48, v70, v66, s40
    v_perm_b32 v52, v70, v66, s41
    v_perm_b32 v56, v71, v67, s40
    v_perm_b32 v60, v71, v67, s41
    s_waitcnt vmcnt(12)
    v_perm_b32 v33, v76, v72, s40
    v_perm_b32 v37, v76, v72, s41
    v_perm_b32 v41, v77, v73, s40
    v_perm_b32 v45, v77, v73, s41
    v_perm_b32 v49, v78, v74, s40
    v_perm_b32 v53, v78, v74, s41
    v_perm_b32 v57, v79, v75, s40
    v_perm_b32 v61, v79, v75, s41
    s_waitcnt vmcnt(10)
    v_perm_b32 v34, v84, v80, s40
    v_perm_b32 v38, v84, v80, s41
    v_perm_b32 v42, v85, v81, s40
    v_perm_b32 v46, v85, v81, s41
    v_perm_b32 v50, v86, v82, s40
    v_perm_b32 v54, v86, v82, s41
    v_perm_b32 v58, v87, v83, s40
    v_perm_b32 v62, v87, v83, s41
    s_waitcnt vmcnt(8)
    v_perm_b32 v35, v92, v88, s40
    v_perm_b32 v39, v92, v88, s41
    v_perm_b32 v43, v93, v89, s40
    v_perm_b32 v47, v93, v89, s41
    v_perm_b32 v51, v94, v90, s40
    v_perm_b32 v55, v94, v90, s41
    v_perm_b32 v59, v95, v91, s40
    v_perm_b32 v63, v95, v91, s41
    ds_write_b128 v26, v[32:35] offset:4096
    ds_write_b128 v26, v[36:39] offset:5120
    ds_write_b128 v26, v[40:43] offset:4112
    ds_write_b128 v26, v[44:47] offset:5136
    ds_write_b128 v26, v[48:51] offset:4128
    ds_write_b128 v26, v[52:55] offset:5152
    ds_write_b128 v26, v[56:59] offset:4144
    ds_write_b128 v26, v[60:63] offset:5168
    s_waitcnt vmcnt(6)
    v_perm_b32 v32, v100, v96, s40
    v_perm_b32 v36, v100, v96, s41
    v_perm_b32 v40, v101, v97, s40
    v_perm_b32 v44, v101, v97, s41
    v_perm_b32 v48, v102, v98, s40
    v_perm_b32 v52, v102, v98, s41
    v_perm_b32 v56, v103, v99, s40
    v_perm_b32 v60, v103, v99, s41
    s_waitcnt vmcnt(4)
    v_perm_b32 v33, v108, v104, s40
    v_perm_b32 v37, v108, v104, s41
    v_perm_b32 v41, v109, v105, s40
    v_perm_b32 v45, v109, v105, s41
    v_perm_b32 v49, v110, v106, s40
    v_perm_b32 v53, v110, v106, s41
    v_perm_b32 v57, v111, v107, s40
    v_perm_b32 v61, v111, v107, s41
    s_waitcnt vmcnt(2)
    v_perm_b32 v34, v116, v112, s40
    v_perm_b32 v38, v116, v112, s41
    v_perm_b32 v42, v117, v113, s40
    v_perm_b32 v46, v117, v113, s41
    v_perm_b32 v50, v118, v114, s40
    v_perm_b32 v54, v118, v114, s41
    v_perm_b32 v58, v119, v115, s40
    v_perm_b32 v62, v119, v115, s41
    s_waitcnt vmcnt(0)
    v_perm_b32 v35, v124, v120, s40
    v_perm_b32 v39, v124, v120, s41
    v_perm_b32 v43, v125, v121, s40
    v_perm_b32 v47, v125, v121, s41
    v_perm_b32 v51, v126, v122, s40
    v_perm_b32 v55, v126, v122, s41
    v_perm_b32 v59, v127, v123, s40
    v_perm_b32 v63, v127, v123, s41
    ds_write_b128 v26, v[32:35] offset:6144
    ds_write_b128 v26, v[36:39] offset:7168
    ds_write_b128 v26, v[40:43] offset:6160
    ds_write_b128 v26, v[44:47] offset:7184
    ds_write_b128 v26, v[48:51] offset:6176
    ds_write_b128 v26, v[52:55] offset:7200
    ds_write_b128 v26, v[56:59] offset:6192
    ds_write_b128 v26, v[60:63] offset:7216
    s_waitcnt lgkmcnt(0)
    s_barrier
    ds_read_b128 a[128:131], v27 offset:0
    ds_read_b128 a[132:135], v27 offset:1024
    ds_read_b128 a[136:139], v27 offset:2048
    ds_read_b128 a[140:143], v27 offset:3072
    ds_read_b128 a[144:147], v27 offset:4096
    ds_read_b128 a[148:151], v27 offset:5120
    ds_read_b128 a[152:155], v27 offset:6144
    ds_read_b128 a[156:159], v27 offset:7168
    ds_read_b128 a[160:163], v27 offset:8192
    ds_read_b128 a[164:167], v27 offset:9216
    ds_read_b128 a[168:171], v27 offset:10240
    ds_read_b128 a[172:175], v27 offset:11264
    ds_read_b128 a[176:179], v27 offset:12288
    ds_read_b128 a[180:183], v27 offset:13312
    ds_read_b128 a[184:187], v27 offset:14336
    ds_read_b128 a[188:191], v27 offset:15360
    ds_read_b128 a[192:195], v27 offset:16384
    ds_read_b128 a[196:199], v27 offset:17408
    ds_read_b128 a[200:203], v27 offset:18432
    ds_read_b128 a[204:207], v27 offset:19456
    ds_read_b128 a[208:211], v27 offset:20480
    ds_read_b128 a[212:215], v27 offset:21504
    ds_read_b128 a[216:219], v27 offset:22528
    ds_read_b128 a[220:223], v27 offset:23552
    ds_read_b128 a[224:227], v27 offset:24576
    ds_read_b128 a[228:231], v27 offset:25600
    ds_read_b128 a[232:235], v27 offset:26624
    ds_read_b128 a[236:239], v27 offset:27648
    ds_read_b128 a[240:243], v27 offset:28672
    ds_read_b128 a[244:247], v27 offset:29696
    ds_read_b128 a[248:251], v27 offset:30720
    ds_read_b128 a[252:255], v27 offset:31744
    s_waitcnt lgkmcnt(0)
    s_barrier
    s_lshl_b32 s90, s5, 15
    s_lshl_b32 s91, s3, 13
    s_add_u32 s90, s90, s91
    s_mul_i32 s91, s3, 8320
    s_add_u32 s91, s91, s46
    s_add_u32 m0, s91, 0
    s_nop 0
    buffer_load_dwordx4 v0, s[8:11], s90 offen lds
    s_add_u32 s90, s90, 1024
    s_add_u32 m0, s91, 1040
    s_nop 0
    buffer_load_dwordx4 v0, s[8:11], s90 offen lds
    s_add_u32 s90, s90, 1024
    s_add_u32 m0, s91, 2080
    s_nop 0
    buffer_load_dwordx4 v0, s[8:11], s90 offen lds
    s_add_u32 s90, s90, 1024
    s_add_u32 m0, s91, 3120
    s_nop 0
    buffer_load_dwordx4 v0, s[8:11], s90 offen lds
    s_add_u32 s90, s90, 1024
    s_add_u32 m0, s91, 4160
    s_nop 0
    buffer_load_dwordx4 v0, s[8:11], s90 offen lds
    s_add_u32 s90, s90, 1024
    s_add_u32 m0, s91, 5200
    s_nop 0
    buffer_load_dwordx4 v0, s[8:11], s90 offen lds
    s_add_u32 s90, s90, 1024
    s_add_u32 m0, s91, 6240
    s_nop 0
    buffer_load_dwordx4 v0, s[8:11], s90 offen lds
    s_add_u32 s90, s90, 1024
    s_add_u32 m0, s91, 7280
    s_nop 0
    buffer_load_dwordx4 v0, s[8:11], s90 offen lds
    s_waitcnt vmcnt(0)
B_loop:
    s_waitcnt vmcnt(6)
    s_barrier
    s_lshl_b32 s43, s6, 1
    s_add_u32 s43, s43, s5
    s_add_u32 s44, s43, 2
    s_min_u32 s44, s44, 63
    s_sub_u32 s45, 33280, s46
    s_lshl_b32 s90, s44, 15
    s_lshl_b32 s91, s3, 13
    s_add_u32 s90, s90, s91
    s_mul_i32 s91, s3, 8320
    s_add_u32 s91, s91, s45
    s_add_u32 m0, s91, 0
    s_nop 0
    buffer_load_dwordx4 v0, s[8:11], s90 offen lds
    s_add_u32 s90, s90, 1024
    s_add_u32 m0, s91, 1040
    s_nop 0
    buffer_load_dwordx4 v0, s[8:11], s90 offen lds
    s_add_u32 s90, s90, 1024
    s_add_u32 m0, s91, 2080
    s_nop 0
    buffer_load_dwordx4 v0, s[8:11], s90 offen lds
    s_add_u32 s90, s90, 1024
    s_add_u32 m0, s91, 3120
    s_nop 0
    buffer_load_dwordx4 v0, s[8:11], s90 offen lds
    s_add_u32 s90, s90, 1024
    s_add_u32 m0, s91, 4160
    s_nop 0
    buffer_load_dwordx4 v0, s[8:11], s90 offen lds
    s_add_u32 s90, s90, 1024
    s_add_u32 m0, s91, 5200
    s_nop 0
    buffer_load_dwordx4 v0, s[8:11], s90 offen lds
    s_add_u32 s90, s90, 1024
    s_add_u32 m0, s91, 6240
    s_nop 0
    buffer_load_dwordx4 v0, s[8:11], s90 offen lds
    s_add_u32 s90, s90, 1024
    s_add_u32 m0, s91, 7280
    s_nop 0
    buffer_load_dwordx4 v0, s[8:11], s90 offen lds
    v_add_u32 v4, s46, v3
    ds_read_b128 v[32:35], v4 offset:0
    ds_read_b128 v[36:39], v4 offset:16640
    ds_read_b128 v[40:43], v4 offset:64
    ds_read_b128 v[44:47], v4 offset:16704
    ds_read_b128 v[48:51], v4 offset:128
    ds_read_b128 v[52:55], v4 offset:16768
    s_waitcnt lgkmcnt(4)
    v_mfma_f32_16x16x32_bf16 v[64:67], a[0:3], v[32:35], 0
    v_mfma_f32_16x16x32_bf16 v[68:71], a[0:3], v[36:39], 0
    v_mfma_f32_16x16x32_bf16 v[72:75], a[4:7], v[32:35], 0
    v_mfma_f32_16x16x32_bf16 v[76:79], a[4:7], v[36:39], 0
    v_mfma_f32_16x16x32_bf16 v[80:83], v[32:35], a[128:131], 0
    v_mfma_f32_16x16x32_bf16 v[84:87], v[36:39], a[128:131], 0
    v_mfma_f32_16x16x32_bf16 v[88:91], v[32:35], a[132:135], 0
    v_mfma_f32_16x16x32_bf16 v[92:95], v[36:39], a[132:135], 0
    v_mfma_f32_16x16x32_bf16 v[96:99], v[128:131], v[32:35], 0
    v_mfma_f32_16x16x32_bf16 v[100:103], v[128:131], v[36:39], 0
    v_mfma_f32_16x16x32_bf16 v[104:107], v[132:135], v[32:35], 0
    v_mfma_f32_16x16x32_bf16 v[108:111], v[132:135], v[36:39], 0
    ds_read_b128 v[32:35], v4 offset:192
    ds_read_b128 v[36:39], v4 offset:16832
    s_waitcnt lgkmcnt(4)
    v_mfma_f32_16x16x32_bf16 v[64:67], a[8:11], v[40:43], v[64:67]
    v_mfma_f32_16x16x32_bf16 v[68:71], a[8:11], v[44:47], v[68:71]
    v_mfma_f32_16x16x32_bf16 v[72:75], a[12:15], v[40:43], v[72:75]
    v_mfma_f32_16x16x32_bf16 v[76:79], a[12:15], v[44:47], v[76:79]
    v_mfma_f32_16x16x32_bf16 v[80:83], v[40:43], a[136:139], v[80:83]
    v_mfma_f32_16x16x32_bf16 v[84:87], v[44:47], a[136:139], v[84:87]
    v_mfma_f32_16x16x32_bf16 v[88:91], v[40:43], a[140:143], v[88:91]
    v_mfma_f32_16x16x32_bf16 v[92:95], v[44:47], a[140:143], v[92:95]
    v_mfma_f32_16x16x32_bf16 v[96:99], v[136:139], v[40:43], v[96:99]
    v_mfma_f32_16x16x32_bf16 v[100:103], v[136:139], v[44:47], v[100:103]
    v_mfma_f32_16x16x32_bf16 v[104:107], v[140:143], v[40:43], v[104:107]
    v_mfma_f32_16x16x32_bf16 v[108:111], v[140:143], v[44:47], v[108:111]
    ds_read_b128 v[40:43], v4 offset:256
    ds_read_b128 v[44:47], v4 offset:16896
    s_waitcnt lgkmcnt(4)
    v_mfma_f32_16x16x32_bf16 v[64:67], a[16:19], v[48:51], v[64:67]
    v_mfma_f32_16x16x32_bf16 v[68:71], a[16:19], v[52:55], v[68:71]
    v_mfma_f32_16x16x32_bf16 v[72:75], a[20:23], v[48:51], v[72:75]
    v_mfma_f32_16x16x32_bf16 v[76:79], a[20:23], v[52:55], v[76:79]
    v_mfma_f32_16x16x32_bf16 v[80:83], v[48:51], a[144:147], v[80:83]
    v_mfma_f32_16x16x32_bf16 v[84:87], v[52:55], a[144:147], v[84:87]
    v_mfma_f32_16x16x32_bf16 v[88:91], v[48:51], a[148:151], v[88:91]
    v_mfma_f32_16x16x32_bf16 v[92:95], v[52:55], a[148:151], v[92:95]
    v_mfma_f32_16x16x32_bf16 v[96:99], v[144:147], v[48:51], v[96:99]
    v_mfma_f32_16x16x32_bf16 v[100:103], v[144:147], v[52:55], v[100:103]
    v_mfma_f32_16x16x32_bf16 v[104:107], v[148:151], v[48:51], v[104:107]
    v_mfma_f32_16x16x32_bf16 v[108:111], v[148:151], v[52:55], v[108:111]
    ds_read_b128 v[48:51], v4 offset:320
    ds_read_b128 v[52:55], v4 offset:16960
    s_waitcnt lgkmcnt(4)
    v_mfma_f32_16x16x32_bf16 v[64:67], a[24:27], v[32:35], v[64:67]
    v_mfma_f32_16x16x32_bf16 v[68:71], a[24:27], v[36:39], v[68:71]
    v_mfma_f32_16x16x32_bf16 v[72:75], a[28:31], v[32:35], v[72:75]
    v_mfma_f32_16x16x32_bf16 v[76:79], a[28:31], v[36:39], v[76:79]
    v_mfma_f32_16x16x32_bf16 v[80:83], v[32:35], a[152:155], v[80:83]
    v_mfma_f32_16x16x32_bf16 v[84:87], v[36:39], a[152:155], v[84:87]
    v_mfma_f32_16x16x32_bf16 v[88:91], v[32:35], a[156:159], v[88:91]
    v_mfma_f32_16x16x32_bf16 v[92:95], v[36:39], a[156:159], v[92:95]
    v_mfma_f32_16x16x32_bf16 v[96:99], v[152:155], v[32:35], v[96:99]
    v_mfma_f32_16x16x32_bf16 v[100:103], v[152:155], v[36:39], v[100:103]
    v_mfma_f32_16x16x32_bf16 v[104:107], v[156:159], v[32:35], v[104:107]
    v_mfma_f32_16x16x32_bf16 v[108:111], v[156:159], v[36:39], v[108:111]
    ds_read_b128 v[32:35], v4 offset:384
    ds_read_b128 v[36:39], v4 offset:17024
    s_waitcnt lgkmcnt(4)
    v_mfma_f32_16x16x32_bf16 v[64:67], a[32:35], v[40:43], v[64:67]
    v_mfma_f32_16x16x32_bf16 v[68:71], a[32:35], v[44:47], v[68:71]
    v_mfma_f32_16x16x32_bf16 v[72:75], a[36:39], v[40:43], v[72:75]
    v_mfma_f32_16x16x32_bf16 v[76:79], a[36:39], v[44:47], v[76:79]
    v_mfma_f32_16x16x32_bf16 v[80:83], v[40:43], a[160:163], v[80:83]
    v_mfma_f32_16x16x32_bf16 v[84:87], v[44:47], a[160:163], v[84:87]
    v_mfma_f32_16x16x32_bf16 v[88:91], v[40:43], a[164:167], v[88:91]
    v_mfma_f32_16x16x32_bf16 v[92:95], v[44:47], a[164:167], v[92:95]
    v_mfma_f32_16x16x32_bf16 v[96:99], v[160:163], v[40:43], v[96:99]
    v_mfma_f32_16x16x32_bf16 v[100:103], v[160:163], v[44:47], v[100:103]
    v_mfma_f32_16x16x32_bf16 v[104:107], v[164:167], v[40:43], v[104:107]
    v_mfma_f32_16x16x32_bf16 v[108:111], v[164:167], v[44:47], v[108:111]
    s_waitcnt vmcnt(8)
    s_barrier
    s_cmp_lg_u32 s3, 0
    s_cbranch_scc1 BF_35
    s_max_u32 s7, s6, 0
    v_mov_b32 v6, s6
    v_writelane_b32 v6, s7, 0
    s_mov_b64 exec, 3
    buffer_store_dword v6, v5, s[12:15], s47 offen sc1
    s_mov_b64 exec, -1
BF_35:
    ds_read_b128 v[40:43], v4 offset:448
    ds_read_b128 v[44:47], v4 offset:17088
    s_waitcnt lgkmcnt(4)
    v_mfma_f32_16x16x32_bf16 v[64:67], a[40:43], v[48:51], v[64:67]
    v_mfma_f32_16x16x32_bf16 v[68:71], a[40:43], v[52:55], v[68:71]
    v_mfma_f32_16x16x32_bf16 v[72:75], a[44:47], v[48:51], v[72:75]
    v_mfma_f32_16x16x32_bf16 v[76:79], a[44:47], v[52:55], v[76:79]
    v_mfma_f32_16x16x32_bf16 v[80:83], v[48:51], a[168:171], v[80:83]
    v_mfma_f32_16x16x32_bf16 v[84:87], v[52:55], a[168:171], v[84:87]
    v_mfma_f32_16x16x32_bf16 v[88:91], v[48:51], a[172:175], v[88:91]
    v_mfma_f32_16x16x32_bf16 v[92:95], v[52:55], a[172:175], v[92:95]
    v_mfma_f32_16x16x32_bf16 v[96:99], v[168:171], v[48:51], v[96:99]
    v_mfma_f32_16x16x32_bf16 v[100:103], v[168:171], v[52:55], v[100:103]
    v_mfma_f32_16x16x32_bf16 v[104:107], v[172:175], v[48:51], v[104:107]
    v_mfma_f32_16x16x32_bf16 v[108:111], v[172:175], v[52:55], v[108:111]
    ds_read_b128 v[48:51], v4 offset:512
    ds_read_b128 v[52:55], v4 offset:17152
    s_waitcnt lgkmcnt(4)
    v_mfma_f32_16x16x32_bf16 v[64:67], a[48:51], v[32:35], v[64:67]
    v_mfma_f32_16x16x32_bf16 v[68:71], a[48:51], v[36:39], v[68:71]
    v_mfma_f32_16x16x32_bf16 v[72:75], a[52:55], v[32:35], v[72:75]
    v_mfma_f32_16x16x32_bf16 v[76:79], a[52:55], v[36:39], v[76:79]
    v_mfma_f32_16x16x32_bf16 v[80:83], v[32:35], a[176:179], v[80:83]
    v_mfma_f32_16x16x32_bf16 v[84:87], v[36:39], a[176:179], v[84:87]
    v_mfma_f32_16x16x32_bf16 v[88:91], v[32:35], a[180:183], v[88:91]
    v_mfma_f32_16x16x32_bf16 v[92:95], v[36:39], a[180:183], v[92:95]
    v_mfma_f32_16x16x32_bf16 v[96:99], v[176:179], v[32:35], v[96:99]
    v_mfma_f32_16x16x32_bf16 v[100:103], v[176:179], v[36:39], v[100:103]
    v_mfma_f32_16x16x32_bf16 v[104:107], v[180:183], v[32:35], v[104:107]
    v_mfma_f32_16x16x32_bf16 v[108:111], v[180:183], v[36:39], v[108:111]
    ds_read_b128 v[32:35], v4 offset:576
    ds_read_b128 v[36:39], v4 offset:17216
    s_waitcnt lgkmcnt(4)
    v_mfma_f32_16x16x32_bf16 v[64:67], a[56:59], v[40:43], v[64:67]
    v_mfma_f32_16x16x32_bf16 v[68:71], a[56:59], v[44:47], v[68:71]
    v_mfma_f32_16x16x32_bf16 v[72:75], a[60:63], v[40:43], v[72:75]
    v_mfma_f32_16x16x32_bf16 v[76:79], a[60:63], v[44:47], v[76:79]
    v_mfma_f32_16x16x32_bf16 v[80:83], v[40:43], a[184:187], v[80:83]
    v_mfma_f32_16x16x32_bf16 v[84:87], v[44:47], a[184:187], v[84:87]
    v_mfma_f32_16x16x32_bf16 v[88:91], v[40:43], a[188:191], v[88:91]
    v_mfma_f32_16x16x32_bf16 v[92:95], v[44:47], a[188:191], v[92:95]
    v_mfma_f32_16x16x32_bf16 v[96:99], v[184:187], v[40:43], v[96:99]
    v_mfma_f32_16x16x32_bf16 v[100:103], v[184:187], v[44:47], v[100:103]
    v_mfma_f32_16x16x32_bf16 v[104:107], v[188:191], v[40:43], v[104:107]
    v_mfma_f32_16x16x32_bf16 v[108:111], v[188:191], v[44:47], v[108:111]
    ds_read_b128 v[40:43], v4 offset:640
    ds_read_b128 v[44:47], v4 offset:17280
    s_waitcnt lgkmcnt(4)
    v_mfma_f32_16x16x32_bf16 v[64:67], a[64:67], v[48:51], v[64:67]
    v_mfma_f32_16x16x32_bf16 v[68:71], a[64:67], v[52:55], v[68:71]
    v_mfma_f32_16x16x32_bf16 v[72:75], a[68:71], v[48:51], v[72:75]
    v_mfma_f32_16x16x32_bf16 v[76:79], a[68:71], v[52:55], v[76:79]
    v_mfma_f32_16x16x32_bf16 v[80:83], v[48:51], a[192:195], v[80:83]
    v_mfma_f32_16x16x32_bf16 v[84:87], v[52:55], a[192:195], v[84:87]
    v_mfma_f32_16x16x32_bf16 v[88:91], v[48:51], a[196:199], v[88:91]
    v_mfma_f32_16x16x32_bf16 v[92:95], v[52:55], a[196:199], v[92:95]
    v_mfma_f32_16x16x32_bf16 v[96:99], v[192:195], v[48:51], v[96:99]
    v_mfma_f32_16x16x32_bf16 v[100:103], v[192:195], v[52:55], v[100:103]
    v_mfma_f32_16x16x32_bf16 v[104:107], v[196:199], v[48:51], v[104:107]
    v_mfma_f32_16x16x32_bf16 v[108:111], v[196:199], v[52:55], v[108:111]
    ds_read_b128 v[48:51], v4 offset:704
    ds_read_b128 v[52:55], v4 offset:17344
    s_waitcnt lgkmcnt(4)
    v_mfma_f32_16x16x32_bf16 v[64:67], a[72:75], v[32:35], v[64:67]
    v_mfma_f32_16x16x32_bf16 v[68:71], a[72:75], v[36:39], v[68:71]
    v_mfma_f32_16x16x32_bf16 v[72:75], a[76:79], v[32:35], v[72:75]
    v_mfma_f32_16x16x32_bf16 v[76:79], a[76:79], v[36:39], v[76:79]
    v_mfma_f32_16x16x32_bf16 v[80:83], v[32:35], a[200:203], v[80:83]
    v_mfma_f32_16x16x32_bf16 v[84:87], v[36:39], a[200:203], v[84:87]
    v_mfma_f32_16x16x32_bf16 v[88:91], v[32:35], a[204:207], v[88:91]
    v_mfma_f32_16x16x32_bf16 v[92:95], v[36:39], a[204:207], v[92:95]
    v_mfma_f32_16x16x32_bf16 v[96:99], v[200:203], v[32:35], v[96:99]
    v_mfma_f32_16x16x32_bf16 v[100:103], v[200:203], v[36:39], v[100:103]
    v_mfma_f32_16x16x32_bf16 v[104:107], v[204:207], v[32:35], v[104:107]
    v_mfma_f32_16x16x32_bf16 v[108:111], v[204:207], v[36:39], v[108:111]
    ds_read_b128 v[32:35], v4 offset:768
    ds_read_b128 v[36:39], v4 offset:17408
    s_waitcnt lgkmcnt(4)
    v_mfma_f32_16x16x32_bf16 v[64:67], a[80:83], v[40:43], v[64:67]
    v_mfma_f32_16x16x32_bf16 v[68:71], a[80:83], v[44:47], v[68:71]
    v_mfma_f32_16x16x32_bf16 v[72:75], a[84:87], v[40:43], v[72:75]
    v_mfma_f32_16x16x32_bf16 v[76:79], a[84:87], v[44:47], v[76:79]
    v_mfma_f32_16x16x32_bf16 v[80:83], v[40:43], a[208:211], v[80:83]
    v_mfma_f32_16x16x32_bf16 v[84:87], v[44:47], a[208:211], v[84:87]
    v_mfma_f32_16x16x32_bf16 v[88:91], v[40:43], a[212:215], v[88:91]
    v_mfma_f32_16x16x32_bf16 v[92:95], v[44:47], a[212:215], v[92:95]
    v_mfma_f32_16x16x32_bf16 v[96:99], v[208:211], v[40:43], v[96:99]
    v_mfma_f32_16x16x32_bf16 v[100:103], v[208:211], v[44:47], v[100:103]
    v_mfma_f32_16x16x32_bf16 v[104:107], v[212:215], v[40:43], v[104:107]
    v_mfma_f32_16x16x32_bf16 v[108:111], v[212:215], v[44:47], v[108:111]
    ds_read_b128 v[40:43], v4 offset:832
    ds_read_b128 v[44:47], v4 offset:17472
    s_waitcnt lgkmcnt(4)
    v_mfma_f32_16x16x32_bf16 v[64:67], a[88:91], v[48:51], v[64:67]
    v_mfma_f32_16x16x32_bf16 v[68:71], a[88:91], v[52:55], v[68:71]
    v_mfma_f32_16x16x32_bf16 v[72:75], a[92:95], v[48:51], v[72:75]
    v_mfma_f32_16x16x32_bf16 v[76:79], a[92:95], v[52:55], v[76:79]
    v_mfma_f32_16x16x32_bf16 v[80:83], v[48:51], a[216:219], v[80:83]
    v_mfma_f32_16x16x32_bf16 v[84:87], v[52:55], a[216:219], v[84:87]
    v_mfma_f32_16x16x32_bf16 v[88:91], v[48:51], a[220:223], v[88:91]
    v_mfma_f32_16x16x32_bf16 v[92:95], v[52:55], a[220:223], v[92:95]
    v_mfma_f32_16x16x32_bf16 v[96:99], v[216:219], v[48:51], v[96:99]
    v_mfma_f32_16x16x32_bf16 v[100:103], v[216:219], v[52:55], v[100:103]
    v_mfma_f32_16x16x32_bf16 v[104:107], v[220:223], v[48:51], v[104:107]
    v_mfma_f32_16x16x32_bf16 v[108:111], v[220:223], v[52:55], v[108:111]
    ds_read_b128 v[48:51], v4 offset:896
    ds_read_b128 v[52:55], v4 offset:17536
    s_waitcnt lgkmcnt(4)
    v_mfma_f32_16x16x32_bf16 v[64:67], a[96:99], v[32:35], v[64:67]
    v_mfma_f32_16x16x32_bf16 v[68:71], a[96:99], v[36:39], v[68:71]
    v_mfma_f32_16x16x32_bf16 v[72:75], a[100:103], v[32:35], v[72:75]
    v_mfma_f32_16x16x32_bf16 v[76:79], a[100:103], v[36:39], v[76:79]
    v_mfma_f32_16x16x32_bf16 v[80:83], v[32:35], a[224:227], v[80:83]
    v_mfma_f32_16x16x32_bf16 v[84:87], v[36:39], a[224:227], v[84:87]
    v_mfma_f32_16x16x32_bf16 v[88:91], v[32:35], a[228:231], v[88:91]
    v_mfma_f32_16x16x32_bf16 v[92:95], v[36:39], a[228:231], v[92:95]
    v_mfma_f32_16x16x32_bf16 v[96:99], v[224:227], v[32:35], v[96:99]
    v_mfma_f32_16x16x32_bf16 v[100:103], v[224:227], v[36:39], v[100:103]
    v_mfma_f32_16x16x32_bf16 v[104:107], v[228:231], v[32:35], v[104:107]
    v_mfma_f32_16x16x32_bf16 v[108:111], v[228:231], v[36:39], v[108:111]
    ds_read_b128 v[32:35], v4 offset:960
    ds_read_b128 v[36:39], v4 offset:17600
    s_waitcnt lgkmcnt(4)
    v_mfma_f32_16x16x32_bf16 v[64:67], a[104:107], v[40:43], v[64:67]
    v_mfma_f32_16x16x32_bf16 v[68:71], a[104:107], v[44:47], v[68:71]
    v_mfma_f32_16x16x32_bf16 v[72:75], a[108:111], v[40:43], v[72:75]
    v_mfma_f32_16x16x32_bf16 v[76:79], a[108:111], v[44:47], v[76:79]
    v_mfma_f32_16x16x32_bf16 v[80:83], v[40:43], a[232:235], v[80:83]
    v_mfma_f32_16x16x32_bf16 v[84:87], v[44:47], a[232:235], v[84:87]
    v_mfma_f32_16x16x32_bf16 v[88:91], v[40:43], a[236:239], v[88:91]
    v_mfma_f32_16x16x32_bf16 v[92:95], v[44:47], a[236:239], v[92:95]
    v_mfma_f32_16x16x32_bf16 v[96:99], v[232:235], v[40:43], v[96:99]
    v_mfma_f32_16x16x32_bf16 v[100:103], v[232:235], v[44:47], v[100:103]
    v_mfma_f32_16x16x32_bf16 v[104:107], v[236:239], v[40:43], v[104:107]
    v_mfma_f32_16x16x32_bf16 v[108:111], v[236:239], v[44:47], v[108:111]
    s_waitcnt lgkmcnt(2)
    v_mfma_f32_16x16x32_bf16 v[64:67], a[112:115], v[48:51], v[64:67]
    v_mfma_f32_16x16x32_bf16 v[68:71], a[112:115], v[52:55], v[68:71]
    v_mfma_f32_16x16x32_bf16 v[72:75], a[116:119], v[48:51], v[72:75]
    v_mfma_f32_16x16x32_bf16 v[76:79], a[116:119], v[52:55], v[76:79]
    v_mfma_f32_16x16x32_bf16 v[80:83], v[48:51], a[240:243], v[80:83]
    v_mfma_f32_16x16x32_bf16 v[84:87], v[52:55], a[240:243], v[84:87]
    v_mfma_f32_16x16x32_bf16 v[88:91], v[48:51], a[244:247], v[88:91]
    v_mfma_f32_16x16x32_bf16 v[92:95], v[52:55], a[244:247], v[92:95]
    v_mfma_f32_16x16x32_bf16 v[96:99], v[240:243], v[48:51], v[96:99]
    v_mfma_f32_16x16x32_bf16 v[100:103], v[240:243], v[52:55], v[100:103]
    v_mfma_f32_16x16x32_bf16 v[104:107], v[244:247], v[48:51], v[104:107]
    v_mfma_f32_16x16x32_bf16 v[108:111], v[244:247], v[52:55], v[108:111]
    s_waitcnt lgkmcnt(0)
    v_mfma_f32_16x16x32_bf16 v[64:67], a[120:123], v[32:35], v[64:67]
    v_mfma_f32_16x16x32_bf16 v[68:71], a[120:123], v[36:39], v[68:71]
    v_mfma_f32_16x16x32_bf16 v[72:75], a[124:127], v[32:35], v[72:75]
    v_mfma_f32_16x16x32_bf16 v[76:79], a[124:127], v[36:39], v[76:79]
    v_mfma_f32_16x16x32_bf16 v[80:83], v[32:35], a[248:251], v[80:83]
    v_mfma_f32_16x16x32_bf16 v[84:87], v[36:39], a[248:251], v[84:87]
    v_mfma_f32_16x16x32_bf16 v[88:91], v[32:35], a[252:255], v[88:91]
    v_mfma_f32_16x16x32_bf16 v[92:95], v[36:39], a[252:255], v[92:95]
    v_mfma_f32_16x16x32_bf16 v[96:99], v[248:251], v[32:35], v[96:99]
    v_mfma_f32_16x16x32_bf16 v[100:103], v[248:251], v[36:39], v[100:103]
    v_mfma_f32_16x16x32_bf16 v[104:107], v[252:255], v[32:35], v[104:107]
    v_mfma_f32_16x16x32_bf16 v[108:111], v[252:255], v[36:39], v[108:111]
    s_lshl_b32 s52, s43, 5
    s_add_u32 s52, s52, s4
    s_add_u32 s48, s52, s43
    s_lshl_b32 s48, s48, 14
    s_add_u32 s48, s48, 16777216
    s_lshl_b32 s7, s3, 10
    s_add_u32 s49, s48, s7
    s_add_u32 s50, s49, 4096
    s_lshl_b32 s52, s52, 13
    s_add_u32 s52, s52, s7
    s_add_u32 s52, s52, 167772160
    s_add_u32 s53, s52, 4096
    s_lshl_b32 s7, s3, 11
    s_add_u32 s51, s48, s7
    s_add_u32 s51, s51, 8192
    v_cvt_pk_bf16_f32 v112, v64, v72
    v_cvt_pk_bf16_f32 v113, v65, v73
    v_cvt_pk_bf16_f32 v114, v66, v74
    v_cvt_pk_bf16_f32 v115, v67, v75
    buffer_store_dwordx4 v[112:115], v0, s[12:15], s49 offen sc1
    v_cvt_pk_bf16_f32 v116, v68, v76
    v_cvt_pk_bf16_f32 v117, v69, v77
    v_cvt_pk_bf16_f32 v118, v70, v78
    v_cvt_pk_bf16_f32 v119, v71, v79
    buffer_store_dwordx4 v[116:119], v0, s[12:15], s50 offen sc1
    v_cvt_pk_bf16_f32 v120, v80, v81
    v_cvt_pk_bf16_f32 v121, v82, v83
    v_cvt_pk_bf16_f32 v122, v84, v85
    v_cvt_pk_bf16_f32 v123, v86, v87
    buffer_store_dwordx4 v[120:123], v0, s[12:15], s51 offen offset:0 sc1
    v_cvt_pk_bf16_f32 v124, v88, v89
    v_cvt_pk_bf16_f32 v125, v90, v91
    v_cvt_pk_bf16_f32 v126, v92, v93
    v_cvt_pk_bf16_f32 v127, v94, v95
    buffer_store_dwordx4 v[124:127], v0, s[12:15], s51 offen offset:1024 sc1
    v_cvt_pk_bf16_f32 v56, v96, v104
    v_cvt_pk_bf16_f32 v57, v97, v105
    v_cvt_pk_bf16_f32 v58, v98, v106
    v_cvt_pk_bf16_f32 v59, v99, v107
    buffer_store_dwordx4 v[56:59], v0, s[12:15], s52 offen sc1
    v_cvt_pk_bf16_f32 v60, v100, v108
    v_cvt_pk_bf16_f32 v61, v101, v109
    v_cvt_pk_bf16_f32 v62, v102, v110
    v_cvt_pk_bf16_f32 v63, v103, v111
    buffer_store_dwordx4 v[60:63], v0, s[12:15], s53 offen sc1
    s_cmp_ge_u32 s6, 2
    s_cbranch_scc1 B_later
    s_add_u32 s6, s6, 1
    s_waitcnt vmcnt(0)
    s_barrier
    s_cmp_lg_u32 s3, 0
    s_cbranch_scc1 BF_36
    s_max_u32 s7, s6, 0
    v_mov_b32 v6, s6
    v_writelane_b32 v6, s7, 0
    s_mov_b64 exec, 3
    buffer_store_dword v6, v5, s[12:15], s47 offen sc1
    s_mov_b64 exec, -1
BF_36:
    s_sub_u32 s6, s6, 1
B_later:
    s_sub_u32 s46, 33280, s46
    s_add_u32 s6, s6, 1
    s_cmp_lt_u32 s6, 32
    s_cbranch_scc1 B_loop
    s_waitcnt vmcnt(0)
    s_barrier
    s_cmp_lg_u32 s3, 0
    s_cbranch_scc1 BF_37
    s_max_u32 s7, s6, 0
    v_mov_b32 v6, s6
    v_writelane_b32 v6, s7, 0
    s_mov_b64 exec, 3
    buffer_store_dword v6, v5, s[12:15], s47 offen sc1
    s_mov_b64 exec, -1
BF_37:
    s_waitcnt vmcnt(0)
    s_endpgm
L_C:
    s_sub_u32 s4, s4, 96
    s_lshr_b32 s5, s4, 4
    s_and_b32 s4, s4, 15
    s_mov_b32 s6, 0
    v_lshlrev_b32 v0, 4, v0
    s_lshl_b32 s47, s5, 2
    s_add_u32 s47, s47, s3
    s_lshl_b32 s47, s47, 11
    s_lshl_b32 s7, s4, 7
    s_add_u32 s47, s47, s7
    s_add_u32 s47, s47, 393216
    v_mov_b32 v24, 0
    s_mov_b64 exec, 1
    buffer_store_dword v24, off, s[12:15], s47 sc1
    s_mov_b64 exec, -1
    s_lshr_b32 s52, s3, 1
    s_and_b32 s53, s3, 1
    s_lshl_b32 s58, s4, 1
    s_add_u32 s58, s58, s52
    s_lshl_b32 s55, s5, 5
    s_add_u32 s55, s55, s58
    s_lshl_b32 s55, s55, 12
    s_lshl_b32 s7, s53, 11
    s_add_u32 s55, s55, s7
    s_add_u32 s55, s55, 3145728
    v_mov_b64 v[24:25], -1
    v_mov_b64 v[26:27], -1
    s_add_u32 s7, s55, 7864320
    buffer_store_dwordx4 v[24:27], v0, s[12:15], s7 offen sc1
    buffer_store_dwordx4 v[24:27], v0, s[12:15], s7 offen offset:1024 sc1
    s_lshl_b32 s50, s58, 9
    s_add_u32 s50, s50, 16384
    v_lshlrev_b32 v9, 3, v0
    s_waitcnt vmcnt(0)
    s_barrier
    s_cmp_lg_u32 s3, 0
    s_cbranch_scc1 IA_38
    v_mov_b32 v24, 1
    s_mov_b64 exec, 1
    buffer_atomic_add v24, off, s[16:19], 0 offset:64
    s_mov_b64 exec, -1
IA_38:
    s_mov_b32 s90, 224
    s_mov_b32 s96, 0
WS_39:
    buffer_load_dword v24, off, s[16:19], s90 sc1
    s_waitcnt vmcnt(0)
    v_readfirstlane_b32 s7, v24
    s_nop 3
    s_cmp_ge_u32 s7, 1
    s_cbranch_scc1 WSOK_40
    s_sleep 64
    s_add_u32 s96, s96, 1
    s_cmp_lt_u32 s96, 44984
    s_cbranch_scc1 WS_39
    s_branch L_bail
WSOK_40:
    s_lshl_b32 s48, s58, 7
    s_add_u32 s48, s48, 0
    s_mov_b32 s96, 0
WS_41:
    buffer_load_dword v24, off, s[12:15], s48 sc1
    s_waitcnt vmcnt(0)
    v_readfirstlane_b32 s7, v24
    s_nop 3
    s_cmp_ge_u32 s7, 1
    s_cbranch_scc1 WSOK_42
    s_sleep 16
    s_add_u32 s96, s96, 1
    s_cmp_lt_u32 s96, 145560
    s_cbranch_scc1 WS_41
    s_branch L_bail
WSOK_42:
    s_mov_b32 s28, s70
    s_mov_b32 s29, s71
    s_mov_b32 s30, 4194304
    s_mov_b32 s31, 0x20000
    s_lshl_b32 s48, s4, 18
    v_lshlrev_b32 v28, 13, v1
    v_lshl_add_u32 v28, v2, 4, v28
    s_lshl_b32 s7, s3, 8
    s_add_u32 s7, s7, s48
    v_add_u32 v28, s7, v28
    v_lshlrev_b32 v28, 13, v1
    v_lshl_add_u32 v28, v2, 4, v28
    s_lshl_b32 s7, s3, 8
    s_add_u32 s7, s7, s48
    v_add_u32 v28, s7, v28
    s_mov_b32 s7, 131072
    buffer_load_dwordx4 v[32:35], v28, s[28:31], s7 offen
    buffer_load_dwordx4 v[36:39], v28, s[28:31], s7 offen offset:1024
    s_mov_b32 s7, 133120
    buffer_load_dwordx4 v[40:43], v28, s[28:31], s7 offen
    buffer_load_dwordx4 v[44:47], v28, s[28:31], s7 offen offset:1024
    s_mov_b32 s7, 135168
    buffer_load_dwordx4 v[48:51], v28, s[28:31], s7 offen
    buffer_load_dwordx4 v[52:55], v28, s[28:31], s7 offen offset:1024
    s_mov_b32 s7, 137216
    buffer_load_dwordx4 v[56:59], v28, s[28:31], s7 offen
    buffer_load_dwordx4 v[60:63], v28, s[28:31], s7 offen offset:1024
    s_mov_b32 s7, 163840
    buffer_load_dwordx4 v[64:67], v28, s[28:31], s7 offen
    buffer_load_dwordx4 v[68:71], v28, s[28:31], s7 offen offset:1024
    s_mov_b32 s7, 165888
    buffer_load_dwordx4 v[72:75], v28, s[28:31], s7 offen
    buffer_load_dwordx4 v[76:79], v28, s[28:31], s7 offen offset:1024
    s_mov_b32 s7, 167936
    buffer_load_dwordx4 v[80:83], v28, s[28:31], s7 offen
    buffer_load_dwordx4 v[84:87], v28, s[28:31], s7 offen offset:1024
    s_mov_b32 s7, 169984
    buffer_load_dwordx4 v[88:91], v28, s[28:31], s7 offen
    buffer_load_dwordx4 v[92:95], v28, s[28:31], s7 offen offset:1024
    s_mov_b32 s7, 196608
    buffer_load_dwordx4 v[96:99], v28, s[28:31], s7 offen
    buffer_load_dwordx4 v[100:103], v28, s[28:31], s7 offen offset:1024
    s_mov_b32 s7, 198656
    buffer_load_dwordx4 v[104:107], v28, s[28:31], s7 offen
    buffer_load_dwordx4 v[108:111], v28, s[28:31], s7 offen offset:1024
    s_mov_b32 s7, 200704
    buffer_load_dwordx4 v[112:115], v28, s[28:31], s7 offen
    buffer_load_dwordx4 v[116:119], v28, s[28:31], s7 offen offset:1024
    s_mov_b32 s7, 202752
    buffer_load_dwordx4 v[120:123], v28, s[28:31], s7 offen
    buffer_load_dwordx4 v[124:127], v28, s[28:31], s7 offen offset:1024
    s_waitcnt vmcnt(22)
    v_perm_b32 v128, v36, v32, s40
    v_perm_b32 v144, v36, v32, s41
    v_perm_b32 v160, v37, v33, s40
    v_perm_b32 v176, v37, v33, s41
    v_perm_b32 v192, v38, v34, s40
    v_perm_b32 v208, v38, v34, s41
    v_perm_b32 v224, v39, v35, s40
    v_perm_b32 v240, v39, v35, s41
    s_mov_b32 s7, 229376
    buffer_load_dwordx4 v[32:35], v28, s[28:31], s7 offen
    buffer_load_dwordx4 v[36:39], v28, s[28:31], s7 offen offset:1024
    s_waitcnt vmcnt(22)
    v_perm_b32 v129, v44, v40, s40
    v_perm_b32 v145, v44, v40, s41
    v_perm_b32 v161, v45, v41, s40
    v_perm_b32 v177, v45, v41, s41
    v_perm_b32 v193, v46, v42, s40
    v_perm_b32 v209, v46, v42, s41
    v_perm_b32 v225, v47, v43, s40
    v_perm_b32 v241, v47, v43, s41
    s_mov_b32 s7, 231424
    buffer_load_dwordx4 v[40:43], v28, s[28:31], s7 offen
    buffer_load_dwordx4 v[44:47], v28, s[28:31], s7 offen offset:1024
    s_waitcnt vmcnt(22)
    v_perm_b32 v130, v52, v48, s40
    v_perm_b32 v146, v52, v48, s41
    v_perm_b32 v162, v53, v49, s40
    v_perm_b32 v178, v53, v49, s41
    v_perm_b32 v194, v54, v50, s40
    v_perm_b32 v210, v54, v50, s41
    v_perm_b32 v226, v55, v51, s40
    v_perm_b32 v242, v55, v51, s41
    s_mov_b32 s7, 233472
    buffer_load_dwordx4 v[48:51], v28, s[28:31], s7 offen
    buffer_load_dwordx4 v[52:55], v28, s[28:31], s7 offen offset:1024
    s_waitcnt vmcnt(22)
    v_perm_b32 v131, v60, v56, s40
    v_perm_b32 v147, v60, v56, s41
    v_perm_b32 v163, v61, v57, s40
    v_perm_b32 v179, v61, v57, s41
    v_perm_b32 v195, v62, v58, s40
    v_perm_b32 v211, v62, v58, s41
    v_perm_b32 v227, v63, v59, s40
    v_perm_b32 v243, v63, v59, s41
    s_mov_b32 s7, 235520
    buffer_load_dwordx4 v[56:59], v28, s[28:31], s7 offen
    buffer_load_dwordx4 v[60:63], v28, s[28:31], s7 offen offset:1024
    s_waitcnt vmcnt(22)
    v_perm_b32 v132, v68, v64, s40
    v_perm_b32 v148, v68, v64, s41
    v_perm_b32 v164, v69, v65, s40
    v_perm_b32 v180, v69, v65, s41
    v_perm_b32 v196, v70, v66, s40
    v_perm_b32 v212, v70, v66, s41
    v_perm_b32 v228, v71, v67, s40
    v_perm_b32 v244, v71, v67, s41
    s_mov_b32 s7, 0
    buffer_load_dwordx4 v[64:67], v28, s[28:31], s7 offen
    buffer_load_dwordx4 v[68:71], v28, s[28:31], s7 offen offset:1024
    s_waitcnt vmcnt(22)
    v_perm_b32 v133, v76, v72, s40
    v_perm_b32 v149, v76, v72, s41
    v_perm_b32 v165, v77, v73, s40
    v_perm_b32 v181, v77, v73, s41
    v_perm_b32 v197, v78, v74, s40
    v_perm_b32 v213, v78, v74, s41
    v_perm_b32 v229, v79, v75, s40
    v_perm_b32 v245, v79, v75, s41
    s_mov_b32 s7, 2048
    buffer_load_dwordx4 v[72:75], v28, s[28:31], s7 offen
    buffer_load_dwordx4 v[76:79], v28, s[28:31], s7 offen offset:1024
    s_waitcnt vmcnt(22)
    v_perm_b32 v134, v84, v80, s40
    v_perm_b32 v150, v84, v80, s41
    v_perm_b32 v166, v85, v81, s40
    v_perm_b32 v182, v85, v81, s41
    v_perm_b32 v198, v86, v82, s40
    v_perm_b32 v214, v86, v82, s41
    v_perm_b32 v230, v87, v83, s40
    v_perm_b32 v246, v87, v83, s41
    s_mov_b32 s7, 4096
    buffer_load_dwordx4 v[80:83], v28, s[28:31], s7 offen
    buffer_load_dwordx4 v[84:87], v28, s[28:31], s7 offen offset:1024
    s_waitcnt vmcnt(22)
    v_perm_b32 v135, v92, v88, s40
    v_perm_b32 v151, v92, v88, s41
    v_perm_b32 v167, v93, v89, s40
    v_perm_b32 v183, v93, v89, s41
    v_perm_b32 v199, v94, v90, s40
    v_perm_b32 v215, v94, v90, s41
    v_perm_b32 v231, v95, v91, s40
    v_perm_b32 v247, v95, v91, s41
    s_mov_b32 s7, 6144
    buffer_load_dwordx4 v[88:91], v28, s[28:31], s7 offen
    buffer_load_dwordx4 v[92:95], v28, s[28:31], s7 offen offset:1024
    s_waitcnt vmcnt(22)
    v_perm_b32 v136, v100, v96, s40
    v_perm_b32 v152, v100, v96, s41
    v_perm_b32 v168, v101, v97, s40
    v_perm_b32 v184, v101, v97, s41
    v_perm_b32 v200, v102, v98, s40
    v_perm_b32 v216, v102, v98, s41
    v_perm_b32 v232, v103, v99, s40
    v_perm_b32 v248, v103, v99, s41
    s_mov_b32 s7, 32768
    buffer_load_dwordx4 v[96:99], v28, s[28:31], s7 offen
    buffer_load_dwordx4 v[100:103], v28, s[28:31], s7 offen offset:1024
    s_waitcnt vmcnt(22)
    v_perm_b32 v137, v108, v104, s40
    v_perm_b32 v153, v108, v104, s41
    v_perm_b32 v169, v109, v105, s40
    v_perm_b32 v185, v109, v105, s41
    v_perm_b32 v201, v110, v106, s40
    v_perm_b32 v217, v110, v106, s41
    v_perm_b32 v233, v111, v107, s40
    v_perm_b32 v249, v111, v107, s41
    s_mov_b32 s7, 34816
    buffer_load_dwordx4 v[104:107], v28, s[28:31], s7 offen
    buffer_load_dwordx4 v[108:111], v28, s[28:31], s7 offen offset:1024
    s_waitcnt vmcnt(22)
    v_perm_b32 v138, v116, v112, s40
    v_perm_b32 v154, v116, v112, s41
    v_perm_b32 v170, v117, v113, s40
    v_perm_b32 v186, v117, v113, s41
    v_perm_b32 v202, v118, v114, s40
    v_perm_b32 v218, v118, v114, s41
    v_perm_b32 v234, v119, v115, s40
    v_perm_b32 v250, v119, v115, s41
    s_mov_b32 s7, 36864
    buffer_load_dwordx4 v[112:115], v28, s[28:31], s7 offen
    buffer_load_dwordx4 v[116:119], v28, s[28:31], s7 offen offset:1024
    s_waitcnt vmcnt(22)
    v_perm_b32 v139, v124, v120, s40
    v_perm_b32 v155, v124, v120, s41
    v_perm_b32 v171, v125, v121, s40
    v_perm_b32 v187, v125, v121, s41
    v_perm_b32 v203, v126, v122, s40
    v_perm_b32 v219, v126, v122, s41
    v_perm_b32 v235, v127, v123, s40
    v_perm_b32 v251, v127, v123, s41
    s_mov_b32 s7, 38912
    buffer_load_dwordx4 v[120:123], v28, s[28:31], s7 offen
    buffer_load_dwordx4 v[124:127], v28, s[28:31], s7 offen offset:1024
    s_waitcnt vmcnt(22)
    v_perm_b32 v140, v36, v32, s40
    v_perm_b32 v156, v36, v32, s41
    v_perm_b32 v172, v37, v33, s40
    v_perm_b32 v188, v37, v33, s41
    v_perm_b32 v204, v38, v34, s40
    v_perm_b32 v220, v38, v34, s41
    v_perm_b32 v236, v39, v35, s40
    v_perm_b32 v252, v39, v35, s41
    s_mov_b32 s7, 65536
    buffer_load_dwordx4 v[32:35], v28, s[28:31], s7 offen
    buffer_load_dwordx4 v[36:39], v28, s[28:31], s7 offen offset:1024
    s_waitcnt vmcnt(22)
    v_perm_b32 v141, v44, v40, s40
    v_perm_b32 v157, v44, v40, s41
    v_perm_b32 v173, v45, v41, s40
    v_perm_b32 v189, v45, v41, s41
    v_perm_b32 v205, v46, v42, s40
    v_perm_b32 v221, v46, v42, s41
    v_perm_b32 v237, v47, v43, s40
    v_perm_b32 v253, v47, v43, s41
    s_mov_b32 s7, 67584
    buffer_load_dwordx4 v[40:43], v28, s[28:31], s7 offen
    buffer_load_dwordx4 v[44:47], v28, s[28:31], s7 offen offset:1024
    s_waitcnt vmcnt(22)
    v_perm_b32 v142, v52, v48, s40
    v_perm_b32 v158, v52, v48, s41
    v_perm_b32 v174, v53, v49, s40
    v_perm_b32 v190, v53, v49, s41
    v_perm_b32 v206, v54, v50, s40
    v_perm_b32 v222, v54, v50, s41
    v_perm_b32 v238, v55, v51, s40
    v_perm_b32 v254, v55, v51, s41
    s_mov_b32 s7, 69632
    buffer_load_dwordx4 v[48:51], v28, s[28:31], s7 offen
    buffer_load_dwordx4 v[52:55], v28, s[28:31], s7 offen offset:1024
    s_waitcnt vmcnt(22)
    v_perm_b32 v143, v60, v56, s40
    v_perm_b32 v159, v60, v56, s41
    v_perm_b32 v175, v61, v57, s40
    v_perm_b32 v191, v61, v57, s41
    v_perm_b32 v207, v62, v58, s40
    v_perm_b32 v223, v62, v58, s41
    v_perm_b32 v239, v63, v59, s40
    v_perm_b32 v255, v63, v59, s41
    s_mov_b32 s7, 71680
    buffer_load_dwordx4 v[56:59], v28, s[28:31], s7 offen
    buffer_load_dwordx4 v[60:63], v28, s[28:31], s7 offen offset:1024
    v_accvgpr_write_b32 a128, v128
    v_accvgpr_write_b32 a129, v129
    v_accvgpr_write_b32 a130, v130
    v_accvgpr_write_b32 a131, v131
    v_accvgpr_write_b32 a132, v132
    v_accvgpr_write_b32 a133, v133
    v_accvgpr_write_b32 a134, v134
    v_accvgpr_write_b32 a135, v135
    v_accvgpr_write_b32 a136, v136
    v_accvgpr_write_b32 a137, v137
    v_accvgpr_write_b32 a138, v138
    v_accvgpr_write_b32 a139, v139
    v_accvgpr_write_b32 a140, v140
    v_accvgpr_write_b32 a141, v141
    v_accvgpr_write_b32 a142, v142
    v_accvgpr_write_b32 a143, v143
    v_accvgpr_write_b32 a144, v144
    v_accvgpr_write_b32 a145, v145
    v_accvgpr_write_b32 a146, v146
    v_accvgpr_write_b32 a147, v147
    v_accvgpr_write_b32 a148, v148
    v_accvgpr_write_b32 a149, v149
    v_accvgpr_write_b32 a150, v150
    v_accvgpr_write_b32 a151, v151
    v_accvgpr_write_b32 a152, v152
    v_accvgpr_write_b32 a153, v153
    v_accvgpr_write_b32 a154, v154
    v_accvgpr_write_b32 a155, v155
    v_accvgpr_write_b32 a156, v156
    v_accvgpr_write_b32 a157, v157
    v_accvgpr_write_b32 a158, v158
    v_accvgpr_write_b32 a159, v159
    v_accvgpr_write_b32 a160, v160
    v_accvgpr_write_b32 a161, v161
    v_accvgpr_write_b32 a162, v162
    v_accvgpr_write_b32 a163, v163
    v_accvgpr_write_b32 a164, v164
    v_accvgpr_write_b32 a165, v165
    v_accvgpr_write_b32 a166, v166
    v_accvgpr_write_b32 a167, v167
    v_accvgpr_write_b32 a168, v168
    v_accvgpr_write_b32 a169, v169
    v_accvgpr_write_b32 a170, v170
    v_accvgpr_write_b32 a171, v171
    v_accvgpr_write_b32 a172, v172
    v_accvgpr_write_b32 a173, v173
    v_accvgpr_write_b32 a174, v174
    v_accvgpr_write_b32 a175, v175
    v_accvgpr_write_b32 a176, v176
    v_accvgpr_write_b32 a177, v177
    v_accvgpr_write_b32 a178, v178
    v_accvgpr_write_b32 a179, v179
    v_accvgpr_write_b32 a180, v180
    v_accvgpr_write_b32 a181, v181
    v_accvgpr_write_b32 a182, v182
    v_accvgpr_write_b32 a183, v183
    v_accvgpr_write_b32 a184, v184
    v_accvgpr_write_b32 a185, v185
    v_accvgpr_write_b32 a186, v186
    v_accvgpr_write_b32 a187, v187
    v_accvgpr_write_b32 a188, v188
    v_accvgpr_write_b32 a189, v189
    v_accvgpr_write_b32 a190, v190
    v_accvgpr_write_b32 a191, v191
    v_accvgpr_write_b32 a192, v192
    v_accvgpr_write_b32 a193, v193
    v_accvgpr_write_b32 a194, v194
    v_accvgpr_write_b32 a195, v195
    v_accvgpr_write_b32 a196, v196
    v_accvgpr_write_b32 a197, v197
    v_accvgpr_write_b32 a198, v198
    v_accvgpr_write_b32 a199, v199
    v_accvgpr_write_b32 a200, v200
    v_accvgpr_write_b32 a201, v201
    v_accvgpr_write_b32 a202, v202
    v_accvgpr_write_b32 a203, v203
    v_accvgpr_write_b32 a204, v204
    v_accvgpr_write_b32 a205, v205
    v_accvgpr_write_b32 a206, v206
    v_accvgpr_write_b32 a207, v207
    v_accvgpr_write_b32 a208, v208
    v_accvgpr_write_b32 a209, v209
    v_accvgpr_write_b32 a210, v210
    v_accvgpr_write_b32 a211, v211
    v_accvgpr_write_b32 a212, v212
    v_accvgpr_write_b32 a213, v213
    v_accvgpr_write_b32 a214, v214
    v_accvgpr_write_b32 a215, v215
    v_accvgpr_write_b32 a216, v216
    v_accvgpr_write_b32 a217, v217
    v_accvgpr_write_b32 a218, v218
    v_accvgpr_write_b32 a219, v219
    v_accvgpr_write_b32 a220, v220
    v_accvgpr_write_b32 a221, v221
    v_accvgpr_write_b32 a222, v222
    v_accvgpr_write_b32 a223, v223
    v_accvgpr_write_b32 a224, v224
    v_accvgpr_write_b32 a225, v225
    v_accvgpr_write_b32 a226, v226
    v_accvgpr_write_b32 a227, v227
    v_accvgpr_write_b32 a228, v228
    v_accvgpr_write_b32 a229, v229
    v_accvgpr_write_b32 a230, v230
    v_accvgpr_write_b32 a231, v231
    v_accvgpr_write_b32 a232, v232
    v_accvgpr_write_b32 a233, v233
    v_accvgpr_write_b32 a234, v234
    v_accvgpr_write_b32 a235, v235
    v_accvgpr_write_b32 a236, v236
    v_accvgpr_write_b32 a237, v237
    v_accvgpr_write_b32 a238, v238
    v_accvgpr_write_b32 a239, v239
    v_accvgpr_write_b32 a240, v240
    v_accvgpr_write_b32 a241, v241
    v_accvgpr_write_b32 a242, v242
    v_accvgpr_write_b32 a243, v243
    v_accvgpr_write_b32 a244, v244
    v_accvgpr_write_b32 a245, v245
    v_accvgpr_write_b32 a246, v246
    v_accvgpr_write_b32 a247, v247
    v_accvgpr_write_b32 a248, v248
    v_accvgpr_write_b32 a249, v249
    v_accvgpr_write_b32 a250, v250
    v_accvgpr_write_b32 a251, v251
    v_accvgpr_write_b32 a252, v252
    v_accvgpr_write_b32 a253, v253
    v_accvgpr_write_b32 a254, v254
    v_accvgpr_write_b32 a255, v255
    s_waitcnt vmcnt(22)
    v_perm_b32 v128, v68, v64, s40
    v_perm_b32 v144, v68, v64, s41
    v_perm_b32 v160, v69, v65, s40
    v_perm_b32 v176, v69, v65, s41
    v_perm_b32 v192, v70, v66, s40
    v_perm_b32 v208, v70, v66, s41
    v_perm_b32 v224, v71, v67, s40
    v_perm_b32 v240, v71, v67, s41
    s_mov_b32 s7, 98304
    buffer_load_dwordx4 v[64:67], v28, s[28:31], s7 offen
    buffer_load_dwordx4 v[68:71], v28, s[28:31], s7 offen offset:1024
    s_waitcnt vmcnt(22)
    v_perm_b32 v129, v76, v72, s40
    v_perm_b32 v145, v76, v72, s41
    v_perm_b32 v161, v77, v73, s40
    v_perm_b32 v177, v77, v73, s41
    v_perm_b32 v193, v78, v74, s40
    v_perm_b32 v209, v78, v74, s41
    v_perm_b32 v225, v79, v75, s40
    v_perm_b32 v241, v79, v75, s41
    s_mov_b32 s7, 100352
    buffer_load_dwordx4 v[72:75], v28, s[28:31], s7 offen
    buffer_load_dwordx4 v[76:79], v28, s[28:31], s7 offen offset:1024
    s_waitcnt vmcnt(22)
    v_perm_b32 v130, v84, v80, s40
    v_perm_b32 v146, v84, v80, s41
    v_perm_b32 v162, v85, v81, s40
    v_perm_b32 v178, v85, v81, s41
    v_perm_b32 v194, v86, v82, s40
    v_perm_b32 v210, v86, v82, s41
    v_perm_b32 v226, v87, v83, s40
    v_perm_b32 v242, v87, v83, s41
    s_mov_b32 s7, 102400
    buffer_load_dwordx4 v[80:83], v28, s[28:31], s7 offen
    buffer_load_dwordx4 v[84:87], v28, s[28:31], s7 offen offset:1024
    s_waitcnt vmcnt(22)
    v_perm_b32 v131, v92, v88, s40
    v_perm_b32 v147, v92, v88, s41
    v_perm_b32 v163, v93, v89, s40
    v_perm_b32 v179, v93, v89, s41
    v_perm_b32 v195, v94, v90, s40
    v_perm_b32 v211, v94, v90, s41
    v_perm_b32 v227, v95, v91, s40
    v_perm_b32 v243, v95, v91, s41
    s_mov_b32 s7, 104448
    buffer_load_dwordx4 v[88:91], v28, s[28:31], s7 offen
    buffer_load_dwordx4 v[92:95], v28, s[28:31], s7 offen offset:1024
    s_waitcnt vmcnt(22)
    v_perm_b32 v132, v100, v96, s40
    v_perm_b32 v148, v100, v96, s41
    v_perm_b32 v164, v101, v97, s40
    v_perm_b32 v180, v101, v97, s41
    v_perm_b32 v196, v102, v98, s40
    v_perm_b32 v212, v102, v98, s41
    v_perm_b32 v228, v103, v99, s40
    v_perm_b32 v244, v103, v99, s41
    s_waitcnt vmcnt(20)
    v_perm_b32 v133, v108, v104, s40
    v_perm_b32 v149, v108, v104, s41
    v_perm_b32 v165, v109, v105, s40
    v_perm_b32 v181, v109, v105, s41
    v_perm_b32 v197, v110, v106, s40
    v_perm_b32 v213, v110, v106, s41
    v_perm_b32 v229, v111, v107, s40
    v_perm_b32 v245, v111, v107, s41
    s_waitcnt vmcnt(18)
    v_perm_b32 v134, v116, v112, s40
    v_perm_b32 v150, v116, v112, s41
    v_perm_b32 v166, v117, v113, s40
    v_perm_b32 v182, v117, v113, s41
    v_perm_b32 v198, v118, v114, s40
    v_perm_b32 v214, v118, v114, s41
    v_perm_b32 v230, v119, v115, s40
    v_perm_b32 v246, v119, v115, s41
    s_waitcnt vmcnt(16)
    v_perm_b32 v135, v124, v120, s40
    v_perm_b32 v151, v124, v120, s41
    v_perm_b32 v167, v125, v121, s40
    v_perm_b32 v183, v125, v121, s41
    v_perm_b32 v199, v126, v122, s40
    v_perm_b32 v215, v126, v122, s41
    v_perm_b32 v231, v127, v123, s40
    v_perm_b32 v247, v127, v123, s41
    s_waitcnt vmcnt(14)
    v_perm_b32 v136, v36, v32, s40
    v_perm_b32 v152, v36, v32, s41
    v_perm_b32 v168, v37, v33, s40
    v_perm_b32 v184, v37, v33, s41
    v_perm_b32 v200, v38, v34, s40
    v_perm_b32 v216, v38, v34, s41
    v_perm_b32 v232, v39, v35, s40
    v_perm_b32 v248, v39, v35, s41
    s_waitcnt vmcnt(12)
    v_perm_b32 v137, v44, v40, s40
    v_perm_b32 v153, v44, v40, s41
    v_perm_b32 v169, v45, v41, s40
    v_perm_b32 v185, v45, v41, s41
    v_perm_b32 v201, v46, v42, s40
    v_perm_b32 v217, v46, v42, s41
    v_perm_b32 v233, v47, v43, s40
    v_perm_b32 v249, v47, v43, s41
    s_waitcnt vmcnt(10)
    v_perm_b32 v138, v52, v48, s40
    v_perm_b32 v154, v52, v48, s41
    v_perm_b32 v170, v53, v49, s40
    v_perm_b32 v186, v53, v49, s41
    v_perm_b32 v202, v54, v50, s40
    v_perm_b32 v218, v54, v50, s41
    v_perm_b32 v234, v55, v51, s40
    v_perm_b32 v250, v55, v51, s41
    s_waitcnt vmcnt(8)
    v_perm_b32 v139, v60, v56, s40
    v_perm_b32 v155, v60, v56, s41
    v_perm_b32 v171, v61, v57, s40
    v_perm_b32 v187, v61, v57, s41
    v_perm_b32 v203, v62, v58, s40
    v_perm_b32 v219, v62, v58, s41
    v_perm_b32 v235, v63, v59, s40
    v_perm_b32 v251, v63, v59, s41
    s_waitcnt vmcnt(6)
    v_perm_b32 v140, v68, v64, s40
    v_perm_b32 v156, v68, v64, s41
    v_perm_b32 v172, v69, v65, s40
    v_perm_b32 v188, v69, v65, s41
    v_perm_b32 v204, v70, v66, s40
    v_perm_b32 v220, v70, v66, s41
    v_perm_b32 v236, v71, v67, s40
    v_perm_b32 v252, v71, v67, s41
    s_waitcnt vmcnt(4)
    v_perm_b32 v141, v76, v72, s40
    v_perm_b32 v157, v76, v72, s41
    v_perm_b32 v173, v77, v73, s40
    v_perm_b32 v189, v77, v73, s41
    v_perm_b32 v205, v78, v74, s40
    v_perm_b32 v221, v78, v74, s41
    v_perm_b32 v237, v79, v75, s40
    v_perm_b32 v253, v79, v75, s41
    s_waitcnt vmcnt(2)
    v_perm_b32 v142, v84, v80, s40
    v_perm_b32 v158, v84, v80, s41
    v_perm_b32 v174, v85, v81, s40
    v_perm_b32 v190, v85, v81, s41
    v_perm_b32 v206, v86, v82, s40
    v_perm_b32 v222, v86, v82, s41
    v_perm_b32 v238, v87, v83, s40
    v_perm_b32 v254, v87, v83, s41
    s_waitcnt vmcnt(0)
    v_perm_b32 v143, v92, v88, s40
    v_perm_b32 v159, v92, v88, s41
    v_perm_b32 v175, v93, v89, s40
    v_perm_b32 v191, v93, v89, s41
    v_perm_b32 v207, v94, v90, s40
    v_perm_b32 v223, v94, v90, s41
    v_perm_b32 v239, v95, v91, s40
    v_perm_b32 v255, v95, v91, s41
    v_add_u32 v6, 66560, v0
    v_lshlrev_b32 v7, 12, v1
    v_lshl_add_u32 v7, v2, 4, v7
    s_lshl_b32 s7, s3, 8
    v_add_u32 v7, s7, v7
    v_add_u32 v6, 49152, v0
    s_mul_i32 s59, s52, 24576
    v_add_u32 v3, s59, v0
    s_lshl_b32 s7, s53, 12
    s_add_u32 s7, s7, 16384
    v_add_u32 v4, s7, v3
    s_lshl_b32 s7, s3, 11
    s_add_u32 s7, s7, 65536
    v_add_u32 v8, s7, v0
    s_lshl_b32 s7, s52, 12
    s_add_u32 s90, s7, 67584
    v_add_u32 v11, s90, v0
    v_lshrrev_b32 v24, 2, v2
    v_and_b32 v25, 1, v2
    v_lshl_add_u32 v10, v24, 1, v25
    v_lshlrev_b32 v10, 4, v10
    v_lshl_add_u32 v10, v1, 7, v10
    s_add_u32 s90, s7, 65536
    v_add_u32 v10, s90, v10
    s_lshl_b32 s90, s53, 13
    s_add_u32 s90, s90, s7
    v_add_u32 v12, s90, v6
    s_lshl_b32 s7, s53, 4
    v_add_u32 v14, s7, v2
    v_lshlrev_b32 v15, 2, v1
    v_sub_u32 v14, v14, v15
    v_cmp_le_i32 s[60:61], 0, v14
    v_cmp_le_i32 s[62:63], 1, v14
    v_cmp_le_i32 s[64:65], 2, v14
    v_cmp_le_i32 s[66:67], 3, v14
    v_cmp_le_i32 s[68:69], 16, v14
    v_cmp_le_i32 s[70:71], 17, v14
    v_cmp_le_i32 s[72:73], 18, v14
    v_cmp_le_i32 s[74:75], 19, v14
    v_mov_b32 v14, 0xf149f2ca
    v_mov_b32 v16, 0x3f803f80
    v_mov_b32 v17, 0x3f803f80
    v_mov_b32 v18, 0x3f803f80
    v_mov_b32 v19, 0x3f803f80
    v_mov_b32 v21, 0
    v_mov_b32 v22, 0
    s_lshl_b32 s54, s58, 7
    s_and_b32 s7, s5, 1
    s_lshl_b32 s7, s7, 2
    s_add_u32 s54, s54, s7
    s_add_u32 s54, s54, 8
    s_mov_b32 s56, 0
    s_mov_b32 s90, 224
    s_mov_b32 s96, 0
WS_43:
    buffer_load_dword v24, off, s[16:19], s90 sc1
    s_waitcnt vmcnt(0)
    v_readfirstlane_b32 s7, v24
    s_nop 3
    s_cmp_ge_u32 s7, 1
    s_cbranch_scc1 WSOK_44
    s_sleep 64
    s_add_u32 s96, s96, 1
    s_cmp_lt_u32 s96, 44984
    s_cbranch_scc1 WS_43
    s_branch L_bail
WSOK_44:
    s_lshl_b32 s49, s6, 2
    s_add_u32 s49, s49, s5
    s_lshr_b32 s57, s49, 1
    s_cmp_gt_u32 s56, s57
    s_cbranch_scc1 CB_45
    s_add_u32 s57, s57, 1
    s_mov_b32 s96, 0
WS_46:
    buffer_load_dword v13, off, s[12:15], s54 sc1
    s_waitcnt vmcnt(0)
    v_readfirstlane_b32 s56, v13
    s_nop 3
    s_cmp_ge_u32 s56, s57
    s_cbranch_scc1 WSOK_47
    s_sleep 4
    s_add_u32 s96, s96, 1
    s_cmp_lt_u32 s96, 330033
    s_cbranch_scc1 WS_46
    s_branch L_bail
WSOK_47:
CB_45:
    s_lshl_b32 s49, s49, 5
    s_add_u32 s49, s49, s58
    s_lshl_b32 s57, s49, 13
    s_lshl_b32 s7, s53, 12
    s_add_u32 s57, s57, s7
    s_add_u32 s57, s57, 167772160
    s_add_u32 s7, s7, s59
    s_add_u32 m0, s7, 16384
    s_lshr_b32 s7, s49, 5
    s_add_u32 s49, s49, s7
    s_lshl_b32 s49, s49, 14
    s_add_u32 s49, s49, 16777216
    s_lshl_b32 s7, s53, 13
    s_add_u32 s49, s49, s7
    s_add_u32 s7, s7, s59
    buffer_load_dwordx4 v0, s[12:15], s57 offen offset:0 sc1 lds
    buffer_load_dwordx4 v0, s[12:15], s57 offen offset:1024 sc1 lds
    buffer_load_dwordx4 v0, s[12:15], s57 offen offset:2048 sc1 lds
    buffer_load_dwordx4 v0, s[12:15], s57 offen offset:3072 sc1 lds
    s_add_u32 m0, s7, 0
    s_nop 0
    buffer_load_dwordx4 v0, s[12:15], s49 offen offset:0 sc1 lds
    buffer_load_dwordx4 v0, s[12:15], s49 offen offset:1024 sc1 lds
    buffer_load_dwordx4 v0, s[12:15], s49 offen offset:2048 sc1 lds
    buffer_load_dwordx4 v0, s[12:15], s49 offen offset:3072 sc1 lds
    s_add_u32 m0, s7, 4096
    s_add_u32 s49, s49, 4096
    buffer_load_dwordx4 v0, s[12:15], s49 offen offset:0 sc1 lds
    buffer_load_dwordx4 v0, s[12:15], s49 offen offset:1024 sc1 lds
    buffer_load_dwordx4 v0, s[12:15], s49 offen offset:2048 sc1 lds
    buffer_load_dwordx4 v0, s[12:15], s49 offen offset:3072 sc1 lds
    s_waitcnt vmcnt(0)
C_loop:
    s_barrier
    ds_read_b128 a[0:3], v4 offset:0
    ds_read_b128 a[4:7], v4 offset:1024
    ds_read_b128 a[8:11], v4 offset:2048
    ds_read_b128 a[12:15], v4 offset:3072
    ds_read_b128 a[16:19], v3 offset:0
    ds_read_b128 a[20:23], v3 offset:1024
    ds_read_b128 a[24:27], v3 offset:2048
    ds_read_b128 a[28:31], v3 offset:3072
    ds_read_b128 a[32:35], v3 offset:4096
    ds_read_b128 a[36:39], v3 offset:5120
    ds_read_b128 a[40:43], v3 offset:6144
    ds_read_b128 a[44:47], v3 offset:7168
    ds_read_b128 a[48:51], v3 offset:8192
    ds_read_b128 a[52:55], v3 offset:9216
    ds_read_b128 a[56:59], v3 offset:10240
    ds_read_b128 a[60:63], v3 offset:11264
    ds_read_b128 a[64:67], v3 offset:12288
    ds_read_b128 a[68:71], v3 offset:13312
    ds_read_b128 a[72:75], v3 offset:14336
    ds_read_b128 a[76:79], v3 offset:15360
    s_waitcnt lgkmcnt(0)
    v_mfma_f32_16x16x32_bf16 v[116:119], a[16:19], a[0:3], 0
    v_mfma_f32_16x16x32_bf16 v[116:119], a[20:23], a[4:7], v[116:119]
    v_mfma_f32_16x16x32_bf16 v[116:119], a[24:27], a[8:11], v[116:119]
    v_mfma_f32_16x16x32_bf16 v[116:119], a[28:31], a[12:15], v[116:119]
    v_mfma_f32_16x16x32_bf16 v[120:123], a[32:35], a[0:3], 0
    v_mfma_f32_16x16x32_bf16 v[120:123], a[36:39], a[4:7], v[120:123]
    v_mfma_f32_16x16x32_bf16 v[120:123], a[40:43], a[8:11], v[120:123]
    v_mfma_f32_16x16x32_bf16 v[120:123], a[44:47], a[12:15], v[120:123]
    v_cndmask_b32 v116, v14, v116, s[60:61]
    v_cndmask_b32 v117, v14, v117, s[62:63]
    v_cndmask_b32 v118, v14, v118, s[64:65]
    v_cndmask_b32 v119, v14, v119, s[66:67]
    s_nop 3
    v_cndmask_b32 v120, v14, v120, s[68:69]
    v_cndmask_b32 v121, v14, v121, s[70:71]
    v_cndmask_b32 v122, v14, v122, s[72:73]
    v_cndmask_b32 v123, v14, v123, s[74:75]
    s_cmp_eq_u32 s6, 15
    s_cbranch_scc1 C_direct
    s_lshl_b32 s57, s6, 2
    s_add_u32 s57, s57, s5
    s_add_u32 s57, s57, 1
    s_mov_b32 s96, 0
    s_mov_b32 exec_lo, 0x3
    s_mov_b32 exec_hi, 0
WL_48:
    buffer_load_dword v24, v9, s[12:15], s50 offen sc1
    s_waitcnt vmcnt(0)
    v_cmp_gt_u32 vcc, s57, v24
    s_cbranch_vccz WLOK_49
    s_sleep 4
    s_add_u32 s96, s96, 1
    s_cmp_lt_u32 s96, 330033
    s_cbranch_scc1 WL_48
    s_branch L_bail
WLOK_49:
    s_mov_b64 exec, -1
C_direct:
    s_mov_b32 s96, 0
C_poll:
    buffer_load_dwordx4 v[24:27], v0, s[12:15], s55 offen sc1
    buffer_load_dwordx4 v[28:31], v0, s[12:15], s55 offen offset:1024 sc1
    s_waitcnt vmcnt(0)
    v_max3_u32 v32, v24, v25, v26
    v_max3_u32 v33, v27, v28, v29
    v_max3_u32 v32, v32, v30, v31
    v_max_u32 v32, v32, v33
    v_cmp_eq_u32 vcc, -1, v32
    s_cbranch_vccz C_have
    s_sleep 1
    s_add_u32 s96, s96, 1
    s_cmp_lt_u32 s96, 483091
    s_cbranch_scc1 C_poll
    s_branch L_bail
C_have:
    ds_write_b128 v8, v[24:27]
    ds_write_b128 v8, v[28:31] offset:1024
    s_add_u32 s55, s55, 0x80000
    s_waitcnt lgkmcnt(0)
    s_barrier
    ds_read_b128 v[88:91], v10 offset:0
    ds_read_b128 v[92:95], v10 offset:512
    ds_read_b128 v[96:99], v10 offset:1024
    ds_read_b128 v[100:103], v10 offset:1536
    ds_read_b128 v[104:107], v11 offset:0
    ds_read_b128 v[108:111], v11 offset:1024
    s_waitcnt lgkmcnt(5)
    v_mfma_f32_16x16x32_bf16 v[124:127], v[88:91], a[0:3], 0
    s_waitcnt lgkmcnt(4)
    v_mfma_f32_16x16x32_bf16 v[124:127], v[92:95], a[4:7], v[124:127]
    s_waitcnt lgkmcnt(3)
    v_mfma_f32_16x16x32_bf16 v[124:127], v[96:99], a[8:11], v[124:127]
    s_waitcnt lgkmcnt(2)
    v_mfma_f32_16x16x32_bf16 v[124:127], v[100:103], a[12:15], v[124:127]
    v_max3_f32 v28, v116, v117, v118
    v_max3_f32 v29, v119, v120, v121
    v_max3_f32 v28, v28, v122, v123
    s_nop 4
    v_max3_f32 v29, v29, v124, v125
    v_max_f32 v28, v28, v29
    v_max_f32 v29, v28, v29
    s_nop 1
    v_permlane16_swap_b32 v28, v29
    v_max_f32 v30, v28, v29
    v_max_f32 v31, v28, v29
    s_nop 1
    v_permlane32_swap_b32 v30, v31
    v_max_f32 v28, v30, v31
    v_mul_f32 v28, s42, v28
    v_fma_f32 v116, v116, s42, -v28
    v_fma_f32 v117, v117, s42, -v28
    v_fma_f32 v118, v118, s42, -v28
    v_fma_f32 v119, v119, s42, -v28
    v_fma_f32 v120, v120, s42, -v28
    v_fma_f32 v121, v121, s42, -v28
    v_fma_f32 v122, v122, s42, -v28
    v_fma_f32 v123, v123, s42, -v28
    v_fma_f32 v124, v124, s42, -v28
    v_fma_f32 v125, v125, s42, -v28
    v_exp_f32 v116, v116
    v_exp_f32 v117, v117
    v_exp_f32 v118, v118
    v_cvt_pk_bf16_f32 v24, v116, v117
    v_exp_f32 v119, v119
    v_exp_f32 v120, v120
    v_cvt_pk_bf16_f32 v25, v118, v119
    v_exp_f32 v121, v121
    v_exp_f32 v122, v122
    v_cvt_pk_bf16_f32 v26, v120, v121
    v_exp_f32 v123, v123
    v_exp_f32 v124, v124
    v_cvt_pk_bf16_f32 v27, v122, v123
    v_exp_f32 v125, v125
    s_nop 0
    v_cvt_pk_bf16_f32 v20, v124, v125
    v_cvt_pk_bf16_f32 v23, v124, v125
    s_waitcnt lgkmcnt(0)
    v_mfma_f32_16x16x32_bf16 v[64:67], v[16:19], v[24:27], 0
    v_mfma_f32_16x16x32_bf16 v[32:35], a[48:51], v[24:27], 0
    v_mfma_f32_16x16x32_bf16 v[36:39], a[52:55], v[24:27], 0
    v_mfma_f32_16x16x32_bf16 v[40:43], a[56:59], v[24:27], 0
    v_mfma_f32_16x16x32_bf16 v[44:47], a[60:63], v[24:27], 0
    v_mfma_f32_16x16x32_bf16 v[48:51], a[64:67], v[24:27], 0
    v_mfma_f32_16x16x32_bf16 v[52:55], a[68:71], v[24:27], 0
    v_mfma_f32_16x16x32_bf16 v[56:59], a[72:75], v[24:27], 0
    v_mfma_f32_16x16x32_bf16 v[60:63], a[76:79], v[24:27], 0
    v_mfma_f32_16x16x16_bf16 v[64:67], v[16:17], v[20:21], v[64:67]
    v_mfma_f32_16x16x16_bf16 v[32:35], v[104:105], v[20:21], v[32:35]
    v_mfma_f32_16x16x16_bf16 v[36:39], v[104:105], v[22:23], v[36:39]
    v_mfma_f32_16x16x16_bf16 v[40:43], v[106:107], v[20:21], v[40:43]
    v_rcp_f32 v28, v64
    v_mfma_f32_16x16x16_bf16 v[44:47], v[106:107], v[22:23], v[44:47]
    v_mul_f32 v32, v32, v28
    v_mul_f32 v33, v33, v28
    v_mfma_f32_16x16x16_bf16 v[48:51], v[108:109], v[20:21], v[48:51]
    v_mul_f32 v34, v34, v28
    v_mul_f32 v35, v35, v28
    v_mfma_f32_16x16x16_bf16 v[52:55], v[108:109], v[22:23], v[52:55]
    v_mul_f32 v36, v36, v28
    v_mul_f32 v37, v37, v28
    v_mfma_f32_16x16x16_bf16 v[56:59], v[110:111], v[20:21], v[56:59]
    v_mul_f32 v38, v38, v28
    v_mul_f32 v39, v39, v28
    v_mfma_f32_16x16x16_bf16 v[60:63], v[110:111], v[22:23], v[60:63]
    v_mul_f32 v40, v40, v28
    v_mul_f32 v41, v41, v28
    v_cvt_pk_bf16_f32 v68, v32, v36
    v_cvt_pk_bf16_f32 v69, v33, v37
    v_cvt_pk_bf16_f32 v70, v34, v38
    v_cvt_pk_bf16_f32 v71, v35, v39
    ds_write_b128 v12, v[68:71] offset:0
    v_pk_mul_f32 v[42:43], v[42:43], v[28:29] op_sel_hi:[1,0]
    v_pk_mul_f32 v[44:45], v[44:45], v[28:29] op_sel_hi:[1,0]
    v_pk_mul_f32 v[46:47], v[46:47], v[28:29] op_sel_hi:[1,0]
    v_cvt_pk_bf16_f32 v72, v40, v44
    v_cvt_pk_bf16_f32 v73, v41, v45
    v_cvt_pk_bf16_f32 v74, v42, v46
    v_cvt_pk_bf16_f32 v75, v43, v47
    ds_write_b128 v12, v[72:75] offset:1024
    v_pk_mul_f32 v[48:49], v[48:49], v[28:29] op_sel_hi:[1,0]
    v_pk_mul_f32 v[50:51], v[50:51], v[28:29] op_sel_hi:[1,0]
    v_pk_mul_f32 v[52:53], v[52:53], v[28:29] op_sel_hi:[1,0]
    v_pk_mul_f32 v[54:55], v[54:55], v[28:29] op_sel_hi:[1,0]
    v_cvt_pk_bf16_f32 v76, v48, v52
    v_cvt_pk_bf16_f32 v77, v49, v53
    v_cvt_pk_bf16_f32 v78, v50, v54
    v_cvt_pk_bf16_f32 v79, v51, v55
    ds_write_b128 v12, v[76:79] offset:2048
    v_pk_mul_f32 v[56:57], v[56:57], v[28:29] op_sel_hi:[1,0]
    v_pk_mul_f32 v[58:59], v[58:59], v[28:29] op_sel_hi:[1,0]
    v_pk_mul_f32 v[60:61], v[60:61], v[28:29] op_sel_hi:[1,0]
    v_pk_mul_f32 v[62:63], v[62:63], v[28:29] op_sel_hi:[1,0]
    v_cvt_pk_bf16_f32 v80, v56, v60
    v_cvt_pk_bf16_f32 v81, v57, v61
    v_cvt_pk_bf16_f32 v82, v58, v62
    v_cvt_pk_bf16_f32 v83, v59, v63
    ds_write_b128 v12, v[80:83] offset:3072
    s_cmp_eq_u32 s6, 15
    s_cbranch_scc1 C_nofetch
    s_add_u32 s44, s6, 1
    s_lshl_b32 s49, s44, 2
    s_add_u32 s49, s49, s5
    s_lshr_b32 s57, s49, 1
    s_cmp_gt_u32 s56, s57
    s_cbranch_scc1 CB_50
    s_add_u32 s57, s57, 1
    s_mov_b32 s96, 0
WS_51:
    buffer_load_dword v13, off, s[12:15], s54 sc1
    s_waitcnt vmcnt(0)
    v_readfirstlane_b32 s56, v13
    s_nop 3
    s_cmp_ge_u32 s56, s57
    s_cbranch_scc1 WSOK_52
    s_sleep 4
    s_add_u32 s96, s96, 1
    s_cmp_lt_u32 s96, 330033
    s_cbranch_scc1 WS_51
    s_branch L_bail
WSOK_52:
CB_50:
    s_lshl_b32 s49, s49, 5
    s_add_u32 s49, s49, s58
    s_lshl_b32 s57, s49, 13
    s_lshl_b32 s7, s53, 12
    s_add_u32 s57, s57, s7
    s_add_u32 s57, s57, 167772160
    s_add_u32 s7, s7, s59
    s_add_u32 m0, s7, 16384
    s_lshr_b32 s7, s49, 5
    s_add_u32 s49, s49, s7
    s_lshl_b32 s49, s49, 14
    s_add_u32 s49, s49, 16777216
    s_lshl_b32 s7, s53, 13
    s_add_u32 s49, s49, s7
    s_add_u32 s7, s7, s59
    buffer_load_dwordx4 v0, s[12:15], s57 offen offset:0 sc1 lds
    buffer_load_dwordx4 v0, s[12:15], s57 offen offset:1024 sc1 lds
    buffer_load_dwordx4 v0, s[12:15], s57 offen offset:2048 sc1 lds
    buffer_load_dwordx4 v0, s[12:15], s57 offen offset:3072 sc1 lds
    s_add_u32 m0, s7, 0
    s_nop 0
    buffer_load_dwordx4 v0, s[12:15], s49 offen offset:0 sc1 lds
    buffer_load_dwordx4 v0, s[12:15], s49 offen offset:1024 sc1 lds
    buffer_load_dwordx4 v0, s[12:15], s49 offen offset:2048 sc1 lds
    buffer_load_dwordx4 v0, s[12:15], s49 offen offset:3072 sc1 lds
    s_add_u32 m0, s7, 4096
    s_add_u32 s49, s49, 4096
    buffer_load_dwordx4 v0, s[12:15], s49 offen offset:0 sc1 lds
    buffer_load_dwordx4 v0, s[12:15], s49 offen offset:1024 sc1 lds
    buffer_load_dwordx4 v0, s[12:15], s49 offen offset:2048 sc1 lds
    buffer_load_dwordx4 v0, s[12:15], s49 offen offset:3072 sc1 lds
C_nofetch:
    s_lshl_b32 s48, s6, 2
    s_add_u32 s48, s48, s5
    s_lshl_b32 s48, s48, 4
    s_add_u32 s48, s48, s4
    s_lshl_b32 s48, s48, 15
    s_add_u32 s48, s48, 52428800
    s_waitcnt lgkmcnt(0)
    s_barrier
    ds_read_b128 a[0:3], v6 offset:0
    ds_read_b128 a[4:7], v6 offset:1024
    ds_read_b128 a[8:11], v6 offset:2048
    ds_read_b128 a[12:15], v6 offset:3072
    ds_read_b128 a[16:19], v6 offset:4096
    ds_read_b128 a[20:23], v6 offset:5120
    ds_read_b128 a[24:27], v6 offset:6144
    ds_read_b128 a[28:31], v6 offset:7168
    ds_read_b128 a[32:35], v6 offset:8192
    ds_read_b128 a[36:39], v6 offset:9216
    ds_read_b128 a[40:43], v6 offset:10240
    ds_read_b128 a[44:47], v6 offset:11264
    ds_read_b128 a[48:51], v6 offset:12288
    ds_read_b128 a[52:55], v6 offset:13312
    ds_read_b128 a[56:59], v6 offset:14336
    ds_read_b128 a[60:63], v6 offset:15360
    s_add_u32 s7, s48, 16384
    s_waitcnt lgkmcnt(15)
    v_mfma_f32_16x16x32_bf16 v[64:67], a[0:3], v[128:131], 0
    v_mfma_f32_16x16x32_bf16 v[68:71], a[0:3], v[144:147], 0
    v_mfma_f32_16x16x32_bf16 v[72:75], a[0:3], v[160:163], 0
    v_mfma_f32_16x16x32_bf16 v[76:79], a[0:3], v[176:179], 0
    v_mfma_f32_16x16x32_bf16 v[80:83], a[0:3], v[192:195], 0
    v_mfma_f32_16x16x32_bf16 v[84:87], a[0:3], v[208:211], 0
    v_mfma_f32_16x16x32_bf16 v[88:91], a[0:3], v[224:227], 0
    v_mfma_f32_16x16x32_bf16 v[92:95], a[0:3], v[240:243], 0
    s_waitcnt lgkmcnt(14)
    v_mfma_f32_16x16x32_bf16 v[64:67], a[4:7], v[132:135], v[64:67]
    v_mfma_f32_16x16x32_bf16 v[68:71], a[4:7], v[148:151], v[68:71]
    v_mfma_f32_16x16x32_bf16 v[72:75], a[4:7], v[164:167], v[72:75]
    v_mfma_f32_16x16x32_bf16 v[76:79], a[4:7], v[180:183], v[76:79]
    v_mfma_f32_16x16x32_bf16 v[80:83], a[4:7], v[196:199], v[80:83]
    v_mfma_f32_16x16x32_bf16 v[84:87], a[4:7], v[212:215], v[84:87]
    v_mfma_f32_16x16x32_bf16 v[88:91], a[4:7], v[228:231], v[88:91]
    v_mfma_f32_16x16x32_bf16 v[92:95], a[4:7], v[244:247], v[92:95]
    s_waitcnt lgkmcnt(13)
    v_mfma_f32_16x16x32_bf16 v[64:67], a[8:11], v[136:139], v[64:67]
    v_mfma_f32_16x16x32_bf16 v[68:71], a[8:11], v[152:155], v[68:71]
    v_mfma_f32_16x16x32_bf16 v[72:75], a[8:11], v[168:171], v[72:75]
    v_mfma_f32_16x16x32_bf16 v[76:79], a[8:11], v[184:187], v[76:79]
    v_mfma_f32_16x16x32_bf16 v[80:83], a[8:11], v[200:203], v[80:83]
    v_mfma_f32_16x16x32_bf16 v[84:87], a[8:11], v[216:219], v[84:87]
    v_mfma_f32_16x16x32_bf16 v[88:91], a[8:11], v[232:235], v[88:91]
    v_mfma_f32_16x16x32_bf16 v[92:95], a[8:11], v[248:251], v[92:95]
    s_waitcnt lgkmcnt(12)
    v_mfma_f32_16x16x32_bf16 v[64:67], a[12:15], v[140:143], v[64:67]
    v_mfma_f32_16x16x32_bf16 v[68:71], a[12:15], v[156:159], v[68:71]
    v_mfma_f32_16x16x32_bf16 v[72:75], a[12:15], v[172:175], v[72:75]
    v_mfma_f32_16x16x32_bf16 v[76:79], a[12:15], v[188:191], v[76:79]
    v_mfma_f32_16x16x32_bf16 v[80:83], a[12:15], v[204:207], v[80:83]
    v_mfma_f32_16x16x32_bf16 v[84:87], a[12:15], v[220:223], v[84:87]
    v_mfma_f32_16x16x32_bf16 v[88:91], a[12:15], v[236:239], v[88:91]
    v_mfma_f32_16x16x32_bf16 v[92:95], a[12:15], v[252:255], v[92:95]
    s_waitcnt lgkmcnt(11)
    v_mfma_f32_16x16x32_bf16 v[64:67], a[16:19], a[128:131], v[64:67]
    v_mfma_f32_16x16x32_bf16 v[68:71], a[16:19], a[144:147], v[68:71]
    v_mfma_f32_16x16x32_bf16 v[72:75], a[16:19], a[160:163], v[72:75]
    v_mfma_f32_16x16x32_bf16 v[76:79], a[16:19], a[176:179], v[76:79]
    v_mfma_f32_16x16x32_bf16 v[80:83], a[16:19], a[192:195], v[80:83]
    v_mfma_f32_16x16x32_bf16 v[84:87], a[16:19], a[208:211], v[84:87]
    v_mfma_f32_16x16x32_bf16 v[88:91], a[16:19], a[224:227], v[88:91]
    v_mfma_f32_16x16x32_bf16 v[92:95], a[16:19], a[240:243], v[92:95]
    s_waitcnt lgkmcnt(10)
    v_mfma_f32_16x16x32_bf16 v[64:67], a[20:23], a[132:135], v[64:67]
    v_mfma_f32_16x16x32_bf16 v[68:71], a[20:23], a[148:151], v[68:71]
    v_mfma_f32_16x16x32_bf16 v[72:75], a[20:23], a[164:167], v[72:75]
    v_mfma_f32_16x16x32_bf16 v[76:79], a[20:23], a[180:183], v[76:79]
    v_mfma_f32_16x16x32_bf16 v[80:83], a[20:23], a[196:199], v[80:83]
    v_mfma_f32_16x16x32_bf16 v[84:87], a[20:23], a[212:215], v[84:87]
    v_mfma_f32_16x16x32_bf16 v[88:91], a[20:23], a[228:231], v[88:91]
    v_mfma_f32_16x16x32_bf16 v[92:95], a[20:23], a[244:247], v[92:95]
    s_waitcnt lgkmcnt(9)
    v_mfma_f32_16x16x32_bf16 v[64:67], a[24:27], a[136:139], v[64:67]
    v_mfma_f32_16x16x32_bf16 v[68:71], a[24:27], a[152:155], v[68:71]
    v_mfma_f32_16x16x32_bf16 v[72:75], a[24:27], a[168:171], v[72:75]
    v_mfma_f32_16x16x32_bf16 v[76:79], a[24:27], a[184:187], v[76:79]
    v_mfma_f32_16x16x32_bf16 v[80:83], a[24:27], a[200:203], v[80:83]
    v_mfma_f32_16x16x32_bf16 v[84:87], a[24:27], a[216:219], v[84:87]
    v_mfma_f32_16x16x32_bf16 v[88:91], a[24:27], a[232:235], v[88:91]
    v_mfma_f32_16x16x32_bf16 v[92:95], a[24:27], a[248:251], v[92:95]
    s_waitcnt lgkmcnt(8)
    v_mfma_f32_16x16x32_bf16 v[64:67], a[28:31], a[140:143], v[64:67]
    v_mfma_f32_16x16x32_bf16 v[68:71], a[28:31], a[156:159], v[68:71]
    v_mfma_f32_16x16x32_bf16 v[72:75], a[28:31], a[172:175], v[72:75]
    v_mfma_f32_16x16x32_bf16 v[76:79], a[28:31], a[188:191], v[76:79]
    v_mfma_f32_16x16x32_bf16 v[80:83], a[28:31], a[204:207], v[80:83]
    v_mfma_f32_16x16x32_bf16 v[84:87], a[28:31], a[220:223], v[84:87]
    v_mfma_f32_16x16x32_bf16 v[88:91], a[28:31], a[236:239], v[88:91]
    v_mfma_f32_16x16x32_bf16 v[92:95], a[28:31], a[252:255], v[92:95]
    s_waitcnt lgkmcnt(7)
    v_mfma_f32_16x16x32_bf16 v[96:99], a[32:35], v[128:131], 0
    v_mfma_f32_16x16x32_bf16 v[100:103], a[32:35], v[144:147], 0
    v_mfma_f32_16x16x32_bf16 v[104:107], a[32:35], v[160:163], 0
    v_cvt_pk_bf16_f32 v24, v64, v68
    v_mfma_f32_16x16x32_bf16 v[108:111], a[32:35], v[176:179], 0
    v_cvt_pk_bf16_f32 v25, v72, v76
    v_mfma_f32_16x16x32_bf16 v[112:115], a[32:35], v[192:195], 0
    v_cvt_pk_bf16_f32 v26, v80, v84
    v_mfma_f32_16x16x32_bf16 v[116:119], a[32:35], v[208:211], 0
    v_cvt_pk_bf16_f32 v27, v88, v92
    v_mfma_f32_16x16x32_bf16 v[120:123], a[32:35], v[224:227], 0
    buffer_store_dwordx4 v[24:27], v7, s[12:15], s48 offen offset:0 sc1
    v_mfma_f32_16x16x32_bf16 v[124:127], a[32:35], v[240:243], 0
    s_waitcnt lgkmcnt(6)
    v_mfma_f32_16x16x32_bf16 v[96:99], a[36:39], v[132:135], v[96:99]
    v_mfma_f32_16x16x32_bf16 v[100:103], a[36:39], v[148:151], v[100:103]
    v_mfma_f32_16x16x32_bf16 v[104:107], a[36:39], v[164:167], v[104:107]
    v_cvt_pk_bf16_f32 v28, v65, v69
    v_mfma_f32_16x16x32_bf16 v[108:111], a[36:39], v[180:183], v[108:111]
    v_cvt_pk_bf16_f32 v29, v73, v77
    v_mfma_f32_16x16x32_bf16 v[112:115], a[36:39], v[196:199], v[112:115]
    v_cvt_pk_bf16_f32 v30, v81, v85
    v_mfma_f32_16x16x32_bf16 v[116:119], a[36:39], v[212:215], v[116:119]
    v_cvt_pk_bf16_f32 v31, v89, v93
    v_mfma_f32_16x16x32_bf16 v[120:123], a[36:39], v[228:231], v[120:123]
    buffer_store_dwordx4 v[28:31], v7, s[12:15], s48 offen offset:1024 sc1
    v_mfma_f32_16x16x32_bf16 v[124:127], a[36:39], v[244:247], v[124:127]
    s_waitcnt lgkmcnt(5)
    v_mfma_f32_16x16x32_bf16 v[96:99], a[40:43], v[136:139], v[96:99]
    v_mfma_f32_16x16x32_bf16 v[100:103], a[40:43], v[152:155], v[100:103]
    v_mfma_f32_16x16x32_bf16 v[104:107], a[40:43], v[168:171], v[104:107]
    v_cvt_pk_bf16_f32 v24, v66, v70
    v_mfma_f32_16x16x32_bf16 v[108:111], a[40:43], v[184:187], v[108:111]
    v_cvt_pk_bf16_f32 v25, v74, v78
    v_mfma_f32_16x16x32_bf16 v[112:115], a[40:43], v[200:203], v[112:115]
    v_cvt_pk_bf16_f32 v26, v82, v86
    v_mfma_f32_16x16x32_bf16 v[116:119], a[40:43], v[216:219], v[116:119]
    v_cvt_pk_bf16_f32 v27, v90, v94
    v_mfma_f32_16x16x32_bf16 v[120:123], a[40:43], v[232:235], v[120:123]
    buffer_store_dwordx4 v[24:27], v7, s[12:15], s48 offen offset:2048 sc1
    v_mfma_f32_16x16x32_bf16 v[124:127], a[40:43], v[248:251], v[124:127]
    s_waitcnt lgkmcnt(4)
    v_mfma_f32_16x16x32_bf16 v[96:99], a[44:47], v[140:143], v[96:99]
    v_mfma_f32_16x16x32_bf16 v[100:103], a[44:47], v[156:159], v[100:103]
    v_mfma_f32_16x16x32_bf16 v[104:107], a[44:47], v[172:175], v[104:107]
    v_cvt_pk_bf16_f32 v28, v67, v71
    v_mfma_f32_16x16x32_bf16 v[108:111], a[44:47], v[188:191], v[108:111]
    v_cvt_pk_bf16_f32 v29, v75, v79
    v_mfma_f32_16x16x32_bf16 v[112:115], a[44:47], v[204:207], v[112:115]
    v_cvt_pk_bf16_f32 v30, v83, v87
    v_mfma_f32_16x16x32_bf16 v[116:119], a[44:47], v[220:223], v[116:119]
    v_cvt_pk_bf16_f32 v31, v91, v95
    v_mfma_f32_16x16x32_bf16 v[120:123], a[44:47], v[236:239], v[120:123]
    buffer_store_dwordx4 v[28:31], v7, s[12:15], s48 offen offset:3072 sc1
    v_mfma_f32_16x16x32_bf16 v[124:127], a[44:47], v[252:255], v[124:127]
    s_waitcnt lgkmcnt(3)
    v_mfma_f32_16x16x32_bf16 v[96:99], a[48:51], a[128:131], v[96:99]
    v_mfma_f32_16x16x32_bf16 v[100:103], a[48:51], a[144:147], v[100:103]
    v_mfma_f32_16x16x32_bf16 v[104:107], a[48:51], a[160:163], v[104:107]
    v_mfma_f32_16x16x32_bf16 v[108:111], a[48:51], a[176:179], v[108:111]
    v_mfma_f32_16x16x32_bf16 v[112:115], a[48:51], a[192:195], v[112:115]
    v_mfma_f32_16x16x32_bf16 v[116:119], a[48:51], a[208:211], v[116:119]
    v_mfma_f32_16x16x32_bf16 v[120:123], a[48:51], a[224:227], v[120:123]
    v_mfma_f32_16x16x32_bf16 v[124:127], a[48:51], a[240:243], v[124:127]
    s_waitcnt lgkmcnt(2)
    v_mfma_f32_16x16x32_bf16 v[96:99], a[52:55], a[132:135], v[96:99]
    v_mfma_f32_16x16x32_bf16 v[100:103], a[52:55], a[148:151], v[100:103]
    v_mfma_f32_16x16x32_bf16 v[104:107], a[52:55], a[164:167], v[104:107]
    v_mfma_f32_16x16x32_bf16 v[108:111], a[52:55], a[180:183], v[108:111]
    v_mfma_f32_16x16x32_bf16 v[112:115], a[52:55], a[196:199], v[112:115]
    v_mfma_f32_16x16x32_bf16 v[116:119], a[52:55], a[212:215], v[116:119]
    v_mfma_f32_16x16x32_bf16 v[120:123], a[52:55], a[228:231], v[120:123]
    v_mfma_f32_16x16x32_bf16 v[124:127], a[52:55], a[244:247], v[124:127]
    s_waitcnt lgkmcnt(1)
    v_mfma_f32_16x16x32_bf16 v[96:99], a[56:59], a[136:139], v[96:99]
    v_mfma_f32_16x16x32_bf16 v[100:103], a[56:59], a[152:155], v[100:103]
    v_mfma_f32_16x16x32_bf16 v[104:107], a[56:59], a[168:171], v[104:107]
    v_mfma_f32_16x16x32_bf16 v[108:111], a[56:59], a[184:187], v[108:111]
    v_mfma_f32_16x16x32_bf16 v[112:115], a[56:59], a[200:203], v[112:115]
    v_mfma_f32_16x16x32_bf16 v[116:119], a[56:59], a[216:219], v[116:119]
    v_mfma_f32_16x16x32_bf16 v[120:123], a[56:59], a[232:235], v[120:123]
    v_mfma_f32_16x16x32_bf16 v[124:127], a[56:59], a[248:251], v[124:127]
    s_waitcnt lgkmcnt(0)
    v_mfma_f32_16x16x32_bf16 v[96:99], a[60:63], a[140:143], v[96:99]
    v_mfma_f32_16x16x32_bf16 v[100:103], a[60:63], a[156:159], v[100:103]
    v_mfma_f32_16x16x32_bf16 v[104:107], a[60:63], a[172:175], v[104:107]
    v_mfma_f32_16x16x32_bf16 v[108:111], a[60:63], a[188:191], v[108:111]
    v_mfma_f32_16x16x32_bf16 v[112:115], a[60:63], a[204:207], v[112:115]
    v_mfma_f32_16x16x32_bf16 v[116:119], a[60:63], a[220:223], v[116:119]
    v_mfma_f32_16x16x32_bf16 v[120:123], a[60:63], a[236:239], v[120:123]
    v_mfma_f32_16x16x32_bf16 v[124:127], a[60:63], a[252:255], v[124:127]
    v_cvt_pk_bf16_f32 v24, v96, v100
    v_cvt_pk_bf16_f32 v25, v104, v108
    v_cvt_pk_bf16_f32 v26, v112, v116
    s_nop 4
    v_cvt_pk_bf16_f32 v27, v120, v124
    buffer_store_dwordx4 v[24:27], v7, s[12:15], s7 offen offset:0 sc1
    v_cvt_pk_bf16_f32 v28, v97, v101
    v_cvt_pk_bf16_f32 v29, v105, v109
    v_cvt_pk_bf16_f32 v30, v113, v117
    v_cvt_pk_bf16_f32 v31, v121, v125
    buffer_store_dwordx4 v[28:31], v7, s[12:15], s7 offen offset:1024 sc1
    v_cvt_pk_bf16_f32 v24, v98, v102
    v_cvt_pk_bf16_f32 v25, v106, v110
    v_cvt_pk_bf16_f32 v26, v114, v118
    v_cvt_pk_bf16_f32 v27, v122, v126
    buffer_store_dwordx4 v[24:27], v7, s[12:15], s7 offen offset:2048 sc1
    v_cvt_pk_bf16_f32 v28, v99, v103
    v_cvt_pk_bf16_f32 v29, v107, v111
    v_cvt_pk_bf16_f32 v30, v115, v119
    v_cvt_pk_bf16_f32 v31, v123, v127
    buffer_store_dwordx4 v[28:31], v7, s[12:15], s7 offen offset:3072 sc1
    s_add_u32 s6, s6, 1
    s_waitcnt vmcnt(0)
    v_mov_b32 v13, s6
    s_mov_b64 exec, 1
    buffer_store_dword v13, off, s[12:15], s47 sc1
    s_mov_b64 exec, -1
    s_cmp_lt_u32 s6, 16
    s_cbranch_scc1 C_loop
    s_waitcnt vmcnt(0)
    s_endpgm
L_F:
    s_sub_u32 s4, s4, 160
    s_cmp_ge_u32 s4, 14
    s_cselect_b32 s5, 1, 0
    s_cselect_b32 s7, 14, 0
    s_sub_u32 s4, s4, s7
    s_mov_b32 s6, 0
    s_mov_b32 s46, 0
    s_mov_b32 s7, 1040
    v_mul_lo_u32 v3, v2, s7
    v_lshl_add_u32 v3, v1, 4, v3
    v_lshlrev_b32 v0, 4, v0
    s_lshl_b32 s47, s5, 2
    s_add_u32 s47, s47, s3
    s_lshl_b32 s47, s47, 11
    s_lshl_b32 s7, s4, 7
    s_add_u32 s47, s47, s7
    s_add_u32 s47, s47, 425984
    v_mov_b32 v24, 0
    s_mov_b64 exec, 1
    buffer_store_dword v24, off, s[12:15], s47 sc1
    s_mov_b64 exec, -1
    s_waitcnt vmcnt(0)
    s_barrier
    s_cmp_lg_u32 s3, 0
    s_cbranch_scc1 IA_53
    v_mov_b32 v24, 1
    s_mov_b64 exec, 1
    buffer_atomic_add v24, off, s[16:19], 0 offset:64
    s_mov_b64 exec, -1
IA_53:
    s_mov_b32 s90, 224
    s_mov_b32 s96, 0
WS_54:
    buffer_load_dword v24, off, s[16:19], s90 sc1
    s_waitcnt vmcnt(0)
    v_readfirstlane_b32 s7, v24
    s_nop 3
    s_cmp_ge_u32 s7, 1
    s_cbranch_scc1 WSOK_55
    s_sleep 64
    s_add_u32 s96, s96, 1
    s_cmp_lt_u32 s96, 44984
    s_cbranch_scc1 WS_54
    s_branch L_bail
WSOK_55:
    s_lshl_b32 s48, s4, 7
    s_add_u32 s48, s48, 8
    s_mov_b32 s24, s76
    s_mov_b32 s25, s77
    s_mov_b32 s26, 1835008
    s_mov_b32 s27, 0x20000
    s_mov_b32 s28, s78
    s_mov_b32 s29, s79
    s_mov_b32 s30, 1835008
    s_mov_b32 s31, 0x20000
    s_mov_b32 s32, s80
    s_mov_b32 s33, s81
    s_mov_b32 s34, 1835008
    s_mov_b32 s35, 0x20000
    s_lshl_b32 s48, s4, 8
    s_mov_b32 s90, 28672
    v_mul_lo_u32 v24, v1, s90
    v_lshl_add_u32 v24, v2, 4, v24
    s_mul_i32 s7, s3, 458752
    s_add_u32 s7, s7, s48
    v_add_u32 v24, s7, v24
    v_add_u32 v25, 3584, v24
    v_lshrrev_b32 v26, 2, v2
    s_mov_b32 s90, 32784
    v_mul_lo_u32 v26, v26, s90
    v_lshl_add_u32 v26, v1, 8, v26
    v_and_b32 v27, 3, v2
    v_lshl_add_u32 v26, v27, 6, v26
    s_lshl_b32 s7, s3, 13
    v_add_u32 v26, s7, v26
    s_mul_i32 s7, s3, 32784
    v_add_u32 v27, s7, v0
    s_lshl_b32 s48, s4, 17
    v_lshlrev_b32 v28, 13, v1
    v_lshl_add_u32 v28, v2, 4, v28
    s_lshl_b32 s7, s3, 8
    s_add_u32 s7, s7, s48
    v_add_u32 v28, s7, v28
    s_mov_b32 s7, 0
    buffer_load_dwordx4 v[32:35], v24, s[24:27], s7 offen
    buffer_load_dwordx4 v[36:39], v24, s[24:27], s7 offen offset:3584
    s_mov_b32 s7, 7168
    buffer_load_dwordx4 v[40:43], v24, s[24:27], s7 offen
    buffer_load_dwordx4 v[44:47], v24, s[24:27], s7 offen offset:3584
    s_mov_b32 s7, 14336
    buffer_load_dwordx4 v[48:51], v24, s[24:27], s7 offen
    buffer_load_dwordx4 v[52:55], v24, s[24:27], s7 offen offset:3584
    s_mov_b32 s7, 21504
    buffer_load_dwordx4 v[56:59], v24, s[24:27], s7 offen
    buffer_load_dwordx4 v[60:63], v24, s[24:27], s7 offen offset:3584
    s_mov_b32 s7, 114688
    buffer_load_dwordx4 v[64:67], v24, s[24:27], s7 offen
    buffer_load_dwordx4 v[68:71], v24, s[24:27], s7 offen offset:3584
    s_mov_b32 s7, 121856
    buffer_load_dwordx4 v[72:75], v24, s[24:27], s7 offen
    buffer_load_dwordx4 v[76:79], v24, s[24:27], s7 offen offset:3584
    s_mov_b32 s7, 129024
    buffer_load_dwordx4 v[80:83], v24, s[24:27], s7 offen
    buffer_load_dwordx4 v[84:87], v24, s[24:27], s7 offen offset:3584
    s_mov_b32 s7, 136192
    buffer_load_dwordx4 v[88:91], v24, s[24:27], s7 offen
    buffer_load_dwordx4 v[92:95], v24, s[24:27], s7 offen offset:3584
    s_mov_b32 s7, 229376
    buffer_load_dwordx4 v[96:99], v24, s[24:27], s7 offen
    buffer_load_dwordx4 v[100:103], v24, s[24:27], s7 offen offset:3584
    s_mov_b32 s7, 236544
    buffer_load_dwordx4 v[104:107], v24, s[24:27], s7 offen
    buffer_load_dwordx4 v[108:111], v24, s[24:27], s7 offen offset:3584
    s_mov_b32 s7, 243712
    buffer_load_dwordx4 v[112:115], v24, s[24:27], s7 offen
    buffer_load_dwordx4 v[116:119], v24, s[24:27], s7 offen offset:3584
    s_mov_b32 s7, 250880
    buffer_load_dwordx4 v[120:123], v24, s[24:27], s7 offen
    buffer_load_dwordx4 v[124:127], v24, s[24:27], s7 offen offset:3584
    s_waitcnt vmcnt(22)
    v_perm_b32 v128, v36, v32, s40
    v_perm_b32 v132, v36, v32, s41
    v_perm_b32 v136, v37, v33, s40
    v_perm_b32 v140, v37, v33, s41
    v_perm_b32 v144, v38, v34, s40
    v_perm_b32 v148, v38, v34, s41
    v_perm_b32 v152, v39, v35, s40
    v_perm_b32 v156, v39, v35, s41
    s_mov_b32 s7, 344064
    buffer_load_dwordx4 v[32:35], v24, s[24:27], s7 offen
    buffer_load_dwordx4 v[36:39], v24, s[24:27], s7 offen offset:3584
    s_waitcnt vmcnt(22)
    v_perm_b32 v129, v44, v40, s40
    v_perm_b32 v133, v44, v40, s41
    v_perm_b32 v137, v45, v41, s40
    v_perm_b32 v141, v45, v41, s41
    v_perm_b32 v145, v46, v42, s40
    v_perm_b32 v149, v46, v42, s41
    v_perm_b32 v153, v47, v43, s40
    v_perm_b32 v157, v47, v43, s41
    s_mov_b32 s7, 351232
    buffer_load_dwordx4 v[40:43], v24, s[24:27], s7 offen
    buffer_load_dwordx4 v[44:47], v24, s[24:27], s7 offen offset:3584
    s_waitcnt vmcnt(22)
    v_perm_b32 v130, v52, v48, s40
    v_perm_b32 v134, v52, v48, s41
    v_perm_b32 v138, v53, v49, s40
    v_perm_b32 v142, v53, v49, s41
    v_perm_b32 v146, v54, v50, s40
    v_perm_b32 v150, v54, v50, s41
    v_perm_b32 v154, v55, v51, s40
    v_perm_b32 v158, v55, v51, s41
    s_mov_b32 s7, 358400
    buffer_load_dwordx4 v[48:51], v24, s[24:27], s7 offen
    buffer_load_dwordx4 v[52:55], v24, s[24:27], s7 offen offset:3584
    s_waitcnt vmcnt(22)
    v_perm_b32 v131, v60, v56, s40
    v_perm_b32 v135, v60, v56, s41
    v_perm_b32 v139, v61, v57, s40
    v_perm_b32 v143, v61, v57, s41
    v_perm_b32 v147, v62, v58, s40
    v_perm_b32 v151, v62, v58, s41
    v_perm_b32 v155, v63, v59, s40
    v_perm_b32 v159, v63, v59, s41
    s_mov_b32 s7, 365568
    buffer_load_dwordx4 v[56:59], v24, s[24:27], s7 offen
    buffer_load_dwordx4 v[60:63], v24, s[24:27], s7 offen offset:3584
    ds_write_b128 v26, v[128:131] offset:0
    ds_write_b128 v26, v[132:135] offset:1024
    ds_write_b128 v26, v[136:139] offset:16
    ds_write_b128 v26, v[140:143] offset:1040
    ds_write_b128 v26, v[144:147] offset:32
    ds_write_b128 v26, v[148:151] offset:1056
    ds_write_b128 v26, v[152:155] offset:48
    ds_write_b128 v26, v[156:159] offset:1072
    s_waitcnt vmcnt(22)
    v_perm_b32 v128, v68, v64, s40
    v_perm_b32 v132, v68, v64, s41
    v_perm_b32 v136, v69, v65, s40
    v_perm_b32 v140, v69, v65, s41
    v_perm_b32 v144, v70, v66, s40
    v_perm_b32 v148, v70, v66, s41
    v_perm_b32 v152, v71, v67, s40
    v_perm_b32 v156, v71, v67, s41
    s_mov_b32 s7, 0
    buffer_load_dwordx4 v[64:67], v24, s[28:31], s7 offen
    buffer_load_dwordx4 v[68:71], v24, s[28:31], s7 offen offset:3584
    s_waitcnt vmcnt(22)
    v_perm_b32 v129, v76, v72, s40
    v_perm_b32 v133, v76, v72, s41
    v_perm_b32 v137, v77, v73, s40
    v_perm_b32 v141, v77, v73, s41
    v_perm_b32 v145, v78, v74, s40
    v_perm_b32 v149, v78, v74, s41
    v_perm_b32 v153, v79, v75, s40
    v_perm_b32 v157, v79, v75, s41
    s_mov_b32 s7, 7168
    buffer_load_dwordx4 v[72:75], v24, s[28:31], s7 offen
    buffer_load_dwordx4 v[76:79], v24, s[28:31], s7 offen offset:3584
    s_waitcnt vmcnt(22)
    v_perm_b32 v130, v84, v80, s40
    v_perm_b32 v134, v84, v80, s41
    v_perm_b32 v138, v85, v81, s40
    v_perm_b32 v142, v85, v81, s41
    v_perm_b32 v146, v86, v82, s40
    v_perm_b32 v150, v86, v82, s41
    v_perm_b32 v154, v87, v83, s40
    v_perm_b32 v158, v87, v83, s41
    s_mov_b32 s7, 14336
    buffer_load_dwordx4 v[80:83], v24, s[28:31], s7 offen
    buffer_load_dwordx4 v[84:87], v24, s[28:31], s7 offen offset:3584
    s_waitcnt vmcnt(22)
    v_perm_b32 v131, v92, v88, s40
    v_perm_b32 v135, v92, v88, s41
    v_perm_b32 v139, v93, v89, s40
    v_perm_b32 v143, v93, v89, s41
    v_perm_b32 v147, v94, v90, s40
    v_perm_b32 v151, v94, v90, s41
    v_perm_b32 v155, v95, v91, s40
    v_perm_b32 v159, v95, v91, s41
    s_mov_b32 s7, 21504
    buffer_load_dwordx4 v[88:91], v24, s[28:31], s7 offen
    buffer_load_dwordx4 v[92:95], v24, s[28:31], s7 offen offset:3584
    ds_write_b128 v26, v[128:131] offset:2048
    ds_write_b128 v26, v[132:135] offset:3072
    ds_write_b128 v26, v[136:139] offset:2064
    ds_write_b128 v26, v[140:143] offset:3088
    ds_write_b128 v26, v[144:147] offset:2080
    ds_write_b128 v26, v[148:151] offset:3104
    ds_write_b128 v26, v[152:155] offset:2096
    ds_write_b128 v26, v[156:159] offset:3120
    s_waitcnt vmcnt(22)
    v_perm_b32 v128, v100, v96, s40
    v_perm_b32 v132, v100, v96, s41
    v_perm_b32 v136, v101, v97, s40
    v_perm_b32 v140, v101, v97, s41
    v_perm_b32 v144, v102, v98, s40
    v_perm_b32 v148, v102, v98, s41
    v_perm_b32 v152, v103, v99, s40
    v_perm_b32 v156, v103, v99, s41
    s_mov_b32 s7, 114688
    buffer_load_dwordx4 v[96:99], v24, s[28:31], s7 offen
    buffer_load_dwordx4 v[100:103], v24, s[28:31], s7 offen offset:3584
    s_waitcnt vmcnt(22)
    v_perm_b32 v129, v108, v104, s40
    v_perm_b32 v133, v108, v104, s41
    v_perm_b32 v137, v109, v105, s40
    v_perm_b32 v141, v109, v105, s41
    v_perm_b32 v145, v110, v106, s40
    v_perm_b32 v149, v110, v106, s41
    v_perm_b32 v153, v111, v107, s40
    v_perm_b32 v157, v111, v107, s41
    s_mov_b32 s7, 121856
    buffer_load_dwordx4 v[104:107], v24, s[28:31], s7 offen
    buffer_load_dwordx4 v[108:111], v24, s[28:31], s7 offen offset:3584
    s_waitcnt vmcnt(22)
    v_perm_b32 v130, v116, v112, s40
    v_perm_b32 v134, v116, v112, s41
    v_perm_b32 v138, v117, v113, s40
    v_perm_b32 v142, v117, v113, s41
    v_perm_b32 v146, v118, v114, s40
    v_perm_b32 v150, v118, v114, s41
    v_perm_b32 v154, v119, v115, s40
    v_perm_b32 v158, v119, v115, s41
    s_mov_b32 s7, 129024
    buffer_load_dwordx4 v[112:115], v24, s[28:31], s7 offen
    buffer_load_dwordx4 v[116:119], v24, s[28:31], s7 offen offset:3584
    s_waitcnt vmcnt(22)
    v_perm_b32 v131, v124, v120, s40
    v_perm_b32 v135, v124, v120, s41
    v_perm_b32 v139, v125, v121, s40
    v_perm_b32 v143, v125, v121, s41
    v_perm_b32 v147, v126, v122, s40
    v_perm_b32 v151, v126, v122, s41
    v_perm_b32 v155, v127, v123, s40
    v_perm_b32 v159, v127, v123, s41
    s_mov_b32 s7, 136192
    buffer_load_dwordx4 v[120:123], v24, s[28:31], s7 offen
    buffer_load_dwordx4 v[124:127], v24, s[28:31], s7 offen offset:3584
    ds_write_b128 v26, v[128:131] offset:4096
    ds_write_b128 v26, v[132:135] offset:5120
    ds_write_b128 v26, v[136:139] offset:4112
    ds_write_b128 v26, v[140:143] offset:5136
    ds_write_b128 v26, v[144:147] offset:4128
    ds_write_b128 v26, v[148:151] offset:5152
    ds_write_b128 v26, v[152:155] offset:4144
    ds_write_b128 v26, v[156:159] offset:5168
    s_waitcnt vmcnt(22)
    v_perm_b32 v128, v36, v32, s40
    v_perm_b32 v132, v36, v32, s41
    v_perm_b32 v136, v37, v33, s40
    v_perm_b32 v140, v37, v33, s41
    v_perm_b32 v144, v38, v34, s40
    v_perm_b32 v148, v38, v34, s41
    v_perm_b32 v152, v39, v35, s40
    v_perm_b32 v156, v39, v35, s41
    s_mov_b32 s7, 229376
    buffer_load_dwordx4 v[32:35], v24, s[28:31], s7 offen
    buffer_load_dwordx4 v[36:39], v24, s[28:31], s7 offen offset:3584
    s_waitcnt vmcnt(22)
    v_perm_b32 v129, v44, v40, s40
    v_perm_b32 v133, v44, v40, s41
    v_perm_b32 v137, v45, v41, s40
    v_perm_b32 v141, v45, v41, s41
    v_perm_b32 v145, v46, v42, s40
    v_perm_b32 v149, v46, v42, s41
    v_perm_b32 v153, v47, v43, s40
    v_perm_b32 v157, v47, v43, s41
    s_mov_b32 s7, 236544
    buffer_load_dwordx4 v[40:43], v24, s[28:31], s7 offen
    buffer_load_dwordx4 v[44:47], v24, s[28:31], s7 offen offset:3584
    s_waitcnt vmcnt(22)
    v_perm_b32 v130, v52, v48, s40
    v_perm_b32 v134, v52, v48, s41
    v_perm_b32 v138, v53, v49, s40
    v_perm_b32 v142, v53, v49, s41
    v_perm_b32 v146, v54, v50, s40
    v_perm_b32 v150, v54, v50, s41
    v_perm_b32 v154, v55, v51, s40
    v_perm_b32 v158, v55, v51, s41
    s_mov_b32 s7, 243712
    buffer_load_dwordx4 v[48:51], v24, s[28:31], s7 offen
    buffer_load_dwordx4 v[52:55], v24, s[28:31], s7 offen offset:3584
    s_waitcnt vmcnt(22)
    v_perm_b32 v131, v60, v56, s40
    v_perm_b32 v135, v60, v56, s41
    v_perm_b32 v139, v61, v57, s40
    v_perm_b32 v143, v61, v57, s41
    v_perm_b32 v147, v62, v58, s40
    v_perm_b32 v151, v62, v58, s41
    v_perm_b32 v155, v63, v59, s40
    v_perm_b32 v159, v63, v59, s41
    s_mov_b32 s7, 250880
    buffer_load_dwordx4 v[56:59], v24, s[28:31], s7 offen
    buffer_load_dwordx4 v[60:63], v24, s[28:31], s7 offen offset:3584
    ds_write_b128 v26, v[128:131] offset:6144
    ds_write_b128 v26, v[132:135] offset:7168
    ds_write_b128 v26, v[136:139] offset:6160
    ds_write_b128 v26, v[140:143] offset:7184
    ds_write_b128 v26, v[144:147] offset:6176
    ds_write_b128 v26, v[148:151] offset:7200
    ds_write_b128 v26, v[152:155] offset:6192
    ds_write_b128 v26, v[156:159] offset:7216
    s_waitcnt lgkmcnt(0)
    s_barrier
    ds_read_b128 a[0:3], v27 offset:0
    ds_read_b128 a[4:7], v27 offset:1024
    ds_read_b128 a[8:11], v27 offset:2048
    ds_read_b128 a[12:15], v27 offset:3072
    ds_read_b128 a[16:19], v27 offset:4096
    ds_read_b128 a[20:23], v27 offset:5120
    ds_read_b128 a[24:27], v27 offset:6144
    ds_read_b128 a[28:31], v27 offset:7168
    ds_read_b128 a[32:35], v27 offset:8192
    ds_read_b128 a[36:39], v27 offset:9216
    ds_read_b128 a[40:43], v27 offset:10240
    ds_read_b128 a[44:47], v27 offset:11264
    ds_read_b128 a[48:51], v27 offset:12288
    ds_read_b128 a[52:55], v27 offset:13312
    ds_read_b128 a[56:59], v27 offset:14336
    ds_read_b128 a[60:63], v27 offset:15360
    ds_read_b128 a[64:67], v27 offset:16384
    ds_read_b128 a[68:71], v27 offset:17408
    ds_read_b128 a[72:75], v27 offset:18432
    ds_read_b128 a[76:79], v27 offset:19456
    ds_read_b128 a[80:83], v27 offset:20480
    ds_read_b128 a[84:87], v27 offset:21504
    ds_read_b128 a[88:91], v27 offset:22528
    ds_read_b128 a[92:95], v27 offset:23552
    ds_read_b128 a[96:99], v27 offset:24576
    ds_read_b128 a[100:103], v27 offset:25600
    ds_read_b128 a[104:107], v27 offset:26624
    ds_read_b128 a[108:111], v27 offset:27648
    ds_read_b128 a[112:115], v27 offset:28672
    ds_read_b128 a[116:119], v27 offset:29696
    ds_read_b128 a[120:123], v27 offset:30720
    ds_read_b128 a[124:127], v27 offset:31744
    s_waitcnt lgkmcnt(0)
    s_barrier
    s_waitcnt vmcnt(22)
    v_perm_b32 v128, v68, v64, s40
    v_perm_b32 v132, v68, v64, s41
    v_perm_b32 v136, v69, v65, s40
    v_perm_b32 v140, v69, v65, s41
    v_perm_b32 v144, v70, v66, s40
    v_perm_b32 v148, v70, v66, s41
    v_perm_b32 v152, v71, v67, s40
    v_perm_b32 v156, v71, v67, s41
    s_mov_b32 s7, 344064
    buffer_load_dwordx4 v[64:67], v24, s[28:31], s7 offen
    buffer_load_dwordx4 v[68:71], v24, s[28:31], s7 offen offset:3584
    s_waitcnt vmcnt(22)
    v_perm_b32 v129, v76, v72, s40
    v_perm_b32 v133, v76, v72, s41
    v_perm_b32 v137, v77, v73, s40
    v_perm_b32 v141, v77, v73, s41
    v_perm_b32 v145, v78, v74, s40
    v_perm_b32 v149, v78, v74, s41
    v_perm_b32 v153, v79, v75, s40
    v_perm_b32 v157, v79, v75, s41
    s_mov_b32 s7, 351232
    buffer_load_dwordx4 v[72:75], v24, s[28:31], s7 offen
    buffer_load_dwordx4 v[76:79], v24, s[28:31], s7 offen offset:3584
    s_waitcnt vmcnt(22)
    v_perm_b32 v130, v84, v80, s40
    v_perm_b32 v134, v84, v80, s41
    v_perm_b32 v138, v85, v81, s40
    v_perm_b32 v142, v85, v81, s41
    v_perm_b32 v146, v86, v82, s40
    v_perm_b32 v150, v86, v82, s41
    v_perm_b32 v154, v87, v83, s40
    v_perm_b32 v158, v87, v83, s41
    s_mov_b32 s7, 358400
    buffer_load_dwordx4 v[80:83], v24, s[28:31], s7 offen
    buffer_load_dwordx4 v[84:87], v24, s[28:31], s7 offen offset:3584
    s_waitcnt vmcnt(22)
    v_perm_b32 v131, v92, v88, s40
    v_perm_b32 v135, v92, v88, s41
    v_perm_b32 v139, v93, v89, s40
    v_perm_b32 v143, v93, v89, s41
    v_perm_b32 v147, v94, v90, s40
    v_perm_b32 v151, v94, v90, s41
    v_perm_b32 v155, v95, v91, s40
    v_perm_b32 v159, v95, v91, s41
    s_mov_b32 s7, 365568
    buffer_load_dwordx4 v[88:91], v24, s[28:31], s7 offen
    buffer_load_dwordx4 v[92:95], v24, s[28:31], s7 offen offset:3584
    ds_write_b128 v26, v[128:131] offset:0
    ds_write_b128 v26, v[132:135] offset:1024
    ds_write_b128 v26, v[136:139] offset:16
    ds_write_b128 v26, v[140:143] offset:1040
    ds_write_b128 v26, v[144:147] offset:32
    ds_write_b128 v26, v[148:151] offset:1056
    ds_write_b128 v26, v[152:155] offset:48
    ds_write_b128 v26, v[156:159] offset:1072
    s_waitcnt vmcnt(22)
    v_perm_b32 v128, v100, v96, s40
    v_perm_b32 v132, v100, v96, s41
    v_perm_b32 v136, v101, v97, s40
    v_perm_b32 v140, v101, v97, s41
    v_perm_b32 v144, v102, v98, s40
    v_perm_b32 v148, v102, v98, s41
    v_perm_b32 v152, v103, v99, s40
    v_perm_b32 v156, v103, v99, s41
    s_mov_b32 s7, 0
    buffer_load_dwordx4 v[96:99], v28, s[32:35], s7 offen
    buffer_load_dwordx4 v[100:103], v28, s[32:35], s7 offen offset:1024
    s_waitcnt vmcnt(22)
    v_perm_b32 v129, v108, v104, s40
    v_perm_b32 v133, v108, v104, s41
    v_perm_b32 v137, v109, v105, s40
    v_perm_b32 v141, v109, v105, s41
    v_perm_b32 v145, v110, v106, s40
    v_perm_b32 v149, v110, v106, s41
    v_perm_b32 v153, v111, v107, s40
    v_perm_b32 v157, v111, v107, s41
    s_mov_b32 s7, 2048
    buffer_load_dwordx4 v[104:107], v28, s[32:35], s7 offen
    buffer_load_dwordx4 v[108:111], v28, s[32:35], s7 offen offset:1024
    s_waitcnt vmcnt(22)
    v_perm_b32 v130, v116, v112, s40
    v_perm_b32 v134, v116, v112, s41
    v_perm_b32 v138, v117, v113, s40
    v_perm_b32 v142, v117, v113, s41
    v_perm_b32 v146, v118, v114, s40
    v_perm_b32 v150, v118, v114, s41
    v_perm_b32 v154, v119, v115, s40
    v_perm_b32 v158, v119, v115, s41
    s_mov_b32 s7, 4096
    buffer_load_dwordx4 v[112:115], v28, s[32:35], s7 offen
    buffer_load_dwordx4 v[116:119], v28, s[32:35], s7 offen offset:1024
    s_waitcnt vmcnt(22)
    v_perm_b32 v131, v124, v120, s40
    v_perm_b32 v135, v124, v120, s41
    v_perm_b32 v139, v125, v121, s40
    v_perm_b32 v143, v125, v121, s41
    v_perm_b32 v147, v126, v122, s40
    v_perm_b32 v151, v126, v122, s41
    v_perm_b32 v155, v127, v123, s40
    v_perm_b32 v159, v127, v123, s41
    s_mov_b32 s7, 6144
    buffer_load_dwordx4 v[120:123], v28, s[32:35], s7 offen
    buffer_load_dwordx4 v[124:127], v28, s[32:35], s7 offen offset:1024
    ds_write_b128 v26, v[128:131] offset:2048
    ds_write_b128 v26, v[132:135] offset:3072
    ds_write_b128 v26, v[136:139] offset:2064
    ds_write_b128 v26, v[140:143] offset:3088
    ds_write_b128 v26, v[144:147] offset:2080
    ds_write_b128 v26, v[148:151] offset:3104
    ds_write_b128 v26, v[152:155] offset:2096
    ds_write_b128 v26, v[156:159] offset:3120
    s_waitcnt vmcnt(22)
    v_perm_b32 v128, v36, v32, s40
    v_perm_b32 v132, v36, v32, s41
    v_perm_b32 v136, v37, v33, s40
    v_perm_b32 v140, v37, v33, s41
    v_perm_b32 v144, v38, v34, s40
    v_perm_b32 v148, v38, v34, s41
    v_perm_b32 v152, v39, v35, s40
    v_perm_b32 v156, v39, v35, s41
    s_mov_b32 s7, 32768
    buffer_load_dwordx4 v[32:35], v28, s[32:35], s7 offen
    buffer_load_dwordx4 v[36:39], v28, s[32:35], s7 offen offset:1024
    s_waitcnt vmcnt(22)
    v_perm_b32 v129, v44, v40, s40
    v_perm_b32 v133, v44, v40, s41
    v_perm_b32 v137, v45, v41, s40
    v_perm_b32 v141, v45, v41, s41
    v_perm_b32 v145, v46, v42, s40
    v_perm_b32 v149, v46, v42, s41
    v_perm_b32 v153, v47, v43, s40
    v_perm_b32 v157, v47, v43, s41
    s_mov_b32 s7, 34816
    buffer_load_dwordx4 v[40:43], v28, s[32:35], s7 offen
    buffer_load_dwordx4 v[44:47], v28, s[32:35], s7 offen offset:1024
    s_waitcnt vmcnt(22)
    v_perm_b32 v130, v52, v48, s40
    v_perm_b32 v134, v52, v48, s41
    v_perm_b32 v138, v53, v49, s40
    v_perm_b32 v142, v53, v49, s41
    v_perm_b32 v146, v54, v50, s40
    v_perm_b32 v150, v54, v50, s41
    v_perm_b32 v154, v55, v51, s40
    v_perm_b32 v158, v55, v51, s41
    s_mov_b32 s7, 36864
    buffer_load_dwordx4 v[48:51], v28, s[32:35], s7 offen
    buffer_load_dwordx4 v[52:55], v28, s[32:35], s7 offen offset:1024
    s_waitcnt vmcnt(22)
    v_perm_b32 v131, v60, v56, s40
    v_perm_b32 v135, v60, v56, s41
    v_perm_b32 v139, v61, v57, s40
    v_perm_b32 v143, v61, v57, s41
    v_perm_b32 v147, v62, v58, s40
    v_perm_b32 v151, v62, v58, s41
    v_perm_b32 v155, v63, v59, s40
    v_perm_b32 v159, v63, v59, s41
    s_mov_b32 s7, 38912
    buffer_load_dwordx4 v[56:59], v28, s[32:35], s7 offen
    buffer_load_dwordx4 v[60:63], v28, s[32:35], s7 offen offset:1024
    ds_write_b128 v26, v[128:131] offset:4096
    ds_write_b128 v26, v[132:135] offset:5120
    ds_write_b128 v26, v[136:139] offset:4112
    ds_write_b128 v26, v[140:143] offset:5136
    ds_write_b128 v26, v[144:147] offset:4128
    ds_write_b128 v26, v[148:151] offset:5152
    ds_write_b128 v26, v[152:155] offset:4144
    ds_write_b128 v26, v[156:159] offset:5168
    s_waitcnt vmcnt(22)
    v_perm_b32 v128, v68, v64, s40
    v_perm_b32 v132, v68, v64, s41
    v_perm_b32 v136, v69, v65, s40
    v_perm_b32 v140, v69, v65, s41
    v_perm_b32 v144, v70, v66, s40
    v_perm_b32 v148, v70, v66, s41
    v_perm_b32 v152, v71, v67, s40
    v_perm_b32 v156, v71, v67, s41
    s_mov_b32 s7, 65536
    buffer_load_dwordx4 v[64:67], v28, s[32:35], s7 offen
    buffer_load_dwordx4 v[68:71], v28, s[32:35], s7 offen offset:1024
    s_waitcnt vmcnt(22)
    v_perm_b32 v129, v76, v72, s40
    v_perm_b32 v133, v76, v72, s41
    v_perm_b32 v137, v77, v73, s40
    v_perm_b32 v141, v77, v73, s41
    v_perm_b32 v145, v78, v74, s40
    v_perm_b32 v149, v78, v74, s41
    v_perm_b32 v153, v79, v75, s40
    v_perm_b32 v157, v79, v75, s41
    s_mov_b32 s7, 67584
    buffer_load_dwordx4 v[72:75], v28, s[32:35], s7 offen
    buffer_load_dwordx4 v[76:79], v28, s[32:35], s7 offen offset:1024
    s_waitcnt vmcnt(22)
    v_perm_b32 v130, v84, v80, s40
    v_perm_b32 v134, v84, v80, s41
    v_perm_b32 v138, v85, v81, s40
    v_perm_b32 v142, v85, v81, s41
    v_perm_b32 v146, v86, v82, s40
    v_perm_b32 v150, v86, v82, s41
    v_perm_b32 v154, v87, v83, s40
    v_perm_b32 v158, v87, v83, s41
    s_mov_b32 s7, 69632
    buffer_load_dwordx4 v[80:83], v28, s[32:35], s7 offen
    buffer_load_dwordx4 v[84:87], v28, s[32:35], s7 offen offset:1024
    s_waitcnt vmcnt(22)
    v_perm_b32 v131, v92, v88, s40
    v_perm_b32 v135, v92, v88, s41
    v_perm_b32 v139, v93, v89, s40
    v_perm_b32 v143, v93, v89, s41
    v_perm_b32 v147, v94, v90, s40
    v_perm_b32 v151, v94, v90, s41
    v_perm_b32 v155, v95, v91, s40
    v_perm_b32 v159, v95, v91, s41
    s_mov_b32 s7, 71680
    buffer_load_dwordx4 v[88:91], v28, s[32:35], s7 offen
    buffer_load_dwordx4 v[92:95], v28, s[32:35], s7 offen offset:1024
    ds_write_b128 v26, v[128:131] offset:6144
    ds_write_b128 v26, v[132:135] offset:7168
    ds_write_b128 v26, v[136:139] offset:6160
    ds_write_b128 v26, v[140:143] offset:7184
    ds_write_b128 v26, v[144:147] offset:6176
    ds_write_b128 v26, v[148:151] offset:7200
    ds_write_b128 v26, v[152:155] offset:6192
    ds_write_b128 v26, v[156:159] offset:7216
    s_waitcnt lgkmcnt(0)
    s_barrier
    ds_read_b128 a[128:131], v27 offset:0
    ds_read_b128 a[132:135], v27 offset:1024
    ds_read_b128 a[136:139], v27 offset:2048
    ds_read_b128 a[140:143], v27 offset:3072
    ds_read_b128 a[144:147], v27 offset:4096
    ds_read_b128 a[148:151], v27 offset:5120
    ds_read_b128 a[152:155], v27 offset:6144
    ds_read_b128 a[156:159], v27 offset:7168
    ds_read_b128 a[160:163], v27 offset:8192
    ds_read_b128 a[164:167], v27 offset:9216
    ds_read_b128 a[168:171], v27 offset:10240
    ds_read_b128 a[172:175], v27 offset:11264
    ds_read_b128 a[176:179], v27 offset:12288
    ds_read_b128 a[180:183], v27 offset:13312
    ds_read_b128 a[184:187], v27 offset:14336
    ds_read_b128 a[188:191], v27 offset:15360
    ds_read_b128 a[192:195], v27 offset:16384
    ds_read_b128 a[196:199], v27 offset:17408
    ds_read_b128 a[200:203], v27 offset:18432
    ds_read_b128 a[204:207], v27 offset:19456
    ds_read_b128 a[208:211], v27 offset:20480
    ds_read_b128 a[212:215], v27 offset:21504
    ds_read_b128 a[216:219], v27 offset:22528
    ds_read_b128 a[220:223], v27 offset:23552
    ds_read_b128 a[224:227], v27 offset:24576
    ds_read_b128 a[228:231], v27 offset:25600
    ds_read_b128 a[232:235], v27 offset:26624
    ds_read_b128 a[236:239], v27 offset:27648
    ds_read_b128 a[240:243], v27 offset:28672
    ds_read_b128 a[244:247], v27 offset:29696
    ds_read_b128 a[248:251], v27 offset:30720
    ds_read_b128 a[252:255], v27 offset:31744
    s_waitcnt lgkmcnt(0)
    s_barrier
    s_waitcnt vmcnt(22)
    v_perm_b32 v128, v100, v96, s40
    v_perm_b32 v144, v100, v96, s41
    v_perm_b32 v160, v101, v97, s40
    v_perm_b32 v176, v101, v97, s41
    v_perm_b32 v192, v102, v98, s40
    v_perm_b32 v208, v102, v98, s41
    v_perm_b32 v224, v103, v99, s40
    v_perm_b32 v240, v103, v99, s41
    s_mov_b32 s7, 98304
    buffer_load_dwordx4 v[96:99], v28, s[32:35], s7 offen
    buffer_load_dwordx4 v[100:103], v28, s[32:35], s7 offen offset:1024
    s_waitcnt vmcnt(22)
    v_perm_b32 v129, v108, v104, s40
    v_perm_b32 v145, v108, v104, s41
    v_perm_b32 v161, v109, v105, s40
    v_perm_b32 v177, v109, v105, s41
    v_perm_b32 v193, v110, v106, s40
    v_perm_b32 v209, v110, v106, s41
    v_perm_b32 v225, v111, v107, s40
    v_perm_b32 v241, v111, v107, s41
    s_mov_b32 s7, 100352
    buffer_load_dwordx4 v[104:107], v28, s[32:35], s7 offen
    buffer_load_dwordx4 v[108:111], v28, s[32:35], s7 offen offset:1024
    s_waitcnt vmcnt(22)
    v_perm_b32 v130, v116, v112, s40
    v_perm_b32 v146, v116, v112, s41
    v_perm_b32 v162, v117, v113, s40
    v_perm_b32 v178, v117, v113, s41
    v_perm_b32 v194, v118, v114, s40
    v_perm_b32 v210, v118, v114, s41
    v_perm_b32 v226, v119, v115, s40
    v_perm_b32 v242, v119, v115, s41
    s_mov_b32 s7, 102400
    buffer_load_dwordx4 v[112:115], v28, s[32:35], s7 offen
    buffer_load_dwordx4 v[116:119], v28, s[32:35], s7 offen offset:1024
    s_waitcnt vmcnt(22)
    v_perm_b32 v131, v124, v120, s40
    v_perm_b32 v147, v124, v120, s41
    v_perm_b32 v163, v125, v121, s40
    v_perm_b32 v179, v125, v121, s41
    v_perm_b32 v195, v126, v122, s40
    v_perm_b32 v211, v126, v122, s41
    v_perm_b32 v227, v127, v123, s40
    v_perm_b32 v243, v127, v123, s41
    s_mov_b32 s7, 104448
    buffer_load_dwordx4 v[120:123], v28, s[32:35], s7 offen
    buffer_load_dwordx4 v[124:127], v28, s[32:35], s7 offen offset:1024
    s_waitcnt vmcnt(22)
    v_perm_b32 v132, v36, v32, s40
    v_perm_b32 v148, v36, v32, s41
    v_perm_b32 v164, v37, v33, s40
    v_perm_b32 v180, v37, v33, s41
    v_perm_b32 v196, v38, v34, s40
    v_perm_b32 v212, v38, v34, s41
    v_perm_b32 v228, v39, v35, s40
    v_perm_b32 v244, v39, v35, s41
    s_waitcnt vmcnt(20)
    v_perm_b32 v133, v44, v40, s40
    v_perm_b32 v149, v44, v40, s41
    v_perm_b32 v165, v45, v41, s40
    v_perm_b32 v181, v45, v41, s41
    v_perm_b32 v197, v46, v42, s40
    v_perm_b32 v213, v46, v42, s41
    v_perm_b32 v229, v47, v43, s40
    v_perm_b32 v245, v47, v43, s41
    s_waitcnt vmcnt(18)
    v_perm_b32 v134, v52, v48, s40
    v_perm_b32 v150, v52, v48, s41
    v_perm_b32 v166, v53, v49, s40
    v_perm_b32 v182, v53, v49, s41
    v_perm_b32 v198, v54, v50, s40
    v_perm_b32 v214, v54, v50, s41
    v_perm_b32 v230, v55, v51, s40
    v_perm_b32 v246, v55, v51, s41
    s_waitcnt vmcnt(16)
    v_perm_b32 v135, v60, v56, s40
    v_perm_b32 v151, v60, v56, s41
    v_perm_b32 v167, v61, v57, s40
    v_perm_b32 v183, v61, v57, s41
    v_perm_b32 v199, v62, v58, s40
    v_perm_b32 v215, v62, v58, s41
    v_perm_b32 v231, v63, v59, s40
    v_perm_b32 v247, v63, v59, s41
    s_waitcnt vmcnt(14)
    v_perm_b32 v136, v68, v64, s40
    v_perm_b32 v152, v68, v64, s41
    v_perm_b32 v168, v69, v65, s40
    v_perm_b32 v184, v69, v65, s41
    v_perm_b32 v200, v70, v66, s40
    v_perm_b32 v216, v70, v66, s41
    v_perm_b32 v232, v71, v67, s40
    v_perm_b32 v248, v71, v67, s41
    s_waitcnt vmcnt(12)
    v_perm_b32 v137, v76, v72, s40
    v_perm_b32 v153, v76, v72, s41
    v_perm_b32 v169, v77, v73, s40
    v_perm_b32 v185, v77, v73, s41
    v_perm_b32 v201, v78, v74, s40
    v_perm_b32 v217, v78, v74, s41
    v_perm_b32 v233, v79, v75, s40
    v_perm_b32 v249, v79, v75, s41
    s_waitcnt vmcnt(10)
    v_perm_b32 v138, v84, v80, s40
    v_perm_b32 v154, v84, v80, s41
    v_perm_b32 v170, v85, v81, s40
    v_perm_b32 v186, v85, v81, s41
    v_perm_b32 v202, v86, v82, s40
    v_perm_b32 v218, v86, v82, s41
    v_perm_b32 v234, v87, v83, s40
    v_perm_b32 v250, v87, v83, s41
    s_waitcnt vmcnt(8)
    v_perm_b32 v139, v92, v88, s40
    v_perm_b32 v155, v92, v88, s41
    v_perm_b32 v171, v93, v89, s40
    v_perm_b32 v187, v93, v89, s41
    v_perm_b32 v203, v94, v90, s40
    v_perm_b32 v219, v94, v90, s41
    v_perm_b32 v235, v95, v91, s40
    v_perm_b32 v251, v95, v91, s41
    s_waitcnt vmcnt(6)
    v_perm_b32 v140, v100, v96, s40
    v_perm_b32 v156, v100, v96, s41
    v_perm_b32 v172, v101, v97, s40
    v_perm_b32 v188, v101, v97, s41
    v_perm_b32 v204, v102, v98, s40
    v_perm_b32 v220, v102, v98, s41
    v_perm_b32 v236, v103, v99, s40
    v_perm_b32 v252, v103, v99, s41
    s_waitcnt vmcnt(4)
    v_perm_b32 v141, v108, v104, s40
    v_perm_b32 v157, v108, v104, s41
    v_perm_b32 v173, v109, v105, s40
    v_perm_b32 v189, v109, v105, s41
    v_perm_b32 v205, v110, v106, s40
    v_perm_b32 v221, v110, v106, s41
    v_perm_b32 v237, v111, v107, s40
    v_perm_b32 v253, v111, v107, s41
    s_waitcnt vmcnt(2)
    v_perm_b32 v142, v116, v112, s40
    v_perm_b32 v158, v116, v112, s41
    v_perm_b32 v174, v117, v113, s40
    v_perm_b32 v190, v117, v113, s41
    v_perm_b32 v206, v118, v114, s40
    v_perm_b32 v222, v118, v114, s41
    v_perm_b32 v238, v119, v115, s40
    v_perm_b32 v254, v119, v115, s41
    s_waitcnt vmcnt(0)
    v_perm_b32 v143, v124, v120, s40
    v_perm_b32 v159, v124, v120, s41
    v_perm_b32 v175, v125, v121, s40
    v_perm_b32 v191, v125, v121, s41
    v_perm_b32 v207, v126, v122, s40
    v_perm_b32 v223, v126, v122, s41
    v_perm_b32 v239, v127, v123, s40
    v_perm_b32 v255, v127, v123, s41
    s_lshl_b32 s90, s5, 15
    s_lshl_b32 s91, s3, 13
    s_add_u32 s90, s90, s91
    s_mul_i32 s91, s3, 8320
    s_add_u32 s91, s91, s46
    s_add_u32 m0, s91, 0
    s_nop 0
    buffer_load_dwordx4 v0, s[8:11], s90 offen lds
    s_add_u32 s90, s90, 1024
    s_add_u32 m0, s91, 1040
    s_nop 0
    buffer_load_dwordx4 v0, s[8:11], s90 offen lds
    s_add_u32 s90, s90, 1024
    s_add_u32 m0, s91, 2080
    s_nop 0
    buffer_load_dwordx4 v0, s[8:11], s90 offen lds
    s_add_u32 s90, s90, 1024
    s_add_u32 m0, s91, 3120
    s_nop 0
    buffer_load_dwordx4 v0, s[8:11], s90 offen lds
    s_add_u32 s90, s90, 1024
    s_add_u32 m0, s91, 4160
    s_nop 0
    buffer_load_dwordx4 v0, s[8:11], s90 offen lds
    s_add_u32 s90, s90, 1024
    s_add_u32 m0, s91, 5200
    s_nop 0
    buffer_load_dwordx4 v0, s[8:11], s90 offen lds
    s_add_u32 s90, s90, 1024
    s_add_u32 m0, s91, 6240
    s_nop 0
    buffer_load_dwordx4 v0, s[8:11], s90 offen lds
    s_add_u32 s90, s90, 1024
    s_add_u32 m0, s91, 7280
    s_nop 0
    buffer_load_dwordx4 v0, s[8:11], s90 offen lds
    v_add_u32 v6, 66560, v0
    v_lshlrev_b32 v7, 12, v1
    v_lshl_add_u32 v7, v2, 4, v7
    s_lshl_b32 s7, s3, 8
    v_add_u32 v7, s7, v7
    s_lshl_b32 s7, s3, 10
    v_add_u32 v5, s7, v6
    s_waitcnt vmcnt(0)
F_loop:
    s_waitcnt vmcnt(8)
    s_barrier
    s_lshl_b32 s43, s6, 1
    s_add_u32 s43, s43, s5
    s_add_u32 s44, s43, 2
    s_min_u32 s44, s44, 63
    s_sub_u32 s45, 33280, s46
    s_lshl_b32 s90, s44, 15
    s_lshl_b32 s91, s3, 13
    s_add_u32 s90, s90, s91
    s_mul_i32 s91, s3, 8320
    s_add_u32 s91, s91, s45
    s_add_u32 m0, s91, 0
    s_nop 0
    buffer_load_dwordx4 v0, s[8:11], s90 offen lds
    s_add_u32 s90, s90, 1024
    s_add_u32 m0, s91, 1040
    s_nop 0
    buffer_load_dwordx4 v0, s[8:11], s90 offen lds
    s_add_u32 s90, s90, 1024
    s_add_u32 m0, s91, 2080
    s_nop 0
    buffer_load_dwordx4 v0, s[8:11], s90 offen lds
    s_add_u32 s90, s90, 1024
    s_add_u32 m0, s91, 3120
    s_nop 0
    buffer_load_dwordx4 v0, s[8:11], s90 offen lds
    s_add_u32 s90, s90, 1024
    s_add_u32 m0, s91, 4160
    s_nop 0
    buffer_load_dwordx4 v0, s[8:11], s90 offen lds
    s_add_u32 s90, s90, 1024
    s_add_u32 m0, s91, 5200
    s_nop 0
    buffer_load_dwordx4 v0, s[8:11], s90 offen lds
    s_add_u32 s90, s90, 1024
    s_add_u32 m0, s91, 6240
    s_nop 0
    buffer_load_dwordx4 v0, s[8:11], s90 offen lds
    s_add_u32 s90, s90, 1024
    s_add_u32 m0, s91, 7280
    s_nop 0
    buffer_load_dwordx4 v0, s[8:11], s90 offen lds
    v_add_u32 v4, s46, v3
    ds_read_b128 v[32:35], v4 offset:0
    ds_read_b128 v[36:39], v4 offset:16640
    ds_read_b128 v[40:43], v4 offset:64
    ds_read_b128 v[44:47], v4 offset:16704
    ds_read_b128 v[48:51], v4 offset:128
    ds_read_b128 v[52:55], v4 offset:16768
    s_waitcnt lgkmcnt(4)
    v_mfma_f32_16x16x32_bf16 v[64:67], a[0:3], v[32:35], 0
    v_mfma_f32_16x16x32_bf16 v[68:71], a[0:3], v[36:39], 0
    v_mfma_f32_16x16x32_bf16 v[72:75], a[4:7], v[32:35], 0
    v_mfma_f32_16x16x32_bf16 v[76:79], a[4:7], v[36:39], 0
    v_mfma_f32_16x16x32_bf16 v[80:83], a[128:131], v[32:35], 0
    v_mfma_f32_16x16x32_bf16 v[84:87], a[128:131], v[36:39], 0
    v_mfma_f32_16x16x32_bf16 v[88:91], a[132:135], v[32:35], 0
    v_mfma_f32_16x16x32_bf16 v[92:95], a[132:135], v[36:39], 0
    ds_read_b128 v[32:35], v4 offset:192
    ds_read_b128 v[36:39], v4 offset:16832
    s_waitcnt lgkmcnt(4)
    v_mfma_f32_16x16x32_bf16 v[64:67], a[8:11], v[40:43], v[64:67]
    v_mfma_f32_16x16x32_bf16 v[68:71], a[8:11], v[44:47], v[68:71]
    v_mfma_f32_16x16x32_bf16 v[72:75], a[12:15], v[40:43], v[72:75]
    v_mfma_f32_16x16x32_bf16 v[76:79], a[12:15], v[44:47], v[76:79]
    v_mfma_f32_16x16x32_bf16 v[80:83], a[136:139], v[40:43], v[80:83]
    v_mfma_f32_16x16x32_bf16 v[84:87], a[136:139], v[44:47], v[84:87]
    v_mfma_f32_16x16x32_bf16 v[88:91], a[140:143], v[40:43], v[88:91]
    v_mfma_f32_16x16x32_bf16 v[92:95], a[140:143], v[44:47], v[92:95]
    ds_read_b128 v[40:43], v4 offset:256
    ds_read_b128 v[44:47], v4 offset:16896
    s_waitcnt lgkmcnt(4)
    v_mfma_f32_16x16x32_bf16 v[64:67], a[16:19], v[48:51], v[64:67]
    v_mfma_f32_16x16x32_bf16 v[68:71], a[16:19], v[52:55], v[68:71]
    v_mfma_f32_16x16x32_bf16 v[72:75], a[20:23], v[48:51], v[72:75]
    v_mfma_f32_16x16x32_bf16 v[76:79], a[20:23], v[52:55], v[76:79]
    v_mfma_f32_16x16x32_bf16 v[80:83], a[144:147], v[48:51], v[80:83]
    v_mfma_f32_16x16x32_bf16 v[84:87], a[144:147], v[52:55], v[84:87]
    v_mfma_f32_16x16x32_bf16 v[88:91], a[148:151], v[48:51], v[88:91]
    v_mfma_f32_16x16x32_bf16 v[92:95], a[148:151], v[52:55], v[92:95]
    ds_read_b128 v[48:51], v4 offset:320
    ds_read_b128 v[52:55], v4 offset:16960
    s_waitcnt lgkmcnt(4)
    v_mfma_f32_16x16x32_bf16 v[64:67], a[24:27], v[32:35], v[64:67]
    v_mfma_f32_16x16x32_bf16 v[68:71], a[24:27], v[36:39], v[68:71]
    v_mfma_f32_16x16x32_bf16 v[72:75], a[28:31], v[32:35], v[72:75]
    v_mfma_f32_16x16x32_bf16 v[76:79], a[28:31], v[36:39], v[76:79]
    v_mfma_f32_16x16x32_bf16 v[80:83], a[152:155], v[32:35], v[80:83]
    v_mfma_f32_16x16x32_bf16 v[84:87], a[152:155], v[36:39], v[84:87]
    v_mfma_f32_16x16x32_bf16 v[88:91], a[156:159], v[32:35], v[88:91]
    v_mfma_f32_16x16x32_bf16 v[92:95], a[156:159], v[36:39], v[92:95]
    ds_read_b128 v[32:35], v4 offset:384
    ds_read_b128 v[36:39], v4 offset:17024
    s_waitcnt lgkmcnt(4)
    v_mfma_f32_16x16x32_bf16 v[64:67], a[32:35], v[40:43], v[64:67]
    v_mfma_f32_16x16x32_bf16 v[68:71], a[32:35], v[44:47], v[68:71]
    v_mfma_f32_16x16x32_bf16 v[72:75], a[36:39], v[40:43], v[72:75]
    v_mfma_f32_16x16x32_bf16 v[76:79], a[36:39], v[44:47], v[76:79]
    v_mfma_f32_16x16x32_bf16 v[80:83], a[160:163], v[40:43], v[80:83]
    v_mfma_f32_16x16x32_bf16 v[84:87], a[160:163], v[44:47], v[84:87]
    v_mfma_f32_16x16x32_bf16 v[88:91], a[164:167], v[40:43], v[88:91]
    v_mfma_f32_16x16x32_bf16 v[92:95], a[164:167], v[44:47], v[92:95]
    ds_read_b128 v[40:43], v4 offset:448
    ds_read_b128 v[44:47], v4 offset:17088
    s_waitcnt lgkmcnt(4)
    v_mfma_f32_16x16x32_bf16 v[64:67], a[40:43], v[48:51], v[64:67]
    v_mfma_f32_16x16x32_bf16 v[68:71], a[40:43], v[52:55], v[68:71]
    v_mfma_f32_16x16x32_bf16 v[72:75], a[44:47], v[48:51], v[72:75]
    v_mfma_f32_16x16x32_bf16 v[76:79], a[44:47], v[52:55], v[76:79]
    v_mfma_f32_16x16x32_bf16 v[80:83], a[168:171], v[48:51], v[80:83]
    v_mfma_f32_16x16x32_bf16 v[84:87], a[168:171], v[52:55], v[84:87]
    v_mfma_f32_16x16x32_bf16 v[88:91], a[172:175], v[48:51], v[88:91]
    v_mfma_f32_16x16x32_bf16 v[92:95], a[172:175], v[52:55], v[92:95]
    ds_read_b128 v[48:51], v4 offset:512
    ds_read_b128 v[52:55], v4 offset:17152
    s_waitcnt lgkmcnt(4)
    v_mfma_f32_16x16x32_bf16 v[64:67], a[48:51], v[32:35], v[64:67]
    v_mfma_f32_16x16x32_bf16 v[68:71], a[48:51], v[36:39], v[68:71]
    v_mfma_f32_16x16x32_bf16 v[72:75], a[52:55], v[32:35], v[72:75]
    v_mfma_f32_16x16x32_bf16 v[76:79], a[52:55], v[36:39], v[76:79]
    v_mfma_f32_16x16x32_bf16 v[80:83], a[176:179], v[32:35], v[80:83]
    v_mfma_f32_16x16x32_bf16 v[84:87], a[176:179], v[36:39], v[84:87]
    v_mfma_f32_16x16x32_bf16 v[88:91], a[180:183], v[32:35], v[88:91]
    v_mfma_f32_16x16x32_bf16 v[92:95], a[180:183], v[36:39], v[92:95]
    ds_read_b128 v[32:35], v4 offset:576
    ds_read_b128 v[36:39], v4 offset:17216
    s_waitcnt lgkmcnt(4)
    v_mfma_f32_16x16x32_bf16 v[64:67], a[56:59], v[40:43], v[64:67]
    v_mfma_f32_16x16x32_bf16 v[68:71], a[56:59], v[44:47], v[68:71]
    v_mfma_f32_16x16x32_bf16 v[72:75], a[60:63], v[40:43], v[72:75]
    v_mfma_f32_16x16x32_bf16 v[76:79], a[60:63], v[44:47], v[76:79]
    v_mfma_f32_16x16x32_bf16 v[80:83], a[184:187], v[40:43], v[80:83]
    v_mfma_f32_16x16x32_bf16 v[84:87], a[184:187], v[44:47], v[84:87]
    v_mfma_f32_16x16x32_bf16 v[88:91], a[188:191], v[40:43], v[88:91]
    v_mfma_f32_16x16x32_bf16 v[92:95], a[188:191], v[44:47], v[92:95]
    ds_read_b128 v[40:43], v4 offset:640
    ds_read_b128 v[44:47], v4 offset:17280
    s_waitcnt lgkmcnt(4)
    v_mfma_f32_16x16x32_bf16 v[64:67], a[64:67], v[48:51], v[64:67]
    v_mfma_f32_16x16x32_bf16 v[68:71], a[64:67], v[52:55], v[68:71]
    v_mfma_f32_16x16x32_bf16 v[72:75], a[68:71], v[48:51], v[72:75]
    v_mfma_f32_16x16x32_bf16 v[76:79], a[68:71], v[52:55], v[76:79]
    v_mfma_f32_16x16x32_bf16 v[80:83], a[192:195], v[48:51], v[80:83]
    v_mfma_f32_16x16x32_bf16 v[84:87], a[192:195], v[52:55], v[84:87]
    v_mfma_f32_16x16x32_bf16 v[88:91], a[196:199], v[48:51], v[88:91]
    v_mfma_f32_16x16x32_bf16 v[92:95], a[196:199], v[52:55], v[92:95]
    ds_read_b128 v[48:51], v4 offset:704
    ds_read_b128 v[52:55], v4 offset:17344
    s_waitcnt lgkmcnt(4)
    v_mfma_f32_16x16x32_bf16 v[64:67], a[72:75], v[32:35], v[64:67]
    v_mfma_f32_16x16x32_bf16 v[68:71], a[72:75], v[36:39], v[68:71]
    v_mfma_f32_16x16x32_bf16 v[72:75], a[76:79], v[32:35], v[72:75]
    v_mfma_f32_16x16x32_bf16 v[76:79], a[76:79], v[36:39], v[76:79]
    v_mfma_f32_16x16x32_bf16 v[80:83], a[200:203], v[32:35], v[80:83]
    v_mfma_f32_16x16x32_bf16 v[84:87], a[200:203], v[36:39], v[84:87]
    v_mfma_f32_16x16x32_bf16 v[88:91], a[204:207], v[32:35], v[88:91]
    v_mfma_f32_16x16x32_bf16 v[92:95], a[204:207], v[36:39], v[92:95]
    s_waitcnt vmcnt(8)
    v_mov_b32 v24, s6
    s_mov_b64 exec, 1
    buffer_store_dword v24, off, s[12:15], s47 sc1
    s_mov_b64 exec, -1
    ds_read_b128 v[32:35], v4 offset:768
    ds_read_b128 v[36:39], v4 offset:17408
    s_waitcnt lgkmcnt(4)
    v_mfma_f32_16x16x32_bf16 v[64:67], a[80:83], v[40:43], v[64:67]
    v_mfma_f32_16x16x32_bf16 v[68:71], a[80:83], v[44:47], v[68:71]
    v_mfma_f32_16x16x32_bf16 v[72:75], a[84:87], v[40:43], v[72:75]
    v_mfma_f32_16x16x32_bf16 v[76:79], a[84:87], v[44:47], v[76:79]
    v_mfma_f32_16x16x32_bf16 v[80:83], a[208:211], v[40:43], v[80:83]
    v_mfma_f32_16x16x32_bf16 v[84:87], a[208:211], v[44:47], v[84:87]
    v_mfma_f32_16x16x32_bf16 v[88:91], a[212:215], v[40:43], v[88:91]
    v_mfma_f32_16x16x32_bf16 v[92:95], a[212:215], v[44:47], v[92:95]
    ds_read_b128 v[40:43], v4 offset:832
    ds_read_b128 v[44:47], v4 offset:17472
    s_waitcnt lgkmcnt(4)
    v_mfma_f32_16x16x32_bf16 v[64:67], a[88:91], v[48:51], v[64:67]
    v_mfma_f32_16x16x32_bf16 v[68:71], a[88:91], v[52:55], v[68:71]
    v_mfma_f32_16x16x32_bf16 v[72:75], a[92:95], v[48:51], v[72:75]
    v_mfma_f32_16x16x32_bf16 v[76:79], a[92:95], v[52:55], v[76:79]
    v_mfma_f32_16x16x32_bf16 v[80:83], a[216:219], v[48:51], v[80:83]
    v_mfma_f32_16x16x32_bf16 v[84:87], a[216:219], v[52:55], v[84:87]
    v_mfma_f32_16x16x32_bf16 v[88:91], a[220:223], v[48:51], v[88:91]
    v_mfma_f32_16x16x32_bf16 v[92:95], a[220:223], v[52:55], v[92:95]
    ds_read_b128 v[48:51], v4 offset:896
    ds_read_b128 v[52:55], v4 offset:17536
    s_waitcnt lgkmcnt(4)
    v_mfma_f32_16x16x32_bf16 v[64:67], a[96:99], v[32:35], v[64:67]
    v_mfma_f32_16x16x32_bf16 v[68:71], a[96:99], v[36:39], v[68:71]
    v_mfma_f32_16x16x32_bf16 v[72:75], a[100:103], v[32:35], v[72:75]
    v_mfma_f32_16x16x32_bf16 v[76:79], a[100:103], v[36:39], v[76:79]
    v_mfma_f32_16x16x32_bf16 v[80:83], a[224:227], v[32:35], v[80:83]
    v_mfma_f32_16x16x32_bf16 v[84:87], a[224:227], v[36:39], v[84:87]
    v_mfma_f32_16x16x32_bf16 v[88:91], a[228:231], v[32:35], v[88:91]
    v_mfma_f32_16x16x32_bf16 v[92:95], a[228:231], v[36:39], v[92:95]
    ds_read_b128 v[32:35], v4 offset:960
    ds_read_b128 v[36:39], v4 offset:17600
    s_waitcnt lgkmcnt(4)
    v_mfma_f32_16x16x32_bf16 v[64:67], a[104:107], v[40:43], v[64:67]
    v_mfma_f32_16x16x32_bf16 v[68:71], a[104:107], v[44:47], v[68:71]
    v_mfma_f32_16x16x32_bf16 v[72:75], a[108:111], v[40:43], v[72:75]
    v_mfma_f32_16x16x32_bf16 v[76:79], a[108:111], v[44:47], v[76:79]
    v_mfma_f32_16x16x32_bf16 v[80:83], a[232:235], v[40:43], v[80:83]
    v_mfma_f32_16x16x32_bf16 v[84:87], a[232:235], v[44:47], v[84:87]
    v_mfma_f32_16x16x32_bf16 v[88:91], a[236:239], v[40:43], v[88:91]
    v_mfma_f32_16x16x32_bf16 v[92:95], a[236:239], v[44:47], v[92:95]
    s_waitcnt lgkmcnt(2)
    v_mfma_f32_16x16x32_bf16 v[64:67], a[112:115], v[48:51], v[64:67]
    v_mfma_f32_16x16x32_bf16 v[68:71], a[112:115], v[52:55], v[68:71]
    v_mfma_f32_16x16x32_bf16 v[72:75], a[116:119], v[48:51], v[72:75]
    v_mfma_f32_16x16x32_bf16 v[76:79], a[116:119], v[52:55], v[76:79]
    v_mfma_f32_16x16x32_bf16 v[80:83], a[240:243], v[48:51], v[80:83]
    v_mfma_f32_16x16x32_bf16 v[84:87], a[240:243], v[52:55], v[84:87]
    v_mfma_f32_16x16x32_bf16 v[88:91], a[244:247], v[48:51], v[88:91]
    v_mfma_f32_16x16x32_bf16 v[92:95], a[244:247], v[52:55], v[92:95]
    s_waitcnt lgkmcnt(0)
    v_mfma_f32_16x16x32_bf16 v[64:67], a[120:123], v[32:35], v[64:67]
    v_mfma_f32_16x16x32_bf16 v[68:71], a[120:123], v[36:39], v[68:71]
    v_mfma_f32_16x16x32_bf16 v[72:75], a[124:127], v[32:35], v[72:75]
    v_mfma_f32_16x16x32_bf16 v[76:79], a[124:127], v[36:39], v[76:79]
    v_mfma_f32_16x16x32_bf16 v[80:83], a[248:251], v[32:35], v[80:83]
    v_mfma_f32_16x16x32_bf16 v[84:87], a[248:251], v[36:39], v[84:87]
    v_mfma_f32_16x16x32_bf16 v[88:91], a[252:255], v[32:35], v[88:91]
    v_mfma_f32_16x16x32_bf16 v[92:95], a[252:255], v[36:39], v[92:95]
    v_max_f32 v64, 0, v64
    v_max_f32 v65, 0, v65
    v_max_f32 v66, 0, v66
    v_max_f32 v67, 0, v67
    v_max_f32 v68, 0, v68
    v_max_f32 v69, 0, v69
    v_max_f32 v70, 0, v70
    v_max_f32 v71, 0, v71
    v_max_f32 v72, 0, v72
    v_max_f32 v73, 0, v73
    v_max_f32 v74, 0, v74
    v_max_f32 v75, 0, v75
    v_max_f32 v76, 0, v76
    v_max_f32 v77, 0, v77
    v_max_f32 v78, 0, v78
    v_max_f32 v79, 0, v79
    v_mul_f32 v64, v64, v80
    v_mul_f32 v65, v65, v81
    v_mul_f32 v66, v66, v82
    v_mul_f32 v67, v67, v83
    v_mul_f32 v68, v68, v84
    v_mul_f32 v69, v69, v85
    v_mul_f32 v70, v70, v86
    v_mul_f32 v71, v71, v87
    v_mul_f32 v72, v72, v88
    v_mul_f32 v73, v73, v89
    v_mul_f32 v74, v74, v90
    v_mul_f32 v75, v75, v91
    v_mul_f32 v76, v76, v92
    v_mul_f32 v77, v77, v93
    v_mul_f32 v78, v78, v94
    v_mul_f32 v79, v79, v95
    v_cvt_pk_bf16_f32 v96, v64, v72
    v_cvt_pk_bf16_f32 v97, v65, v73
    v_cvt_pk_bf16_f32 v98, v66, v74
    v_cvt_pk_bf16_f32 v99, v67, v75
    ds_write_b128 v5, v[96:99] offset:0
    v_cvt_pk_bf16_f32 v100, v68, v76
    v_cvt_pk_bf16_f32 v101, v69, v77
    v_cvt_pk_bf16_f32 v102, v70, v78
    v_cvt_pk_bf16_f32 v103, v71, v79
    ds_write_b128 v5, v[100:103] offset:4096
    s_lshl_b32 s48, s43, 4
    s_add_u32 s48, s48, s4
    s_lshl_b32 s48, s48, 15
    s_and_b32 s48, s48, 0x1ffffff
    s_add_u32 s48, s48, 117440512
    s_waitcnt lgkmcnt(0)
    s_barrier
    ds_read_b128 v[32:35], v6 offset:0
    ds_read_b128 v[36:39], v6 offset:1024
    ds_read_b128 v[40:43], v6 offset:2048
    ds_read_b128 v[44:47], v6 offset:3072
    ds_read_b128 v[48:51], v6 offset:4096
    ds_read_b128 v[52:55], v6 offset:5120
    ds_read_b128 v[56:59], v6 offset:6144
    ds_read_b128 v[60:63], v6 offset:7168
    s_add_u32 s7, s48, 16384
    s_waitcnt lgkmcnt(7)
    v_mfma_f32_16x16x32_bf16 v[64:67], v[32:35], v[128:131], 0
    v_mfma_f32_16x16x32_bf16 v[68:71], v[32:35], v[144:147], 0
    v_mfma_f32_16x16x32_bf16 v[72:75], v[32:35], v[160:163], 0
    v_mfma_f32_16x16x32_bf16 v[76:79], v[32:35], v[176:179], 0
    v_mfma_f32_16x16x32_bf16 v[80:83], v[32:35], v[192:195], 0
    v_mfma_f32_16x16x32_bf16 v[84:87], v[32:35], v[208:211], 0
    v_mfma_f32_16x16x32_bf16 v[88:91], v[32:35], v[224:227], 0
    v_mfma_f32_16x16x32_bf16 v[92:95], v[32:35], v[240:243], 0
    s_waitcnt lgkmcnt(6)
    v_mfma_f32_16x16x32_bf16 v[64:67], v[36:39], v[132:135], v[64:67]
    v_mfma_f32_16x16x32_bf16 v[68:71], v[36:39], v[148:151], v[68:71]
    v_mfma_f32_16x16x32_bf16 v[72:75], v[36:39], v[164:167], v[72:75]
    v_mfma_f32_16x16x32_bf16 v[76:79], v[36:39], v[180:183], v[76:79]
    v_mfma_f32_16x16x32_bf16 v[80:83], v[36:39], v[196:199], v[80:83]
    v_mfma_f32_16x16x32_bf16 v[84:87], v[36:39], v[212:215], v[84:87]
    v_mfma_f32_16x16x32_bf16 v[88:91], v[36:39], v[228:231], v[88:91]
    v_mfma_f32_16x16x32_bf16 v[92:95], v[36:39], v[244:247], v[92:95]
    s_waitcnt lgkmcnt(5)
    v_mfma_f32_16x16x32_bf16 v[64:67], v[40:43], v[136:139], v[64:67]
    v_mfma_f32_16x16x32_bf16 v[68:71], v[40:43], v[152:155], v[68:71]
    v_mfma_f32_16x16x32_bf16 v[72:75], v[40:43], v[168:171], v[72:75]
    v_mfma_f32_16x16x32_bf16 v[76:79], v[40:43], v[184:187], v[76:79]
    v_mfma_f32_16x16x32_bf16 v[80:83], v[40:43], v[200:203], v[80:83]
    v_mfma_f32_16x16x32_bf16 v[84:87], v[40:43], v[216:219], v[84:87]
    v_mfma_f32_16x16x32_bf16 v[88:91], v[40:43], v[232:235], v[88:91]
    v_mfma_f32_16x16x32_bf16 v[92:95], v[40:43], v[248:251], v[92:95]
    s_waitcnt lgkmcnt(4)
    v_mfma_f32_16x16x32_bf16 v[64:67], v[44:47], v[140:143], v[64:67]
    v_mfma_f32_16x16x32_bf16 v[68:71], v[44:47], v[156:159], v[68:71]
    v_mfma_f32_16x16x32_bf16 v[72:75], v[44:47], v[172:175], v[72:75]
    v_mfma_f32_16x16x32_bf16 v[76:79], v[44:47], v[188:191], v[76:79]
    v_mfma_f32_16x16x32_bf16 v[80:83], v[44:47], v[204:207], v[80:83]
    v_mfma_f32_16x16x32_bf16 v[84:87], v[44:47], v[220:223], v[84:87]
    v_mfma_f32_16x16x32_bf16 v[88:91], v[44:47], v[236:239], v[88:91]
    v_mfma_f32_16x16x32_bf16 v[92:95], v[44:47], v[252:255], v[92:95]
    s_waitcnt lgkmcnt(3)
    v_mfma_f32_16x16x32_bf16 v[96:99], v[48:51], v[128:131], 0
    v_mfma_f32_16x16x32_bf16 v[100:103], v[48:51], v[144:147], 0
    v_mfma_f32_16x16x32_bf16 v[104:107], v[48:51], v[160:163], 0
    v_cvt_pk_bf16_f32 v24, v64, v68
    v_mfma_f32_16x16x32_bf16 v[108:111], v[48:51], v[176:179], 0
    v_cvt_pk_bf16_f32 v25, v72, v76
    v_mfma_f32_16x16x32_bf16 v[112:115], v[48:51], v[192:195], 0
    v_cvt_pk_bf16_f32 v26, v80, v84
    v_mfma_f32_16x16x32_bf16 v[116:119], v[48:51], v[208:211], 0
    v_cvt_pk_bf16_f32 v27, v88, v92
    v_mfma_f32_16x16x32_bf16 v[120:123], v[48:51], v[224:227], 0
    buffer_store_dwordx4 v[24:27], v7, s[12:15], s48 offen offset:0 sc1
    v_mfma_f32_16x16x32_bf16 v[124:127], v[48:51], v[240:243], 0
    s_waitcnt lgkmcnt(2)
    v_mfma_f32_16x16x32_bf16 v[96:99], v[52:55], v[132:135], v[96:99]
    v_mfma_f32_16x16x32_bf16 v[100:103], v[52:55], v[148:151], v[100:103]
    v_mfma_f32_16x16x32_bf16 v[104:107], v[52:55], v[164:167], v[104:107]
    v_cvt_pk_bf16_f32 v28, v65, v69
    v_mfma_f32_16x16x32_bf16 v[108:111], v[52:55], v[180:183], v[108:111]
    v_cvt_pk_bf16_f32 v29, v73, v77
    v_mfma_f32_16x16x32_bf16 v[112:115], v[52:55], v[196:199], v[112:115]
    v_cvt_pk_bf16_f32 v30, v81, v85
    v_mfma_f32_16x16x32_bf16 v[116:119], v[52:55], v[212:215], v[116:119]
    v_cvt_pk_bf16_f32 v31, v89, v93
    v_mfma_f32_16x16x32_bf16 v[120:123], v[52:55], v[228:231], v[120:123]
    buffer_store_dwordx4 v[28:31], v7, s[12:15], s48 offen offset:1024 sc1
    v_mfma_f32_16x16x32_bf16 v[124:127], v[52:55], v[244:247], v[124:127]
    s_waitcnt lgkmcnt(1)
    v_mfma_f32_16x16x32_bf16 v[96:99], v[56:59], v[136:139], v[96:99]
    v_mfma_f32_16x16x32_bf16 v[100:103], v[56:59], v[152:155], v[100:103]
    v_mfma_f32_16x16x32_bf16 v[104:107], v[56:59], v[168:171], v[104:107]
    v_cvt_pk_bf16_f32 v24, v66, v70
    v_mfma_f32_16x16x32_bf16 v[108:111], v[56:59], v[184:187], v[108:111]
    v_cvt_pk_bf16_f32 v25, v74, v78
    v_mfma_f32_16x16x32_bf16 v[112:115], v[56:59], v[200:203], v[112:115]
    v_cvt_pk_bf16_f32 v26, v82, v86
    v_mfma_f32_16x16x32_bf16 v[116:119], v[56:59], v[216:219], v[116:119]
    v_cvt_pk_bf16_f32 v27, v90, v94
    v_mfma_f32_16x16x32_bf16 v[120:123], v[56:59], v[232:235], v[120:123]
    buffer_store_dwordx4 v[24:27], v7, s[12:15], s48 offen offset:2048 sc1
    v_mfma_f32_16x16x32_bf16 v[124:127], v[56:59], v[248:251], v[124:127]
    s_waitcnt lgkmcnt(0)
    v_mfma_f32_16x16x32_bf16 v[96:99], v[60:63], v[140:143], v[96:99]
    v_mfma_f32_16x16x32_bf16 v[100:103], v[60:63], v[156:159], v[100:103]
    v_mfma_f32_16x16x32_bf16 v[104:107], v[60:63], v[172:175], v[104:107]
    v_cvt_pk_bf16_f32 v28, v67, v71
    v_mfma_f32_16x16x32_bf16 v[108:111], v[60:63], v[188:191], v[108:111]
    v_cvt_pk_bf16_f32 v29, v75, v79
    v_mfma_f32_16x16x32_bf16 v[112:115], v[60:63], v[204:207], v[112:115]
    v_cvt_pk_bf16_f32 v30, v83, v87
    v_mfma_f32_16x16x32_bf16 v[116:119], v[60:63], v[220:223], v[116:119]
    v_cvt_pk_bf16_f32 v31, v91, v95
    v_mfma_f32_16x16x32_bf16 v[120:123], v[60:63], v[236:239], v[120:123]
    buffer_store_dwordx4 v[28:31], v7, s[12:15], s48 offen offset:3072 sc1
    v_mfma_f32_16x16x32_bf16 v[124:127], v[60:63], v[252:255], v[124:127]
    v_cvt_pk_bf16_f32 v24, v96, v100
    v_cvt_pk_bf16_f32 v25, v104, v108
    v_cvt_pk_bf16_f32 v26, v112, v116
    s_nop 4
    v_cvt_pk_bf16_f32 v27, v120, v124
    buffer_store_dwordx4 v[24:27], v7, s[12:15], s7 offen offset:0 sc1
    v_cvt_pk_bf16_f32 v28, v97, v101
    v_cvt_pk_bf16_f32 v29, v105, v109
    v_cvt_pk_bf16_f32 v30, v113, v117
    v_cvt_pk_bf16_f32 v31, v121, v125
    buffer_store_dwordx4 v[28:31], v7, s[12:15], s7 offen offset:1024 sc1
    v_cvt_pk_bf16_f32 v24, v98, v102
    v_cvt_pk_bf16_f32 v25, v106, v110
    v_cvt_pk_bf16_f32 v26, v114, v118
    v_cvt_pk_bf16_f32 v27, v122, v126
    buffer_store_dwordx4 v[24:27], v7, s[12:15], s7 offen offset:2048 sc1
    v_cvt_pk_bf16_f32 v28, v99, v103
    v_cvt_pk_bf16_f32 v29, v107, v111
    v_cvt_pk_bf16_f32 v30, v115, v119
    v_cvt_pk_bf16_f32 v31, v123, v127
    buffer_store_dwordx4 v[28:31], v7, s[12:15], s7 offen offset:3072 sc1
    s_sub_u32 s46, 33280, s46
    s_add_u32 s6, s6, 1
    s_cmp_lt_u32 s6, 32
    s_cbranch_scc1 F_loop
    s_waitcnt vmcnt(0)
    v_mov_b32 v24, s6
    s_mov_b64 exec, 1
    buffer_store_dword v24, off, s[12:15], s47 sc1
    s_mov_b64 exec, -1
    s_waitcnt vmcnt(0)
    s_endpgm
L_code_end:
.section .rodata,"a"
.p2align 6
.amdhsa_kernel gated_mix__memory_aug_recurrent_mem_tr__glu_gated_reglu__prompt_kernel
  .amdhsa_next_free_vgpr 512
  .amdhsa_next_free_sgpr 102
  .amdhsa_accum_offset 256
  .amdhsa_group_segment_fixed_size 0
  .amdhsa_kernarg_size 120
  .amdhsa_user_sgpr_count 2
  .amdhsa_user_sgpr_kernarg_segment_ptr 1
  .amdhsa_system_sgpr_workgroup_id_x 1
.end_amdhsa_kernel
```
